```python
import torch

def _softmax(x, axis=-1):
    return torch.softmax(x, dim=axis)

def _gelu(x):
    return torch.nn.functional.gelu(x, approximate='tanh')

def _silu(x):
    return torch.nn.functional.silu(x)

def _sigmoid(x):
    return torch.sigmoid(x)

def _layernorm(x, axis=-1, eps=1e-05):
    m = x.mean(dim=axis, keepdim=True)
    v = x.var(dim=axis, keepdim=True, unbiased=False)
    return (x - m) / torch.sqrt(v + eps)

def _scatter_add(tgt, idx, src, axis=0):
    return tgt.clone().index_add_(axis, idx, src)

def _segment_sum(src, seg, n):
    out = torch.zeros((n,) + src.shape[1:], dtype=src.dtype)
    return out.index_add_(0, seg, src)

def _pad(x, pw):
    flat = tuple((v for pair in reversed(pw) for v in pair))
    return torch.nn.functional.pad(x, flat)
kernel_name = 'standalone__factorization_afm__recsys'

def setup_inputs():

    _w = lambda a: (lambda t: t.to(torch.bfloat16) if t.is_floating_point() else t)(torch.as_tensor(a))
    B, F, D, V = (16384, 26, 32, min(1000000, 100000))
    A = D
    ii, jj = tuple(torch.triu_indices(F, F, 1).unbind(0))
    return {'idx': _w((lambda lo, hi, *s: torch.randint(lo, hi, s))(0, V, B, F).to(torch.int64)), 'table': _w((lambda *s: torch.randn(*s, dtype=torch.bfloat16) * 0.8)(V, D)), 'ii': _w(ii.to(torch.int64)), 'jj': _w(jj.to(torch.int64)), 'W': _w((lambda *s: torch.randn(*s, dtype=torch.bfloat16) * 0.8)(D, A) * (1.0 / D ** 0.5)), 'b': _w((lambda *s: torch.randn(*s, dtype=torch.bfloat16) * 0.8)(A)), 'h': _w((lambda *s: torch.randn(*s, dtype=torch.bfloat16) * 0.8)(A)), 'p': _w((lambda *s: torch.randn(*s, dtype=torch.bfloat16) * 0.2)(D))}

def reference(idx, table, ii, jj, W, b, h, p):
    emb = table[idx]
    ei = emb[:, ii, :].clone()
    ej = emb[:, jj, :].clone()
    pair = ei * ej
    hid = pair @ W + b
    hid = 0.5 * (hid + torch.abs(hid))
    e = hid @ h
    alpha = _softmax(e, axis=-1)
    pooled = torch.einsum('bp,bpd->bd', alpha, pair)
    return pooled @ p
```

```asm
; @launch grid=(256,1,1) block=(512,1,1) lds=142368
.amdgcn_target "amdgcn-amd-amdhsa--gfx950"
.text
.p2align 12
.globl standalone__factorization_afm__recsys_kernel
.p2align 8
.type standalone__factorization_afm__recsys_kernel,@function
standalone__factorization_afm__recsys_kernel:
    s_cmpk_ge_u32 s2, 256
    s_cbranch_scc1 L_end
    s_load_dwordx2 s[4:5], s[0:1], 0
    s_load_dwordx2 s[20:21], s[0:1], 8
    s_load_dwordx8 s[8:15], s[0:1], 32
    s_load_dwordx2 s[16:17], s[0:1], 64
    v_readfirstlane_b32 s38, v0
    v_lshrrev_b32 v221, 4, v0
    s_lshl_b32 s18, s2, 6
    v_bfe_u32 v220, v0, 2, 2
    v_add_u32 v221, s18, v221
    v_mul_u32_u24 v221, 104, v221
    v_and_b32 v225, 4, v0
    v_mad_u32_u24 v23, v220, 24, v221
    v_add_u32 v31, v221, v225
    v_and_b32 v222, 3, v0
    v_lshlrev_b32 v20, 4, v222
    s_xor_b32 s38, s38, 256
    s_mov_b32 s22, 6400000
    s_mov_b32 s23, 0x00020000
    s_cmpk_ge_u32 s38, 256
    s_cselect_b64 vcc, -1, 0
    s_cbranch_scc0 L_i
L_y1:
    s_getpc_b64 s[18:19]
L_pc:
    s_sub_u32 s18, s18, L_pc-standalone__factorization_afm__recsys_kernel
    s_subb_u32 s19, s19, 0
    s_lshr_b32 s39, s2, 1
    v_bfe_u32 v248, v0, 6, 2
    s_and_b32 s39, s39, 0x7c
    v_and_b32 v249, 1, v0
    v_add_u32 v248, s39, v248
    v_lshl_add_u32 v248, v249, 7, v248
    v_min_u32 v248, 159, v248
    v_lshlrev_b32 v248, 7, v248
    v_mov_b32 v249, 0
    v_lshl_add_u64 v[248:249], v[248:249], 0, s[18:19]
    global_load_dword v250, v[248:249], off
    s_cmpk_gt_u32 s38, 384
    s_cbranch_scc1 L_c
    v_and_b32 v234, 31, v0
    v_lshlrev_b32 v233, 1, v234
    s_waitcnt lgkmcnt(0)
    global_load_ushort v233, v233, s[12:13]
    s_cmpk_eq_u32 s38, 320
    s_cbranch_scc1 L_y1l
    v_lshrrev_b32 v226, 1, v0
    v_and_b32 v224, 8, v0
    v_and_b32 v228, 19, v0
    v_and_b32 v226, 16, v226
    v_lshl_add_u32 v228, v228, 6, v226
    v_lshl_add_u32 v228, v225, 7, v228
    v_lshl_add_u32 v228, v224, 5, v228
    s_cmpk_eq_u32 s38, 384
    s_cbranch_scc1 L_y1c
    global_load_dwordx4 v[180:183], v228, s[8:9]
    global_load_dwordx4 v[184:187], v228, s[8:9] offset:32
    s_branch L_c
L_y1c:
    global_load_dwordx4 v[180:183], v226, s[10:11]
    global_load_dwordx4 v[184:187], v226, s[10:11] offset:32
    s_branch L_c
L_y1l:
    v_and_b32 v227, 48, v0
    global_load_dwordx4 v[204:207], v227, s[12:13]
    global_load_dwordx4 v[208:211], v227, s[14:15]
    v_and_b32 v229, 14, v0
    v_and_b32 v226, 1, v0
    v_lshl_add_u32 v229, v229, 7, v227
    v_lshl_add_u32 v229, v226, 6, v229
    global_load_dwordx4 v[196:199], v229, s[8:9]
    global_load_dwordx4 v[200:203], v229, s[8:9] offset:128
    s_branch L_c
L_i:
    s_waitcnt lgkmcnt(0)
    global_load_dwordx4 v[24:27], v23, s[4:5] offset:0
    global_load_dword v30, v31, s[4:5] offset:96
    global_load_dwordx2 v[28:29], v23, s[4:5] offset:16
L_c:
    v_lshrrev_b32 v230, 6, v0
    s_movk_i32 s18, 2080
    v_mul_u32_u24 v11, 16640, v230
    v_mad_u32_u24 v13, v222, s18, v11
    v_bfe_u32 v230, v0, 4, 2
    v_lshl_add_u32 v13, v220, 4, v13
    v_lshl_add_u32 v13, v230, 7, v13
    v_bfe_u32 v230, v0, 5, 1
    v_mad_u32_u24 v8, v230, s18, v11
    v_and_b32 v230, 24, v0
    v_and_b32 v231, 7, v0
    v_lshl_add_u32 v8, v230, 4, v8
    v_lshl_add_u32 v2, v231, 4, v8
    v_xor_b32 v230, 4, v231
    v_lshl_add_u32 v5, v230, 4, v8
    v_add_u32 v230, 1, v231
    v_and_b32 v230, 7, v230
    v_lshl_add_u32 v3, v230, 4, v8
    v_add_u32 v230, 3, v231
    v_and_b32 v230, 7, v230
    v_lshl_add_u32 v4, v230, 4, v8
    v_lshlrev_b32 v230, 7, v225
    s_mov_b32 s28, 0xf0f0f0f0
    v_add_u32 v6, v5, v230
    s_mov_b32 s29, s28
    v_sub_u32 v7, v5, v230
    s_cbranch_vccnz L_n0
    s_setprio 3
    s_waitcnt vmcnt(2)
    v_lshl_add_u32 v24, v24, 6, v20
    buffer_load_dwordx4 v[136:139], v24, s[20:23], 0 offen
L_n0:
    v_add_u32 v230, 1536, v8
    s_mov_b32 s31, 0xe0e0e0e0
    v_cndmask_b32_e64 v9, v2, v230, s[28:29]
    v_add_u32 v230, 16, v230
    s_mov_b32 s30, 0
    v_cndmask_b32_e64 v10, v5, v230, s[28:29]
    s_mov_b32 s24, 0xaaaaaaaa
    v_mov_b32 v11, 140288
    v_add_u32 v230, 16, v11
    s_mov_b32 s25, s24
    v_cndmask_b32_e64 v12, v11, v230, s[30:31]
    s_lshr_b64 s[30:31], s[30:31], 32
    v_cndmask_b32_e64 v22, v11, v230, s[30:31]
    v_mov_b32 v230, 0x4444
    s_cbranch_vccnz L_n1
    v_lshl_add_u32 v25, v25, 6, v20
    buffer_load_dwordx4 v[140:143], v25, s[20:23], 0 offen
L_n1:
    v_mov_b32 v1, 0xeeee
    s_mov_b32 s26, 0xcccccccc
    v_cndmask_b32_e64 v1, v230, v1, s[24:25]
    v_mov_b32 v230, 16896
    s_mov_b32 s27, s26
    v_lshlrev_b32 v232, 16, v230
    v_cndmask_b32_e64 v232, v230, v232, s[24:25]
    v_cndmask_b32_e64 v100, v232, 0, s[26:27]
    v_cndmask_b32_e64 v101, 0, v232, s[26:27]
    v_and_b32 v21, 63, v0
    v_lshlrev_b32 v21, 4, v21
    v_add_u32 v21, 133120, v21
    s_mov_b32 s34, 0
    s_mov_b32 s35, 0
    s_cbranch_vccnz L_n2
    s_waitcnt vmcnt(3)
    v_lshl_add_u32 v30, v30, 6, v20
    buffer_load_dwordx4 v[144:147], v30, s[20:23], 0 offen
L_n2:
    s_cbranch_vccnz L_y2
    s_barrier
    v_lshl_add_u32 v26, v26, 6, v20
    buffer_load_dwordx4 v[148:151], v26, s[20:23], 0 offen
    v_lshl_add_u32 v27, v27, 6, v20
    buffer_load_dwordx4 v[152:155], v27, s[20:23], 0 offen
    ds_read_b128 v[80:83], v21 offset:0
    ds_read_b128 v[84:87], v21 offset:1024
    ds_read_b128 v[32:35], v21 offset:2048
    ds_read_b128 v[36:39], v21 offset:3072
    ds_read_b128 v[40:43], v21 offset:4096
    ds_read_b128 v[44:47], v21 offset:5120
    ds_read_b64 v[96:97], v21 offset:6144
    ds_read_b128 v[88:91], v21 offset:7168
    ds_read_b128 v[92:95], v21 offset:8192
L_p:
    s_lshl_b32 s39, s2, 6
    s_mov_b32 s30, 0x01010101
    s_mov_b32 s31, s30
    ds_read_b128 v[124:127], v11 offset:2048
    ds_read_b128 v[128:131], v11 offset:2048
    ds_read_b128 v[132:135], v12 offset:2048
    ds_read_b128 v[252:255], v11 offset:2048
    s_mov_b32 s19, 0x3e000000
    s_waitcnt lgkmcnt(6)
    v_mul_f32 v97, v97, v96
    s_waitcnt vmcnt(4)
    v_mfma_f32_4x4x4_16b_bf16 v[48:51], v[100:101], v[136:137], 0
    v_mfma_f32_4x4x4_16b_bf16 v[52:55], v[100:101], v[138:139], 0
    s_waitcnt vmcnt(3)
    v_mfma_f32_4x4x4_16b_bf16 v[56:59], v[100:101], v[140:141], 0
    v_mfma_f32_4x4x4_16b_bf16 v[60:63], v[100:101], v[142:143], 0
    s_nop 0
    v_cvt_pk_f16_f32 v136, v48, v49
    v_cvt_pk_f16_f32 v137, v50, v51
    v_cvt_pk_f16_f32 v138, v52, v53
    v_cvt_pk_f16_f32 v139, v54, v55
    ds_write_b128 v13, v[136:139] offset:0
    v_cvt_pk_f16_f32 v140, v56, v57
    v_cvt_pk_f16_f32 v141, v58, v59
    v_cvt_pk_f16_f32 v142, v60, v61
    v_cvt_pk_f16_f32 v143, v62, v63
    ds_write_b128 v13, v[140:143] offset:64
    ds_read_b128 v[180:183], v2 offset:0
    ds_read_b128 v[184:187], v2 offset:4160
    ds_read_b128 v[188:191], v3 offset:0
    ds_read_b128 v[192:195], v3 offset:4160
    ds_read_b128 v[196:199], v4 offset:0
    ds_read_b128 v[200:203], v4 offset:4160
    v_cmp_le_f32_e64 vcc, s19, |v48|
    s_waitcnt vmcnt(2)
    v_mfma_f32_4x4x4_16b_bf16 v[64:67], v[100:101], v[144:145], 0
    v_mfma_f32_4x4x4_16b_bf16 v[68:71], v[100:101], v[146:147], 0
    s_and_b32 s18, vcc_lo, 0xffff
    s_cselect_b32 s34, s34, 1
    s_lshr_b32 s18, vcc_lo, 16
    s_cselect_b32 s34, s34, 1
    s_and_b32 s18, vcc_hi, 0xffff
    s_cselect_b32 s34, s34, 1
    s_lshr_b32 s18, vcc_hi, 16
    s_cselect_b32 s34, s34, 1
    v_cvt_pk_f16_f32 v144, v64, v65
    v_cvt_pk_f16_f32 v145, v66, v67
    v_cvt_pk_f16_f32 v146, v68, v69
    v_cvt_pk_f16_f32 v147, v70, v71
    ds_write_b128 v13, v[144:147] offset:1536
.p2align 3
L_main:
    s_waitcnt lgkmcnt(3)
    s_nop 0
    v_pk_mul_f16 v108, v180, v188
    v_pk_mul_f16 v109, v181, v189
    v_pk_mul_f16 v110, v182, v190
    v_pk_mul_f16 v111, v183, v191
    v_pk_mul_f16 v112, v184, v192
    v_pk_mul_f16 v113, v185, v193
    v_pk_mul_f16 v114, v186, v194
    v_pk_mul_f16 v115, v187, v195
    v_mfma_f32_32x32x16_f16 v[48:63], v[80:83], v[108:111], v[32:47]
    s_setprio 1
    s_nop 0
    ds_read_b128 v[204:207], v8 offset:1536
    ds_read_b128 v[208:211], v8 offset:5696
    ds_read_b128 v[212:215], v8 offset:1552
    ds_read_b128 v[216:219], v8 offset:5712
    s_waitcnt lgkmcnt(5)
    s_nop 0
    v_pk_mul_f16 v116, v180, v196
    v_pk_mul_f16 v117, v181, v197
    v_mfma_f32_32x32x16_f16 v[48:63], v[84:87], v[112:115], v[48:63]
    v_pk_mul_f16 v118, v182, v198
    v_pk_mul_f16 v119, v183, v199
    v_pk_mul_f16 v120, v184, v200
    v_pk_mul_f16 v121, v185, v201
    v_pk_mul_f16 v122, v186, v202
    v_pk_mul_f16 v123, v187, v203
    v_smfmac_f32_16x16x64_f16 v[124:127], v[88:91], v[108:115], v1
    ds_read_b128 v[220:223], v9 offset:0
    v_pk_mul_f16 v108, v188, v196
    v_mfma_f32_32x32x16_f16 v[64:79], v[80:83], v[116:119], v[32:47]
    v_pk_mul_f16 v109, v189, v197
    v_pk_mul_f16 v110, v190, v198
    v_pk_mul_f16 v111, v191, v199
    v_pk_mul_f16 v112, v192, v200
    v_pk_mul_f16 v113, v193, v201
    v_pk_mul_f16 v114, v194, v202
    v_mfma_f32_32x32x16_f16 v[64:79], v[84:87], v[120:123], v[64:79]
    v_add_u32_e64 v98, v48, v49
    v_sad_u32 v98, v98, v50, v51
    v_add3_u32 v98, v98, v52, v53
    v_sad_u32 v98, v98, v54, v55
    v_add3_u32 v98, v98, v56, v57
    v_add3_u32 v98, v98, v58, v59
    v_smfmac_f32_16x16x64_f16 v[124:127], v[92:95], v[116:123], v1
    ds_read_b128 v[224:227], v9 offset:4160
    v_add3_u32 v98, v98, v60, v61
    v_sad_u32 v98, v98, v62, v63
    s_setprio 0
    s_nop 0
    v_add_u32 v99, v64, v65
    s_waitcnt lgkmcnt(2)
    v_pk_mul_f16 v115, v195, v203
    v_mfma_f32_32x32x16_f16 v[48:63], v[80:83], v[108:111], v[32:47]
    s_setprio 1
    s_nop 0
    v_pk_mul_f16 v116, v204, v180
    v_pk_mul_f16 v117, v205, v181
    v_pk_mul_f16 v118, v206, v182
    v_pk_mul_f16 v119, v207, v183
    v_sad_u32 v99, v99, v66, v67
    v_add3_u32 v99, v99, v68, v69
    v_mfma_f32_32x32x16_f16 v[48:63], v[84:87], v[112:115], v[48:63]
    v_sad_u32 v99, v99, v70, v71
    v_add3_u32 v99, v99, v72, v73
    v_add3_u32 v99, v99, v74, v75
    v_add3_u32 v99, v99, v76, v77
    v_sad_u32 v99, v99, v78, v79
    v_pk_mul_f16 v120, v208, v184
    v_smfmac_f32_16x16x64_f16 v[128:131], v[88:91], v[108:115], v1
    ds_read_b128 v[228:231], v10 offset:0
    v_pk_mul_f16 v121, v209, v185
    v_mfma_f32_32x32x16_f16 v[64:79], v[80:83], v[116:119], v[32:47]
    v_pk_mul_f16 v122, v210, v186
    v_pk_mul_f16 v123, v211, v187
    v_pk_mul_f16 v108, v212, v180
    v_pk_mul_f16 v109, v213, v181
    v_permlane32_swap_b32_e64 v98, v99
    v_mfma_f32_32x32x16_f16 v[64:79], v[84:87], v[120:123], v[64:79]
    v_add3_u32 v16, v98, v99, v124
    v_pk_mul_f16 v110, v214, v182
    v_pk_mul_f16 v111, v215, v183
    v_pk_mul_f16 v112, v216, v184
    v_pk_mul_f16 v113, v217, v185
    v_pk_mul_f16 v114, v218, v186
    v_smfmac_f32_16x16x64_f16 v[128:131], v[92:95], v[116:123], v1
    ds_read_b128 v[232:235], v10 offset:4160
    v_add_u32_e64 v98, v48, v49
    v_sad_u32 v98, v98, v50, v51
    v_add3_u32 v98, v98, v52, v53
    v_sad_u32 v98, v98, v54, v55
    v_add3_u32 v98, v98, v56, v57
    v_add3_u32 v98, v98, v58, v59
    v_add3_u32 v98, v98, v60, v61
    v_sad_u32 v98, v98, v62, v63
    s_waitcnt vmcnt(0)
    s_nop 0
    v_mfma_f32_4x4x4_16b_bf16 v[164:167], v[100:101], v[148:149], 0
    v_mfma_f32_4x4x4_16b_bf16 v[168:171], v[100:101], v[150:151], 0
    v_mfma_f32_4x4x4_16b_bf16 v[172:175], v[100:101], v[152:153], 0
    v_mfma_f32_4x4x4_16b_bf16 v[176:179], v[100:101], v[154:155], 0
    v_lshl_add_u32 v28, v28, 6, v20
    buffer_load_dwordx4 v[156:159], v28, s[20:23], 0 offen
    v_lshl_add_u32 v29, v29, 6, v20
    buffer_load_dwordx4 v[160:163], v29, s[20:23], 0 offen
    v_cvt_pk_f16_f32 v148, v164, v165
    v_cvt_pk_f16_f32 v149, v166, v167
    v_cvt_pk_f16_f32 v150, v168, v169
    v_cvt_pk_f16_f32 v151, v170, v171
    v_cvt_pk_f16_f32 v152, v172, v173
    v_cvt_pk_f16_f32 v153, v174, v175
    v_cvt_pk_f16_f32 v154, v176, v177
    v_cvt_pk_f16_f32 v155, v178, v179
    s_setprio 0
    s_nop 0
    ds_write_b128 v13, v[148:151] offset:512
    ds_write_b128 v13, v[152:155] offset:576
    ds_read_b128 v[236:239], v2 offset:512
    ds_read_b128 v[240:243], v2 offset:4672
    v_fmac_f32_e64 v125, v16, v97
    v_add_u32 v99, v64, v65
    s_waitcnt lgkmcnt(4)
    v_pk_mul_f16 v115, v219, v187
    v_mfma_f32_32x32x16_f16 v[48:63], v[80:83], v[108:111], v[32:47]
    s_setprio 1
    v_exp_f32 v19, v125
    v_pk_mul_f16 v116, v220, v228
    v_pk_mul_f16 v117, v221, v229
    v_pk_mul_f16 v118, v222, v230
    v_pk_mul_f16 v119, v223, v231
    v_mfma_f32_32x32x16_f16 v[48:63], v[84:87], v[112:115], v[48:63]
    v_sad_u32 v99, v99, v66, v67
    v_add3_u32 v99, v99, v68, v69
    v_sad_u32 v99, v99, v70, v71
    v_add3_u32 v99, v99, v72, v73
    v_add3_u32 v99, v99, v74, v75
    v_add3_u32 v99, v99, v76, v77
    v_smfmac_f32_16x16x64_f16 v[132:135], v[88:91], v[108:115], v1
    ds_read_b128 v[244:247], v3 offset:512
    v_sad_u32 v99, v99, v78, v79
    v_mfma_f32_32x32x16_f16 v[64:79], v[80:83], v[116:119], v[32:47]
    s_waitcnt lgkmcnt(1)
    s_nop 0
    v_pk_mul_f16 v120, v224, v232
    v_pk_mul_f16 v121, v225, v233
    v_pk_mul_f16 v122, v226, v234
    v_pk_mul_f16 v123, v227, v235
    v_pk_mul_f16 v108, v180, v236
    v_pk_mul_f16 v109, v181, v237
    v_mfma_f32_32x32x16_f16 v[64:79], v[84:87], v[120:123], v[64:79]
    v_permlane32_swap_b32_e64 v98, v99
    v_add3_u32 v16, v98, v99, v128
    v_pk_mul_f16 v110, v182, v238
    v_pk_mul_f16 v111, v183, v239
    v_pk_mul_f16 v112, v184, v240
    v_smfmac_f32_16x16x64_f16 v[132:135], v[92:95], v[116:123], v1
    ds_read_b128 v[248:251], v3 offset:4672
    v_pk_mul_f16 v113, v185, v241
    v_pk_mul_f16 v114, v186, v242
    v_add_u32_e64 v98, v48, v49
    v_sad_u32 v98, v98, v50, v51
    v_add3_u32 v98, v98, v52, v53
    v_sad_u32 v98, v98, v54, v55
    v_add3_u32 v98, v98, v56, v57
    v_add3_u32 v98, v98, v58, v59
    v_add3_u32 v98, v98, v60, v61
    v_sad_u32 v98, v98, v62, v63
    s_setprio 0
    v_fmac_f32 v129, v16, v97
    v_add_u32 v99, v64, v65
    v_mul_f32 v18, v19, v126
    v_fmac_f32_e64 v18, v19, v127
    v_pk_mul_f16 v115, v187, v243
    v_mfma_f32_32x32x16_f16 v[48:63], v[80:83], v[108:111], v[32:47]
    s_setprio 1
    v_exp_f32 v17, v129
    v_pk_mul_f16 v116, v188, v236
    v_pk_mul_f16 v117, v189, v237
    v_pk_mul_f16 v118, v190, v238
    v_pk_mul_f16 v119, v191, v239
    v_mfma_f32_32x32x16_f16 v[48:63], v[84:87], v[112:115], v[48:63]
    v_sad_u32 v99, v99, v66, v67
    v_add3_u32 v99, v99, v68, v69
    v_sad_u32 v99, v99, v70, v71
    v_add3_u32 v99, v99, v72, v73
    v_add3_u32 v99, v99, v74, v75
    v_add3_u32 v99, v99, v76, v77
    v_smfmac_f32_16x16x64_f16 v[252:255], v[88:91], v[108:115], v1
    ds_read_b128 v[124:127], v11 offset:2048
    v_sad_u32 v99, v99, v78, v79
    v_mfma_f32_32x32x16_f16 v[64:79], v[80:83], v[116:119], v[32:47]
    v_pk_mul_f16 v120, v192, v240
    v_pk_mul_f16 v121, v193, v241
    v_pk_mul_f16 v122, v194, v242
    v_pk_mul_f16 v123, v195, v243
    v_pk_mul_f16 v108, v196, v236
    v_pk_mul_f16 v109, v197, v237
    v_mfma_f32_32x32x16_f16 v[64:79], v[84:87], v[120:123], v[64:79]
    v_permlane32_swap_b32_e64 v98, v99
    v_add3_u32 v16, v98, v99, v132
    v_pk_mul_f16 v110, v198, v238
    v_pk_mul_f16 v111, v199, v239
    v_pk_mul_f16 v112, v200, v240
    v_smfmac_f32_16x16x64_f16 v[252:255], v[92:95], v[116:123], v1
    ds_read_b128 v[220:223], v4 offset:512
    v_pk_mul_f16 v113, v201, v241
    v_pk_mul_f16 v114, v202, v242
    v_add_u32_e64 v98, v48, v49
    v_sad_u32 v98, v98, v50, v51
    v_add3_u32 v98, v98, v52, v53
    v_sad_u32 v98, v98, v54, v55
    v_add3_u32 v98, v98, v56, v57
    v_add3_u32 v98, v98, v58, v59
    v_add3_u32 v98, v98, v60, v61
    v_sad_u32 v98, v98, v62, v63
    s_setprio 0
    v_fmac_f32 v133, v16, v97
    v_add_u32 v99, v64, v65
    v_add_f32 v19, v19, v17
    v_fmac_f32_e64 v18, v17, v130
    v_fmac_f32 v18, v17, v131
    s_waitcnt lgkmcnt(1)
    v_pk_mul_f16 v115, v203, v243
    v_mfma_f32_32x32x16_f16 v[48:63], v[80:83], v[108:111], v[32:47]
    s_setprio 1
    v_exp_f32 v17, v133
    v_pk_mul_f16 v116, v204, v236
    v_pk_mul_f16 v117, v205, v237
    v_pk_mul_f16 v118, v206, v238
    v_pk_mul_f16 v119, v207, v239
    v_mfma_f32_32x32x16_f16 v[48:63], v[84:87], v[112:115], v[48:63]
    v_sad_u32 v99, v99, v66, v67
    v_add3_u32 v99, v99, v68, v69
    v_sad_u32 v99, v99, v70, v71
    v_add3_u32 v99, v99, v72, v73
    v_add3_u32 v99, v99, v74, v75
    v_add3_u32 v99, v99, v76, v77
    v_smfmac_f32_16x16x64_f16 v[124:127], v[88:91], v[108:115], v1
    ds_read_b128 v[128:131], v11 offset:2048
    v_sad_u32 v99, v99, v78, v79
    v_mfma_f32_32x32x16_f16 v[64:79], v[80:83], v[116:119], v[32:47]
    v_pk_mul_f16 v120, v208, v240
    v_pk_mul_f16 v121, v209, v241
    v_pk_mul_f16 v122, v210, v242
    v_pk_mul_f16 v123, v211, v243
    v_pk_mul_f16 v108, v212, v236
    v_pk_mul_f16 v109, v213, v237
    v_mfma_f32_32x32x16_f16 v[64:79], v[84:87], v[120:123], v[64:79]
    v_permlane32_swap_b32_e64 v98, v99
    v_add3_u32 v16, v98, v99, v252
    v_pk_mul_f16 v110, v214, v238
    v_pk_mul_f16 v111, v215, v239
    v_pk_mul_f16 v112, v216, v240
    v_smfmac_f32_16x16x64_f16 v[124:127], v[92:95], v[116:123], v1
    ds_read_b128 v[224:227], v4 offset:4672
    v_pk_mul_f16 v113, v217, v241
    v_pk_mul_f16 v114, v218, v242
    v_add_u32_e64 v98, v48, v49
    v_sad_u32 v98, v98, v50, v51
    v_add3_u32 v98, v98, v52, v53
    v_sad_u32 v98, v98, v54, v55
    v_add3_u32 v98, v98, v56, v57
    v_add3_u32 v98, v98, v58, v59
    v_add3_u32 v98, v98, v60, v61
    v_sad_u32 v98, v98, v62, v63
    s_setprio 0
    v_fmac_f32 v253, v16, v97
    v_add_u32 v99, v64, v65
    v_add_f32 v19, v19, v17
    v_fmac_f32_e64 v18, v17, v134
    v_fmac_f32 v18, v17, v135
    s_waitcnt lgkmcnt(1)
    v_pk_mul_f16 v115, v219, v243
    v_mfma_f32_32x32x16_f16 v[48:63], v[80:83], v[108:111], v[32:47]
    s_setprio 1
    v_exp_f32 v17, v253
    v_pk_mul_f16 v116, v180, v244
    v_pk_mul_f16 v117, v181, v245
    v_pk_mul_f16 v118, v182, v246
    v_pk_mul_f16 v119, v183, v247
    v_mfma_f32_32x32x16_f16 v[48:63], v[84:87], v[112:115], v[48:63]
    v_sad_u32 v99, v99, v66, v67
    v_add3_u32 v99, v99, v68, v69
    v_sad_u32 v99, v99, v70, v71
    v_add3_u32 v99, v99, v72, v73
    v_add3_u32 v99, v99, v74, v75
    v_add3_u32 v99, v99, v76, v77
    v_smfmac_f32_16x16x64_f16 v[128:131], v[88:91], v[108:115], v1
    ds_read_b128 v[132:135], v11 offset:2048
    v_sad_u32 v99, v99, v78, v79
    v_mfma_f32_32x32x16_f16 v[64:79], v[80:83], v[116:119], v[32:47]
    v_pk_mul_f16 v120, v184, v248
    v_pk_mul_f16 v121, v185, v249
    v_pk_mul_f16 v122, v186, v250
    v_pk_mul_f16 v123, v187, v251
    v_pk_mul_f16 v108, v196, v244
    v_pk_mul_f16 v109, v197, v245
    v_mfma_f32_32x32x16_f16 v[64:79], v[84:87], v[120:123], v[64:79]
    v_permlane32_swap_b32_e64 v98, v99
    v_add3_u32 v16, v98, v99, v124
    v_pk_mul_f16 v110, v198, v246
    v_pk_mul_f16 v111, v199, v247
    v_pk_mul_f16 v112, v200, v248
    v_smfmac_f32_16x16x64_f16 v[128:131], v[92:95], v[116:123], v1
    v_pk_mul_f16 v113, v201, v249
    v_pk_mul_f16 v114, v202, v250
    v_add_u32_e64 v98, v48, v49
    v_sad_u32 v98, v98, v50, v51
    v_add3_u32 v98, v98, v52, v53
    v_sad_u32 v98, v98, v54, v55
    v_add3_u32 v98, v98, v56, v57
    v_add3_u32 v98, v98, v58, v59
    v_add3_u32 v98, v98, v60, v61
    v_sad_u32 v98, v98, v62, v63
    s_setprio 0
    v_fmac_f32 v125, v16, v97
    v_add_u32 v99, v64, v65
    v_add_f32 v19, v19, v17
    v_fmac_f32_e64 v18, v17, v254
    v_fmac_f32 v18, v17, v255
    s_waitcnt lgkmcnt(0)
    v_pk_mul_f16 v115, v203, v251
    v_mfma_f32_32x32x16_f16 v[48:63], v[80:83], v[108:111], v[32:47]
    s_setprio 1
    v_exp_f32 v17, v125
    v_pk_mul_f16 v116, v236, v244
    v_pk_mul_f16 v117, v237, v245
    v_pk_mul_f16 v118, v238, v246
    v_pk_mul_f16 v119, v239, v247
    v_mfma_f32_32x32x16_f16 v[48:63], v[84:87], v[112:115], v[48:63]
    v_sad_u32 v99, v99, v66, v67
    v_add3_u32 v99, v99, v68, v69
    v_sad_u32 v99, v99, v70, v71
    v_add3_u32 v99, v99, v72, v73
    v_add3_u32 v99, v99, v74, v75
    v_add3_u32 v99, v99, v76, v77
    v_smfmac_f32_16x16x64_f16 v[132:135], v[88:91], v[108:115], v1
    ds_read_b128 v[252:255], v11 offset:2048
    v_sad_u32 v99, v99, v78, v79
    v_mfma_f32_32x32x16_f16 v[64:79], v[80:83], v[116:119], v[32:47]
    v_pk_mul_f16 v120, v240, v248
    v_pk_mul_f16 v121, v241, v249
    v_pk_mul_f16 v122, v242, v250
    v_pk_mul_f16 v123, v243, v251
    v_pk_mul_f16 v108, v180, v220
    v_pk_mul_f16 v109, v181, v221
    v_mfma_f32_32x32x16_f16 v[64:79], v[84:87], v[120:123], v[64:79]
    v_permlane32_swap_b32_e64 v98, v99
    v_add3_u32 v16, v98, v99, v128
    v_pk_mul_f16 v110, v182, v222
    v_pk_mul_f16 v111, v183, v223
    v_pk_mul_f16 v112, v184, v224
    v_smfmac_f32_16x16x64_f16 v[132:135], v[92:95], v[116:123], v1
    v_pk_mul_f16 v113, v185, v225
    v_pk_mul_f16 v114, v186, v226
    v_add_u32_e64 v98, v48, v49
    v_sad_u32 v98, v98, v50, v51
    v_add3_u32 v98, v98, v52, v53
    v_sad_u32 v98, v98, v54, v55
    v_add3_u32 v98, v98, v56, v57
    v_add3_u32 v98, v98, v58, v59
    v_add3_u32 v98, v98, v60, v61
    v_sad_u32 v98, v98, v62, v63
    s_setprio 0
    v_fmac_f32 v129, v16, v97
    v_add_u32 v99, v64, v65
    v_add_f32 v19, v19, v17
    v_fmac_f32_e64 v18, v17, v126
    v_fmac_f32 v18, v17, v127
    s_waitcnt lgkmcnt(0)
    v_pk_mul_f16 v115, v187, v227
    v_mfma_f32_32x32x16_f16 v[48:63], v[80:83], v[108:111], v[32:47]
    s_setprio 1
    v_exp_f32 v17, v129
    v_pk_mul_f16 v116, v188, v220
    v_pk_mul_f16 v117, v189, v221
    v_pk_mul_f16 v118, v190, v222
    v_pk_mul_f16 v119, v191, v223
    v_mfma_f32_32x32x16_f16 v[48:63], v[84:87], v[112:115], v[48:63]
    v_sad_u32 v99, v99, v66, v67
    v_add3_u32 v99, v99, v68, v69
    v_sad_u32 v99, v99, v70, v71
    v_add3_u32 v99, v99, v72, v73
    v_add3_u32 v99, v99, v74, v75
    v_add3_u32 v99, v99, v76, v77
    v_smfmac_f32_16x16x64_f16 v[252:255], v[88:91], v[108:115], v1
    s_waitcnt vmcnt(0)
    s_nop 0
    v_sad_u32 v99, v99, v78, v79
    v_pk_mul_f16 v120, v192, v224
    v_pk_mul_f16 v121, v193, v225
    v_pk_mul_f16 v122, v194, v226
    v_mfma_f32_4x4x4_16b_bf16 v[164:167], v[100:101], v[156:157], 0
    v_pk_mul_f16 v123, v195, v227
    v_mfma_f32_4x4x4_16b_bf16 v[168:171], v[100:101], v[158:159], 0
    v_pk_mul_f16 v108, v236, v220
    v_mfma_f32_4x4x4_16b_bf16 v[172:175], v[100:101], v[160:161], 0
    v_pk_mul_f16 v109, v237, v221
    v_mfma_f32_4x4x4_16b_bf16 v[176:179], v[100:101], v[162:163], 0
    v_permlane32_swap_b32_e64 v98, v99
    v_mfma_f32_32x32x16_f16 v[64:79], v[80:83], v[116:119], v[32:47]
    ds_read_b128 v[124:127], v11 offset:2048
    v_add3_u32 v16, v98, v99, v132
    v_cvt_pk_f16_f32 v156, v164, v165
    v_cvt_pk_f16_f32 v157, v166, v167
    v_cvt_pk_f16_f32 v158, v168, v169
    v_cvt_pk_f16_f32 v159, v170, v171
    v_cvt_pk_f16_f32 v160, v172, v173
    v_mfma_f32_32x32x16_f16 v[64:79], v[84:87], v[120:123], v[64:79]
    v_cvt_pk_f16_f32 v161, v174, v175
    v_cvt_pk_f16_f32 v162, v176, v177
    v_cvt_pk_f16_f32 v163, v178, v179
    v_pk_mul_f16 v110, v238, v222
    v_pk_mul_f16 v111, v239, v223
    v_pk_mul_f16 v112, v240, v224
    v_smfmac_f32_16x16x64_f16 v[252:255], v[92:95], v[116:123], v1
    v_pk_mul_f16 v113, v241, v225
    v_pk_mul_f16 v114, v242, v226
    v_add_u32_e64 v98, v48, v49
    v_sad_u32 v98, v98, v50, v51
    v_add3_u32 v98, v98, v52, v53
    v_sad_u32 v98, v98, v54, v55
    v_add3_u32 v98, v98, v56, v57
    v_add3_u32 v98, v98, v58, v59
    v_add3_u32 v98, v98, v60, v61
    v_sad_u32 v98, v98, v62, v63
    s_setprio 0
    s_nop 0
    ds_write_b128 v13, v[156:159] offset:1024
    ds_write_b128 v13, v[160:163] offset:1088
    ds_read_b128 v[228:231], v2 offset:1024
    ds_read_b128 v[232:235], v2 offset:5184
    v_fmac_f32 v133, v16, v97
    v_add_u32 v99, v64, v65
    v_add_f32 v19, v19, v17
    v_fmac_f32 v18, v17, v130
    v_fmac_f32 v18, v17, v131
    s_waitcnt lgkmcnt(4)
    v_pk_mul_f16 v115, v243, v227
    v_mfma_f32_32x32x16_f16 v[48:63], v[80:83], v[108:111], v[32:47]
    s_setprio 1
    v_exp_f32 v17, v133
    v_pk_mul_f16 v116, v244, v220
    v_pk_mul_f16 v117, v245, v221
    v_pk_mul_f16 v118, v246, v222
    v_pk_mul_f16 v119, v247, v223
    v_mfma_f32_32x32x16_f16 v[48:63], v[84:87], v[112:115], v[48:63]
    v_sad_u32 v99, v99, v66, v67
    v_add3_u32 v99, v99, v68, v69
    v_sad_u32 v99, v99, v70, v71
    v_add3_u32 v99, v99, v72, v73
    v_add3_u32 v99, v99, v74, v75
    v_add3_u32 v99, v99, v76, v77
    v_smfmac_f32_16x16x64_f16 v[124:127], v[88:91], v[108:115], v1
    ds_read_b128 v[128:131], v11 offset:2048
    v_sad_u32 v99, v99, v78, v79
    v_mfma_f32_32x32x16_f16 v[64:79], v[80:83], v[116:119], v[32:47]
    s_waitcnt lgkmcnt(1)
    s_nop 0
    v_pk_mul_f16 v120, v248, v224
    v_pk_mul_f16 v121, v249, v225
    v_pk_mul_f16 v122, v250, v226
    v_pk_mul_f16 v123, v251, v227
    v_pk_mul_f16 v108, v204, v228
    v_pk_mul_f16 v109, v205, v229
    v_mfma_f32_32x32x16_f16 v[64:79], v[84:87], v[120:123], v[64:79]
    v_permlane32_swap_b32_e64 v98, v99
    v_add3_u32 v16, v98, v99, v252
    v_pk_mul_f16 v110, v206, v230
    v_pk_mul_f16 v111, v207, v231
    v_pk_mul_f16 v112, v208, v232
    v_smfmac_f32_16x16x64_f16 v[124:127], v[92:95], v[116:123], v1
    v_pk_mul_f16 v113, v209, v233
    v_pk_mul_f16 v114, v210, v234
    v_add_u32_e64 v98, v48, v49
    v_sad_u32 v98, v98, v50, v51
    v_add3_u32 v98, v98, v52, v53
    v_sad_u32 v98, v98, v54, v55
    v_add3_u32 v98, v98, v56, v57
    v_add3_u32 v98, v98, v58, v59
    v_add3_u32 v98, v98, v60, v61
    v_sad_u32 v98, v98, v62, v63
    s_setprio 0
    v_fmac_f32 v253, v16, v97
    v_add_u32 v99, v64, v65
    v_add_f32 v19, v19, v17
    v_fmac_f32_e64 v18, v17, v134
    v_fmac_f32 v18, v17, v135
    s_waitcnt lgkmcnt(0)
    v_pk_mul_f16 v115, v211, v235
    v_mfma_f32_32x32x16_f16 v[48:63], v[80:83], v[108:111], v[32:47]
    s_setprio 1
    v_exp_f32 v17, v253
    v_pk_mul_f16 v116, v212, v228
    v_pk_mul_f16 v117, v213, v229
    v_pk_mul_f16 v118, v214, v230
    v_pk_mul_f16 v119, v215, v231
    v_mfma_f32_32x32x16_f16 v[48:63], v[84:87], v[112:115], v[48:63]
    v_sad_u32 v99, v99, v66, v67
    v_add3_u32 v99, v99, v68, v69
    v_sad_u32 v99, v99, v70, v71
    v_add3_u32 v99, v99, v72, v73
    v_add3_u32 v99, v99, v74, v75
    v_add3_u32 v99, v99, v76, v77
    v_smfmac_f32_16x16x64_f16 v[128:131], v[88:91], v[108:115], v1
    ds_read_b128 v[132:135], v11 offset:2048
    v_sad_u32 v99, v99, v78, v79
    v_mfma_f32_32x32x16_f16 v[64:79], v[80:83], v[116:119], v[32:47]
    v_pk_mul_f16 v120, v216, v232
    v_pk_mul_f16 v121, v217, v233
    v_pk_mul_f16 v122, v218, v234
    v_pk_mul_f16 v123, v219, v235
    v_pk_mul_f16 v108, v188, v228
    v_pk_mul_f16 v109, v189, v229
    v_mfma_f32_32x32x16_f16 v[64:79], v[84:87], v[120:123], v[64:79]
    v_permlane32_swap_b32_e64 v98, v99
    v_add3_u32 v16, v98, v99, v124
    v_pk_mul_f16 v110, v190, v230
    v_pk_mul_f16 v111, v191, v231
    v_pk_mul_f16 v112, v192, v232
    v_smfmac_f32_16x16x64_f16 v[128:131], v[92:95], v[116:123], v1
    ds_read_b128 v[204:207], v4 offset:1024
    v_pk_mul_f16 v113, v193, v233
    v_pk_mul_f16 v114, v194, v234
    v_add_u32_e64 v98, v48, v49
    v_sad_u32 v98, v98, v50, v51
    v_add3_u32 v98, v98, v52, v53
    v_sad_u32 v98, v98, v54, v55
    v_add3_u32 v98, v98, v56, v57
    v_add3_u32 v98, v98, v58, v59
    v_add3_u32 v98, v98, v60, v61
    v_sad_u32 v98, v98, v62, v63
    s_setprio 0
    s_nop 0
    global_load_dwordx4 v[24:27], v23, s[4:5] offset:3328
    global_load_dword v30, v31, s[4:5] offset:3424
    global_load_dwordx2 v[28:29], v23, s[4:5] offset:3344
    v_fmac_f32 v125, v16, v97
    v_add_u32 v99, v64, v65
    v_add_f32 v19, v19, v17
    v_fmac_f32 v18, v17, v254
    v_fmac_f32 v18, v17, v255
    s_waitcnt lgkmcnt(1)
    v_pk_mul_f16 v115, v195, v235
    v_mfma_f32_32x32x16_f16 v[48:63], v[80:83], v[108:111], v[32:47]
    s_setprio 1
    v_exp_f32 v17, v125
    v_pk_mul_f16 v116, v244, v228
    v_pk_mul_f16 v117, v245, v229
    v_pk_mul_f16 v118, v246, v230
    v_pk_mul_f16 v119, v247, v231
    v_mfma_f32_32x32x16_f16 v[48:63], v[84:87], v[112:115], v[48:63]
    v_sad_u32 v99, v99, v66, v67
    v_add3_u32 v99, v99, v68, v69
    v_sad_u32 v99, v99, v70, v71
    v_add3_u32 v99, v99, v72, v73
    v_add3_u32 v99, v99, v74, v75
    v_add3_u32 v99, v99, v76, v77
    v_smfmac_f32_16x16x64_f16 v[132:135], v[88:91], v[108:115], v1
    ds_read_b128 v[252:255], v11 offset:2048
    v_sad_u32 v99, v99, v78, v79
    v_mfma_f32_32x32x16_f16 v[64:79], v[80:83], v[116:119], v[32:47]
    v_pk_mul_f16 v120, v248, v232
    v_pk_mul_f16 v121, v249, v233
    v_pk_mul_f16 v122, v250, v234
    v_pk_mul_f16 v123, v251, v235
    v_pk_mul_f16 v108, v180, v228
    v_pk_mul_f16 v109, v181, v229
    v_mfma_f32_32x32x16_f16 v[64:79], v[84:87], v[120:123], v[64:79]
    v_permlane32_swap_b32_e64 v98, v99
    v_add3_u32 v16, v98, v99, v128
    v_pk_mul_f16 v110, v182, v230
    v_pk_mul_f16 v111, v183, v231
    v_pk_mul_f16 v112, v184, v232
    v_smfmac_f32_16x16x64_f16 v[132:135], v[92:95], v[116:123], v1
    ds_read_b128 v[208:211], v4 offset:5184
    v_pk_mul_f16 v113, v185, v233
    v_pk_mul_f16 v114, v186, v234
    v_add_u32_e64 v98, v48, v49
    v_sad_u32 v98, v98, v50, v51
    v_add3_u32 v98, v98, v52, v53
    v_sad_u32 v98, v98, v54, v55
    v_add3_u32 v98, v98, v56, v57
    v_add3_u32 v98, v98, v58, v59
    v_add3_u32 v98, v98, v60, v61
    v_sad_u32 v98, v98, v62, v63
    s_setprio 0
    v_fmac_f32 v129, v16, v97
    v_add_u32 v99, v64, v65
    v_add_f32 v19, v19, v17
    v_fmac_f32_e64 v18, v17, v126
    v_fmac_f32 v18, v17, v127
    s_waitcnt lgkmcnt(1)
    v_pk_mul_f16 v115, v187, v235
    v_mfma_f32_32x32x16_f16 v[48:63], v[80:83], v[108:111], v[32:47]
    s_setprio 1
    v_exp_f32 v17, v129
    v_pk_mul_f16 v116, v236, v228
    v_pk_mul_f16 v117, v237, v229
    v_pk_mul_f16 v118, v238, v230
    v_pk_mul_f16 v119, v239, v231
    v_mfma_f32_32x32x16_f16 v[48:63], v[84:87], v[112:115], v[48:63]
    v_sad_u32 v99, v99, v66, v67
    v_add3_u32 v99, v99, v68, v69
    v_sad_u32 v99, v99, v70, v71
    v_add3_u32 v99, v99, v72, v73
    v_add3_u32 v99, v99, v74, v75
    v_add3_u32 v99, v99, v76, v77
    v_smfmac_f32_16x16x64_f16 v[252:255], v[88:91], v[108:115], v1
    ds_read_b128 v[124:127], v11 offset:2048
    v_sad_u32 v99, v99, v78, v79
    v_mfma_f32_32x32x16_f16 v[64:79], v[80:83], v[116:119], v[32:47]
    v_pk_mul_f16 v120, v240, v232
    v_pk_mul_f16 v121, v241, v233
    v_pk_mul_f16 v122, v242, v234
    v_pk_mul_f16 v123, v243, v235
    v_pk_mul_f16 v108, v196, v228
    v_pk_mul_f16 v109, v197, v229
    v_mfma_f32_32x32x16_f16 v[64:79], v[84:87], v[120:123], v[64:79]
    v_permlane32_swap_b32_e64 v98, v99
    v_add3_u32 v16, v98, v99, v132
    v_pk_mul_f16 v110, v198, v230
    v_pk_mul_f16 v111, v199, v231
    v_pk_mul_f16 v112, v200, v232
    v_smfmac_f32_16x16x64_f16 v[252:255], v[92:95], v[116:123], v1
    ds_read_b128 v[212:215], v5 offset:0
    v_pk_mul_f16 v113, v201, v233
    v_pk_mul_f16 v114, v202, v234
    v_add_u32_e64 v98, v48, v49
    v_sad_u32 v98, v98, v50, v51
    v_add3_u32 v98, v98, v52, v53
    v_sad_u32 v98, v98, v54, v55
    v_add3_u32 v98, v98, v56, v57
    v_add3_u32 v98, v98, v58, v59
    v_add3_u32 v98, v98, v60, v61
    v_sad_u32 v98, v98, v62, v63
    s_setprio 0
    s_waitcnt vmcnt(0)
    v_fmac_f32 v133, v16, v97
    v_add_u32 v99, v64, v65
    v_add_f32 v19, v19, v17
    v_fmac_f32 v18, v17, v130
    v_fmac_f32 v18, v17, v131
    s_waitcnt lgkmcnt(1)
    v_pk_mul_f16 v115, v203, v235
    v_mfma_f32_32x32x16_f16 v[48:63], v[80:83], v[108:111], v[32:47]
    s_setprio 1
    v_exp_f32 v17, v133
    v_pk_mul_f16 v116, v220, v228
    v_pk_mul_f16 v117, v221, v229
    v_pk_mul_f16 v118, v222, v230
    v_pk_mul_f16 v119, v223, v231
    v_mfma_f32_32x32x16_f16 v[48:63], v[84:87], v[112:115], v[48:63]
    v_sad_u32 v99, v99, v66, v67
    v_add3_u32 v99, v99, v68, v69
    v_sad_u32 v99, v99, v70, v71
    v_add3_u32 v99, v99, v72, v73
    v_add3_u32 v99, v99, v74, v75
    v_add3_u32 v99, v99, v76, v77
    v_smfmac_f32_16x16x64_f16 v[124:127], v[88:91], v[108:115], v1
    ds_read_b128 v[128:131], v11 offset:2048
    v_sad_u32 v99, v99, v78, v79
    v_mfma_f32_32x32x16_f16 v[64:79], v[80:83], v[116:119], v[32:47]
    v_pk_mul_f16 v120, v224, v232
    v_pk_mul_f16 v121, v225, v233
    v_pk_mul_f16 v122, v226, v234
    v_pk_mul_f16 v123, v227, v235
    v_pk_mul_f16 v108, v188, v204
    v_pk_mul_f16 v109, v189, v205
    v_mfma_f32_32x32x16_f16 v[64:79], v[84:87], v[120:123], v[64:79]
    v_permlane32_swap_b32_e64 v98, v99
    v_add3_u32 v16, v98, v99, v252
    v_pk_mul_f16 v110, v190, v206
    v_pk_mul_f16 v111, v191, v207
    v_pk_mul_f16 v112, v192, v208
    v_smfmac_f32_16x16x64_f16 v[124:127], v[92:95], v[116:123], v1
    ds_read_b128 v[216:219], v5 offset:4160
    v_pk_mul_f16 v113, v193, v209
    v_pk_mul_f16 v114, v194, v210
    v_lshl_add_u32 v24, v24, 6, v20
    v_lshl_add_u32 v25, v25, 6, v20
    v_lshl_add_u32 v26, v26, 6, v20
    v_lshl_add_u32 v27, v27, 6, v20
    v_lshl_add_u32 v28, v28, 6, v20
    v_lshl_add_u32 v29, v29, 6, v20
    v_lshl_add_u32 v30, v30, 6, v20
    v_add_u32_e64 v98, v48, v49
    v_sad_u32 v98, v98, v50, v51
    v_add3_u32 v98, v98, v52, v53
    v_sad_u32 v98, v98, v54, v55
    v_add3_u32 v98, v98, v56, v57
    v_add3_u32 v98, v98, v58, v59
    v_add3_u32 v98, v98, v60, v61
    v_sad_u32 v98, v98, v62, v63
    s_setprio 0
    s_nop 0
    buffer_load_dwordx4 v[136:139], v24, s[20:23], 0 offen
    buffer_load_dwordx4 v[140:143], v25, s[20:23], 0 offen
    buffer_load_dwordx4 v[144:147], v30, s[20:23], 0 offen
    buffer_load_dwordx4 v[148:151], v26, s[20:23], 0 offen
    buffer_load_dwordx4 v[152:155], v27, s[20:23], 0 offen
    buffer_load_dwordx4 v[156:159], v28, s[20:23], 0 offen
    buffer_load_dwordx4 v[160:163], v29, s[20:23], 0 offen
    v_fmac_f32 v253, v16, v97
    v_add_u32 v99, v64, v65
    v_add_f32 v19, v19, v17
    v_fmac_f32 v18, v17, v134
    v_fmac_f32 v18, v17, v135
    s_waitcnt lgkmcnt(1)
    v_pk_mul_f16 v115, v195, v211
    v_mfma_f32_32x32x16_f16 v[48:63], v[80:83], v[108:111], v[32:47]
    s_setprio 1
    v_exp_f32 v17, v253
    v_pk_mul_f16 v116, v244, v204
    v_pk_mul_f16 v117, v245, v205
    v_pk_mul_f16 v118, v246, v206
    v_pk_mul_f16 v119, v247, v207
    v_mfma_f32_32x32x16_f16 v[48:63], v[84:87], v[112:115], v[48:63]
    v_sad_u32 v99, v99, v66, v67
    v_add3_u32 v99, v99, v68, v69
    v_sad_u32 v99, v99, v70, v71
    v_add3_u32 v99, v99, v72, v73
    v_add3_u32 v99, v99, v74, v75
    v_add3_u32 v99, v99, v76, v77
    v_smfmac_f32_16x16x64_f16 v[128:131], v[88:91], v[108:115], v1
    ds_read_b128 v[132:135], v11 offset:2048
    v_sad_u32 v99, v99, v78, v79
    v_mfma_f32_32x32x16_f16 v[64:79], v[80:83], v[116:119], v[32:47]
    v_pk_mul_f16 v120, v248, v208
    v_pk_mul_f16 v121, v249, v209
    v_pk_mul_f16 v122, v250, v210
    v_pk_mul_f16 v123, v251, v211
    v_pk_mul_f16 v108, v180, v204
    v_pk_mul_f16 v109, v181, v205
    v_mfma_f32_32x32x16_f16 v[64:79], v[84:87], v[120:123], v[64:79]
    v_permlane32_swap_b32_e64 v98, v99
    v_add3_u32 v16, v98, v99, v124
    v_pk_mul_f16 v110, v182, v206
    v_pk_mul_f16 v111, v183, v207
    v_pk_mul_f16 v112, v184, v208
    v_smfmac_f32_16x16x64_f16 v[128:131], v[92:95], v[116:123], v1
    ds_read_b128 v[188:191], v3 offset:1024
    v_pk_mul_f16 v113, v185, v209
    v_pk_mul_f16 v114, v186, v210
    v_bfe_u32 v23, v0, 6, 3
    v_bfe_u32 v31, v0, 3, 2
    v_lshl_add_u32 v23, v23, 2, v31
    v_and_or_b32 v31, v0, 32, s39
    v_add_lshl_u32 v23, v23, v31, 1
    v_add_u32_e64 v98, v48, v49
    v_sad_u32 v98, v98, v50, v51
    v_add3_u32 v98, v98, v52, v53
    v_sad_u32 v98, v98, v54, v55
    v_add3_u32 v98, v98, v56, v57
    v_add3_u32 v98, v98, v58, v59
    v_add3_u32 v98, v98, v60, v61
    v_sad_u32 v98, v98, v62, v63
    s_setprio 0
    v_fmac_f32 v125, v16, v97
    v_add_u32 v99, v64, v65
    v_add_f32 v19, v19, v17
    v_fmac_f32_e64 v18, v17, v254
    v_fmac_f32 v18, v17, v255
    s_waitcnt lgkmcnt(1)
    v_pk_mul_f16 v115, v187, v211
    v_mfma_f32_32x32x16_f16 v[48:63], v[80:83], v[108:111], v[32:47]
    s_setprio 1
    v_exp_f32 v17, v125
    v_pk_mul_f16 v116, v236, v204
    v_pk_mul_f16 v117, v237, v205
    v_pk_mul_f16 v118, v238, v206
    v_pk_mul_f16 v119, v239, v207
    v_mfma_f32_32x32x16_f16 v[48:63], v[84:87], v[112:115], v[48:63]
    v_sad_u32 v99, v99, v66, v67
    v_add3_u32 v99, v99, v68, v69
    v_sad_u32 v99, v99, v70, v71
    v_add3_u32 v99, v99, v72, v73
    v_add3_u32 v99, v99, v74, v75
    v_add3_u32 v99, v99, v76, v77
    v_smfmac_f32_16x16x64_f16 v[132:135], v[88:91], v[108:115], v1
    ds_read_b128 v[252:255], v11 offset:2048
    v_sad_u32 v99, v99, v78, v79
    v_mfma_f32_32x32x16_f16 v[64:79], v[80:83], v[116:119], v[32:47]
    v_pk_mul_f16 v120, v240, v208
    v_pk_mul_f16 v121, v241, v209
    v_pk_mul_f16 v122, v242, v210
    v_pk_mul_f16 v123, v243, v211
    v_pk_mul_f16 v108, v228, v204
    v_pk_mul_f16 v109, v229, v205
    v_mfma_f32_32x32x16_f16 v[64:79], v[84:87], v[120:123], v[64:79]
    v_permlane32_swap_b32_e64 v98, v99
    v_add3_u32 v16, v98, v99, v128
    v_pk_mul_f16 v110, v230, v206
    v_pk_mul_f16 v111, v231, v207
    v_pk_mul_f16 v112, v232, v208
    v_smfmac_f32_16x16x64_f16 v[132:135], v[92:95], v[116:123], v1
    ds_read_b128 v[192:195], v3 offset:5184
    v_pk_mul_f16 v113, v233, v209
    v_pk_mul_f16 v114, v234, v210
    v_add_u32_e64 v98, v48, v49
    v_sad_u32 v98, v98, v50, v51
    v_add3_u32 v98, v98, v52, v53
    v_sad_u32 v98, v98, v54, v55
    v_add3_u32 v98, v98, v56, v57
    v_add3_u32 v98, v98, v58, v59
    v_add3_u32 v98, v98, v60, v61
    v_sad_u32 v98, v98, v62, v63
    s_setprio 0
    v_fmac_f32 v129, v16, v97
    v_add_u32 v99, v64, v65
    v_add_f32 v19, v19, v17
    v_fmac_f32_e64 v18, v17, v126
    v_fmac_f32 v18, v17, v127
    s_waitcnt lgkmcnt(1)
    v_pk_mul_f16 v115, v235, v211
    v_mfma_f32_32x32x16_f16 v[48:63], v[80:83], v[108:111], v[32:47]
    s_setprio 1
    v_exp_f32 v17, v129
    v_pk_mul_f16 v116, v212, v228
    v_pk_mul_f16 v117, v213, v229
    v_pk_mul_f16 v118, v214, v230
    v_pk_mul_f16 v119, v215, v231
    v_mfma_f32_32x32x16_f16 v[48:63], v[84:87], v[112:115], v[48:63]
    v_sad_u32 v99, v99, v66, v67
    v_add3_u32 v99, v99, v68, v69
    v_sad_u32 v99, v99, v70, v71
    v_add3_u32 v99, v99, v72, v73
    v_add3_u32 v99, v99, v74, v75
    v_add3_u32 v99, v99, v76, v77
    v_smfmac_f32_16x16x64_f16 v[252:255], v[88:91], v[108:115], v1
    ds_read_b128 v[124:127], v11 offset:2048
    v_sad_u32 v99, v99, v78, v79
    v_mfma_f32_32x32x16_f16 v[64:79], v[80:83], v[116:119], v[32:47]
    v_pk_mul_f16 v120, v216, v232
    v_pk_mul_f16 v121, v217, v233
    v_pk_mul_f16 v122, v218, v234
    v_pk_mul_f16 v123, v219, v235
    v_pk_mul_f16 v108, v212, v236
    v_pk_mul_f16 v109, v213, v237
    v_mfma_f32_32x32x16_f16 v[64:79], v[84:87], v[120:123], v[64:79]
    v_permlane32_swap_b32_e64 v98, v99
    v_add3_u32 v16, v98, v99, v132
    v_pk_mul_f16 v110, v214, v238
    v_pk_mul_f16 v111, v215, v239
    v_pk_mul_f16 v112, v216, v240
    v_smfmac_f32_16x16x64_f16 v[252:255], v[92:95], v[116:123], v1
    ds_read_b128 v[244:247], v6 offset:512
    v_pk_mul_f16 v113, v217, v241
    v_pk_mul_f16 v114, v218, v242
    v_add_u32_e64 v98, v48, v49
    v_sad_u32 v98, v98, v50, v51
    v_add3_u32 v98, v98, v52, v53
    v_sad_u32 v98, v98, v54, v55
    v_add3_u32 v98, v98, v56, v57
    v_add3_u32 v98, v98, v58, v59
    v_add3_u32 v98, v98, v60, v61
    v_sad_u32 v98, v98, v62, v63
    s_setprio 0
    s_waitcnt vmcnt(0)
    v_fmac_f32 v133, v16, v97
    v_add_u32 v99, v64, v65
    v_add_f32 v19, v19, v17
    v_fmac_f32 v18, v17, v130
    v_fmac_f32 v18, v17, v131
    s_waitcnt lgkmcnt(1)
    v_pk_mul_f16 v115, v219, v243
    v_mfma_f32_32x32x16_f16 v[48:63], v[80:83], v[108:111], v[32:47]
    s_setprio 1
    v_exp_f32 v17, v133
    v_pk_mul_f16 v116, v188, v204
    v_pk_mul_f16 v117, v189, v205
    v_pk_mul_f16 v118, v190, v206
    v_pk_mul_f16 v119, v191, v207
    v_mfma_f32_32x32x16_f16 v[48:63], v[84:87], v[112:115], v[48:63]
    v_sad_u32 v99, v99, v66, v67
    v_add3_u32 v99, v99, v68, v69
    v_sad_u32 v99, v99, v70, v71
    v_add3_u32 v99, v99, v72, v73
    v_add3_u32 v99, v99, v74, v75
    v_add3_u32 v99, v99, v76, v77
    v_smfmac_f32_16x16x64_f16 v[124:127], v[88:91], v[108:115], v1
    ds_read_b128 v[128:131], v11 offset:2048
    v_sad_u32 v99, v99, v78, v79
    v_pk_mul_f16 v120, v192, v208
    v_pk_mul_f16 v121, v193, v209
    v_pk_mul_f16 v122, v194, v210
    v_mfma_f32_4x4x4_16b_bf16 v[164:167], v[100:101], v[136:137], 0
    v_pk_mul_f16 v123, v195, v211
    v_mfma_f32_4x4x4_16b_bf16 v[168:171], v[100:101], v[138:139], 0
    v_pk_mul_f16 v108, v196, v188
    v_mfma_f32_32x32x16_f16 v[64:79], v[80:83], v[116:119], v[32:47]
    v_pk_mul_f16 v109, v197, v189
    v_permlane32_swap_b32_e64 v98, v99
    v_add3_u32 v16, v98, v99, v252
    v_cvt_pk_f16_f32 v136, v164, v165
    v_cvt_pk_f16_f32 v137, v166, v167
    v_mfma_f32_32x32x16_f16 v[64:79], v[84:87], v[120:123], v[64:79]
    v_cvt_pk_f16_f32 v138, v168, v169
    v_cvt_pk_f16_f32 v139, v170, v171
    v_cmp_le_f32_e64 vcc, s19, |v164|
    v_pk_mul_f16 v110, v198, v190
    v_pk_mul_f16 v111, v199, v191
    v_pk_mul_f16 v112, v200, v192
    v_smfmac_f32_16x16x64_f16 v[124:127], v[92:95], v[116:123], v1
    ds_read_b128 v[248:251], v6 offset:4672
    v_pk_mul_f16 v113, v201, v193
    v_pk_mul_f16 v114, v202, v194
    v_add_u32_e64 v98, v48, v49
    v_sad_u32 v98, v98, v50, v51
    v_add3_u32 v98, v98, v52, v53
    v_sad_u32 v98, v98, v54, v55
    v_add3_u32 v98, v98, v56, v57
    v_add3_u32 v98, v98, v58, v59
    v_add3_u32 v98, v98, v60, v61
    v_sad_u32 v98, v98, v62, v63
    s_setprio 0
    s_nop 0
    ds_write_b128 v13, v[136:139] offset:8320
    s_and_b32 s18, vcc_lo, 0xffff
    s_cselect_b32 s34, s34, 1
    s_lshr_b32 s18, vcc_lo, 16
    s_cselect_b32 s34, s34, 1
    s_nop 0
    s_and_b32 s18, vcc_hi, 0xffff
    s_cselect_b32 s34, s34, 1
    s_lshr_b32 s18, vcc_hi, 16
    s_cselect_b32 s34, s34, 1
    v_fmac_f32 v253, v16, v97
    v_add_u32 v99, v64, v65
    v_add_f32 v19, v19, v17
    v_fmac_f32_e64 v18, v17, v134
    v_fmac_f32 v18, v17, v135
    s_waitcnt lgkmcnt(2)
    v_pk_mul_f16 v115, v203, v195
    v_mfma_f32_32x32x16_f16 v[48:63], v[80:83], v[108:111], v[32:47]
    s_setprio 1
    v_exp_f32 v17, v253
    v_pk_mul_f16 v116, v220, v188
    v_pk_mul_f16 v117, v221, v189
    v_pk_mul_f16 v118, v222, v190
    v_pk_mul_f16 v119, v223, v191
    v_mfma_f32_32x32x16_f16 v[48:63], v[84:87], v[112:115], v[48:63]
    v_sad_u32 v99, v99, v66, v67
    v_add3_u32 v99, v99, v68, v69
    v_sad_u32 v99, v99, v70, v71
    v_add3_u32 v99, v99, v72, v73
    v_add3_u32 v99, v99, v74, v75
    v_add3_u32 v99, v99, v76, v77
    v_smfmac_f32_16x16x64_f16 v[128:131], v[88:91], v[108:115], v1
    ds_read_b128 v[132:135], v11 offset:2048
    v_sad_u32 v99, v99, v78, v79
    v_pk_mul_f16 v120, v224, v192
    v_pk_mul_f16 v121, v225, v193
    v_pk_mul_f16 v122, v226, v194
    v_mfma_f32_4x4x4_16b_bf16 v[164:167], v[100:101], v[140:141], 0
    v_pk_mul_f16 v123, v227, v195
    v_mfma_f32_4x4x4_16b_bf16 v[168:171], v[100:101], v[142:143], 0
    v_pk_mul_f16 v108, v180, v188
    v_mfma_f32_32x32x16_f16 v[64:79], v[80:83], v[116:119], v[32:47]
    v_pk_mul_f16 v109, v181, v189
    v_permlane32_swap_b32_e64 v98, v99
    v_add3_u32 v16, v98, v99, v124
    v_cvt_pk_f16_f32 v140, v164, v165
    v_cvt_pk_f16_f32 v141, v166, v167
    v_mfma_f32_32x32x16_f16 v[64:79], v[84:87], v[120:123], v[64:79]
    v_cvt_pk_f16_f32 v142, v168, v169
    v_cvt_pk_f16_f32 v143, v170, v171
    v_pk_mul_f16 v110, v182, v190
    v_pk_mul_f16 v111, v183, v191
    v_pk_mul_f16 v112, v184, v192
    v_pk_mul_f16 v113, v185, v193
    v_smfmac_f32_16x16x64_f16 v[128:131], v[92:95], v[116:123], v1
    ds_read_b128 v[212:215], v7 offset:1024
    v_pk_mul_f16 v114, v186, v194
    v_add_u32_e64 v98, v48, v49
    v_sad_u32 v98, v98, v50, v51
    v_add3_u32 v98, v98, v52, v53
    v_sad_u32 v98, v98, v54, v55
    v_add3_u32 v98, v98, v56, v57
    v_add3_u32 v98, v98, v58, v59
    v_add3_u32 v98, v98, v60, v61
    v_sad_u32 v98, v98, v62, v63
    s_setprio 0
    s_nop 0
    ds_write_b128 v13, v[140:143] offset:8384
    v_fmac_f32 v125, v16, v97
    v_add_u32 v99, v64, v65
    v_add_f32 v19, v19, v17
    v_fmac_f32 v18, v17, v254
    v_fmac_f32 v18, v17, v255
    s_waitcnt lgkmcnt(2)
    v_pk_mul_f16 v115, v187, v195
    v_mfma_f32_32x32x16_f16 v[48:63], v[80:83], v[108:111], v[32:47]
    s_setprio 1
    v_exp_f32 v17, v125
    v_pk_mul_f16 v116, v236, v188
    v_pk_mul_f16 v117, v237, v189
    v_pk_mul_f16 v118, v238, v190
    v_pk_mul_f16 v119, v239, v191
    v_mfma_f32_32x32x16_f16 v[48:63], v[84:87], v[112:115], v[48:63]
    v_sad_u32 v99, v99, v66, v67
    v_add3_u32 v99, v99, v68, v69
    v_sad_u32 v99, v99, v70, v71
    v_add3_u32 v99, v99, v72, v73
    v_add3_u32 v99, v99, v74, v75
    v_add3_u32 v99, v99, v76, v77
    v_smfmac_f32_16x16x64_f16 v[132:135], v[88:91], v[108:115], v1
    ds_read_b128 v[252:255], v11 offset:2048
    v_sad_u32 v99, v99, v78, v79
    v_pk_mul_f16 v120, v240, v192
    v_pk_mul_f16 v121, v241, v193
    v_pk_mul_f16 v122, v242, v194
    v_mfma_f32_4x4x4_16b_bf16 v[164:167], v[100:101], v[144:145], 0
    v_pk_mul_f16 v123, v243, v195
    v_mfma_f32_4x4x4_16b_bf16 v[168:171], v[100:101], v[146:147], 0
    v_pk_mul_f16 v108, v228, v188
    v_mfma_f32_32x32x16_f16 v[64:79], v[80:83], v[116:119], v[32:47]
    v_pk_mul_f16 v109, v229, v189
    v_permlane32_swap_b32_e64 v98, v99
    v_add3_u32 v16, v98, v99, v128
    v_cvt_pk_f16_f32 v144, v164, v165
    v_cvt_pk_f16_f32 v145, v166, v167
    v_mfma_f32_32x32x16_f16 v[64:79], v[84:87], v[120:123], v[64:79]
    v_cvt_pk_f16_f32 v146, v168, v169
    v_cvt_pk_f16_f32 v147, v170, v171
    v_pk_mul_f16 v110, v230, v190
    v_pk_mul_f16 v111, v231, v191
    v_pk_mul_f16 v112, v232, v192
    v_pk_mul_f16 v113, v233, v193
    v_smfmac_f32_16x16x64_f16 v[132:135], v[92:95], v[116:123], v1
    ds_read_b128 v[216:219], v7 offset:5184
    v_pk_mul_f16 v114, v234, v194
    v_add_u32_e64 v98, v48, v49
    v_sad_u32 v98, v98, v50, v51
    v_add3_u32 v98, v98, v52, v53
    v_sad_u32 v98, v98, v54, v55
    v_add3_u32 v98, v98, v56, v57
    v_add3_u32 v98, v98, v58, v59
    v_add3_u32 v98, v98, v60, v61
    v_sad_u32 v98, v98, v62, v63
    s_setprio 0
    s_nop 0
    ds_write_b128 v13, v[144:147] offset:9856
    ds_read_b128 v[204:207], v2 offset:8320
    ds_read_b128 v[208:211], v2 offset:12480
    ds_read_b128 v[196:199], v3 offset:8320
    ds_read_b128 v[200:203], v3 offset:12480
    ds_read_b128 v[220:223], v4 offset:8320
    v_fmac_f32 v129, v16, v97
    v_add_u32 v99, v64, v65
    v_add_f32 v19, v19, v17
    v_fmac_f32 v18, v17, v126
    v_fmac_f32 v18, v17, v127
    s_waitcnt lgkmcnt(6)
    v_pk_mul_f16 v115, v235, v195
    v_mfma_f32_32x32x16_f16 v[48:63], v[80:83], v[108:111], v[32:47]
    s_setprio 1
    v_exp_f32 v17, v129
    v_pk_mul_f16 v116, v244, v236
    v_pk_mul_f16 v117, v245, v237
    v_pk_mul_f16 v118, v246, v238
    v_pk_mul_f16 v119, v247, v239
    v_mfma_f32_32x32x16_f16 v[48:63], v[84:87], v[112:115], v[48:63]
    v_sad_u32 v99, v99, v66, v67
    v_add3_u32 v99, v99, v68, v69
    v_sad_u32 v99, v99, v70, v71
    v_add3_u32 v99, v99, v72, v73
    v_add3_u32 v99, v99, v74, v75
    v_add3_u32 v99, v99, v76, v77
    v_smfmac_f32_16x16x64_f16 v[252:255], v[88:91], v[108:115], v1
    ds_read_b128 v[124:127], v11 offset:2048
    v_sad_u32 v99, v99, v78, v79
    v_pk_mul_f16 v120, v248, v240
    v_pk_mul_f16 v121, v249, v241
    v_pk_mul_f16 v122, v250, v242
    v_mfma_f32_4x4x4_16b_bf16 v[164:167], v[100:101], v[148:149], 0
    v_pk_mul_f16 v123, v251, v243
    v_mfma_f32_4x4x4_16b_bf16 v[168:171], v[100:101], v[150:151], 0
    v_pk_mul_f16 v108, v212, v228
    v_mfma_f32_32x32x16_f16 v[64:79], v[80:83], v[116:119], v[32:47]
    v_pk_mul_f16 v109, v213, v229
    v_permlane32_swap_b32_e64 v98, v99
    v_add3_u32 v16, v98, v99, v132
    v_cvt_pk_f16_f32 v148, v164, v165
    v_cvt_pk_f16_f32 v149, v166, v167
    v_mfma_f32_32x32x16_f16 v[64:79], v[84:87], v[120:123], v[64:79]
    v_cvt_pk_f16_f32 v150, v168, v169
    v_cvt_pk_f16_f32 v151, v170, v171
    v_pk_mul_f16 v110, v214, v230
    v_pk_mul_f16 v111, v215, v231
    v_pk_mul_f16 v112, v216, v232
    v_pk_mul_f16 v113, v217, v233
    v_smfmac_f32_16x16x64_f16 v[252:255], v[92:95], v[116:123], v1
    ds_read_b128 v[224:227], v4 offset:12480
    v_pk_mul_f16 v114, v218, v234
    v_add_u32_e64 v98, v48, v49
    v_sad_u32 v98, v98, v50, v51
    v_add3_u32 v98, v98, v52, v53
    v_sad_u32 v98, v98, v54, v55
    v_add3_u32 v98, v98, v56, v57
    v_add3_u32 v98, v98, v58, v59
    v_add3_u32 v98, v98, v60, v61
    v_sad_u32 v98, v98, v62, v63
    s_setprio 0
    s_nop 0
    ds_write_b128 v13, v[148:151] offset:8832
    ds_read_b128 v[180:183], v8 offset:9856
    v_fmac_f32 v133, v16, v97
    v_add_u32 v99, v64, v65
    v_add_f32 v19, v19, v17
    v_fmac_f32 v18, v17, v130
    v_fmac_f32 v18, v17, v131
    s_waitcnt lgkmcnt(2)
    v_pk_mul_f16 v115, v219, v235
    v_mfma_f32_32x32x16_f16 v[48:63], v[80:83], v[108:111], v[32:47]
    s_setprio 1
    v_exp_f32 v17, v133
    v_pk_mul_f16 v116, v204, v196
    v_pk_mul_f16 v117, v205, v197
    v_pk_mul_f16 v118, v206, v198
    v_pk_mul_f16 v119, v207, v199
    v_mfma_f32_32x32x16_f16 v[48:63], v[84:87], v[112:115], v[48:63]
    v_sad_u32 v99, v99, v66, v67
    v_add3_u32 v99, v99, v68, v69
    v_sad_u32 v99, v99, v70, v71
    v_add3_u32 v99, v99, v72, v73
    v_add3_u32 v99, v99, v74, v75
    v_add3_u32 v99, v99, v76, v77
    v_smfmac_f32_16x16x64_f16 v[124:127], v[88:91], v[108:115], v1
    ds_read_b128 v[128:131], v11 offset:2048
    v_sad_u32 v99, v99, v78, v79
    v_pk_mul_f16 v120, v208, v200
    v_pk_mul_f16 v121, v209, v201
    v_pk_mul_f16 v122, v210, v202
    v_mfma_f32_4x4x4_16b_bf16 v[164:167], v[100:101], v[152:153], 0
    v_pk_mul_f16 v123, v211, v203
    v_mfma_f32_4x4x4_16b_bf16 v[168:171], v[100:101], v[154:155], 0
    v_pk_mul_f16 v108, v204, v220
    v_mfma_f32_32x32x16_f16 v[64:79], v[80:83], v[116:119], v[32:47]
    v_pk_mul_f16 v109, v205, v221
    v_permlane32_swap_b32_e64 v98, v99
    v_add3_u32 v16, v98, v99, v252
    v_cvt_pk_f16_f32 v152, v164, v165
    v_cvt_pk_f16_f32 v153, v166, v167
    v_mfma_f32_32x32x16_f16 v[64:79], v[84:87], v[120:123], v[64:79]
    v_cvt_pk_f16_f32 v154, v168, v169
    v_cvt_pk_f16_f32 v155, v170, v171
    v_pk_mul_f16 v110, v206, v222
    v_pk_mul_f16 v111, v207, v223
    v_pk_mul_f16 v112, v208, v224
    v_pk_mul_f16 v113, v209, v225
    v_smfmac_f32_16x16x64_f16 v[124:127], v[92:95], v[116:123], v1
    ds_read_b128 v[184:187], v8 offset:14016
    v_pk_mul_f16 v114, v210, v226
    v_add_u32_e64 v98, v48, v49
    v_sad_u32 v98, v98, v50, v51
    v_add3_u32 v98, v98, v52, v53
    v_sad_u32 v98, v98, v54, v55
    v_add3_u32 v98, v98, v56, v57
    v_add3_u32 v98, v98, v58, v59
    v_add3_u32 v98, v98, v60, v61
    v_sad_u32 v98, v98, v62, v63
    s_setprio 0
    s_nop 0
    ds_write_b128 v13, v[152:155] offset:8896
    ds_read_b128 v[188:191], v8 offset:9872
    ds_read_b128 v[192:195], v8 offset:14032
    ds_read_b128 v[244:247], v9 offset:8320
    ds_read_b128 v[248:251], v9 offset:12480
    ds_read_b128 v[236:239], v10 offset:8320
    v_fmac_f32 v253, v16, v97
    v_add_u32 v99, v64, v65
    v_add_f32 v19, v19, v17
    v_fmac_f32 v18, v17, v134
    v_fmac_f32 v18, v17, v135
    s_waitcnt lgkmcnt(6)
    v_pk_mul_f16 v115, v211, v227
    v_mfma_f32_32x32x16_f16 v[48:63], v[80:83], v[108:111], v[32:47]
    s_setprio 1
    v_exp_f32 v17, v253
    v_pk_mul_f16 v116, v196, v220
    v_pk_mul_f16 v117, v197, v221
    v_pk_mul_f16 v118, v198, v222
    v_pk_mul_f16 v119, v199, v223
    v_mfma_f32_32x32x16_f16 v[48:63], v[84:87], v[112:115], v[48:63]
    v_sad_u32 v99, v99, v66, v67
    v_add3_u32 v99, v99, v68, v69
    v_sad_u32 v99, v99, v70, v71
    v_add3_u32 v99, v99, v72, v73
    v_add3_u32 v99, v99, v74, v75
    v_add3_u32 v99, v99, v76, v77
    v_smfmac_f32_16x16x64_f16 v[128:131], v[88:91], v[108:115], v1
    ds_read_b128 v[132:135], v11 offset:2048
    v_sad_u32 v99, v99, v78, v79
    v_mfma_f32_32x32x16_f16 v[64:79], v[80:83], v[116:119], v[32:47]
    v_pk_mul_f16 v120, v200, v224
    v_pk_mul_f16 v121, v201, v225
    v_pk_mul_f16 v122, v202, v226
    v_pk_mul_f16 v123, v203, v227
    v_pk_mul_f16 v108, v180, v204
    v_pk_mul_f16 v109, v181, v205
    v_mfma_f32_32x32x16_f16 v[64:79], v[84:87], v[120:123], v[64:79]
    v_permlane32_swap_b32_e64 v98, v99
    v_add3_u32 v16, v98, v99, v124
    v_pk_mul_f16 v110, v182, v206
    v_pk_mul_f16 v111, v183, v207
    v_pk_mul_f16 v112, v184, v208
    v_smfmac_f32_16x16x64_f16 v[128:131], v[92:95], v[116:123], v1
    ds_read_b128 v[240:243], v10 offset:12480
    v_pk_mul_f16 v113, v185, v209
    v_pk_mul_f16 v114, v186, v210
    v_add_u32_e64 v98, v48, v49
    v_sad_u32 v98, v98, v50, v51
    v_add3_u32 v98, v98, v52, v53
    v_sad_u32 v98, v98, v54, v55
    v_add3_u32 v98, v98, v56, v57
    v_add3_u32 v98, v98, v58, v59
    v_add3_u32 v98, v98, v60, v61
    v_sad_u32 v98, v98, v62, v63
    s_setprio 0
    s_nop 0
    ds_read_b128 v[212:215], v2 offset:8832
    v_fmac_f32 v125, v16, v97
    v_add_u32 v99, v64, v65
    v_add_f32 v19, v19, v17
    v_fmac_f32 v18, v17, v254
    v_fmac_f32 v18, v17, v255
    s_waitcnt lgkmcnt(1)
    v_pk_mul_f16 v115, v187, v211
    v_mfma_f32_32x32x16_f16 v[48:63], v[80:83], v[108:111], v[32:47]
    s_setprio 1
    v_exp_f32 v21, v125
    v_pk_mul_f16 v116, v188, v204
    v_pk_mul_f16 v117, v189, v205
    v_pk_mul_f16 v118, v190, v206
    v_pk_mul_f16 v119, v191, v207
    v_mfma_f32_32x32x16_f16 v[48:63], v[84:87], v[112:115], v[48:63]
    v_sad_u32 v99, v99, v66, v67
    v_add3_u32 v99, v99, v68, v69
    v_sad_u32 v99, v99, v70, v71
    v_add3_u32 v99, v99, v72, v73
    v_add3_u32 v99, v99, v74, v75
    v_add3_u32 v99, v99, v76, v77
    v_smfmac_f32_16x16x64_f16 v[132:135], v[88:91], v[108:115], v1
    ds_read_b128 v[252:255], v22 offset:2048
    v_sad_u32 v99, v99, v78, v79
    v_mfma_f32_32x32x16_f16 v[64:79], v[80:83], v[116:119], v[32:47]
    v_pk_mul_f16 v120, v192, v208
    v_pk_mul_f16 v121, v193, v209
    v_pk_mul_f16 v122, v194, v210
    v_pk_mul_f16 v123, v195, v211
    v_pk_mul_f16 v108, v244, v236
    v_pk_mul_f16 v109, v245, v237
    v_mfma_f32_32x32x16_f16 v[64:79], v[84:87], v[120:123], v[64:79]
    v_permlane32_swap_b32_e64 v98, v99
    v_add3_u32 v16, v98, v99, v128
    v_pk_mul_f16 v110, v246, v238
    v_pk_mul_f16 v111, v247, v239
    v_pk_mul_f16 v112, v248, v240
    v_smfmac_f32_16x16x64_f16 v[132:135], v[92:95], v[116:123], v1
    ds_read_b128 v[216:219], v2 offset:12992
    v_pk_mul_f16 v113, v249, v241
    v_pk_mul_f16 v114, v250, v242
    v_add_u32_e64 v98, v48, v49
    v_sad_u32 v98, v98, v50, v51
    v_add3_u32 v98, v98, v52, v53
    v_sad_u32 v98, v98, v54, v55
    v_add3_u32 v98, v98, v56, v57
    v_add3_u32 v98, v98, v58, v59
    v_add3_u32 v98, v98, v60, v61
    v_sad_u32 v98, v98, v62, v63
    s_setprio 0
    v_fmac_f32 v129, v16, v97
    v_add_u32 v99, v64, v65
    v_mul_f32 v20, v21, v126
    v_fmac_f32 v20, v21, v127
    s_waitcnt lgkmcnt(0)
    v_pk_mul_f16 v115, v251, v243
    v_mfma_f32_32x32x16_f16 v[48:63], v[80:83], v[108:111], v[32:47]
    s_setprio 1
    v_exp_f32 v15, v129
    v_pk_mul_f16 v116, v204, v212
    v_pk_mul_f16 v117, v205, v213
    v_pk_mul_f16 v118, v206, v214
    v_pk_mul_f16 v119, v207, v215
    v_mfma_f32_32x32x16_f16 v[48:63], v[84:87], v[112:115], v[48:63]
    v_sad_u32 v99, v99, v66, v67
    v_add3_u32 v99, v99, v68, v69
    v_sad_u32 v99, v99, v70, v71
    v_add3_u32 v99, v99, v72, v73
    v_add3_u32 v99, v99, v74, v75
    v_add3_u32 v99, v99, v76, v77
    v_smfmac_f32_16x16x64_f16 v[252:255], v[88:91], v[108:115], v1
    ds_read_b128 v[124:127], v11 offset:2048
    v_sad_u32 v99, v99, v78, v79
    v_mfma_f32_32x32x16_f16 v[64:79], v[80:83], v[116:119], v[32:47]
    v_pk_mul_f16 v120, v208, v216
    v_pk_mul_f16 v121, v209, v217
    v_pk_mul_f16 v122, v210, v218
    v_pk_mul_f16 v123, v211, v219
    v_pk_mul_f16 v108, v196, v212
    v_pk_mul_f16 v109, v197, v213
    v_mfma_f32_32x32x16_f16 v[64:79], v[84:87], v[120:123], v[64:79]
    v_permlane32_swap_b32_e64 v98, v99
    v_add3_u32 v16, v98, v99, v132
    v_pk_mul_f16 v110, v198, v214
    v_pk_mul_f16 v111, v199, v215
    v_pk_mul_f16 v112, v200, v216
    v_smfmac_f32_16x16x64_f16 v[252:255], v[92:95], v[116:123], v1
    ds_read_b128 v[228:231], v3 offset:8832
    v_pk_mul_f16 v113, v201, v217
    v_pk_mul_f16 v114, v202, v218
    v_add_u32_e64 v98, v48, v49
    v_sad_u32 v98, v98, v50, v51
    v_add3_u32 v98, v98, v52, v53
    v_sad_u32 v98, v98, v54, v55
    v_add3_u32 v98, v98, v56, v57
    v_add3_u32 v98, v98, v58, v59
    v_add3_u32 v98, v98, v60, v61
    v_sad_u32 v98, v98, v62, v63
    s_setprio 0
    v_fmac_f32 v133, v16, v97
    v_add_u32 v99, v64, v65
    v_mul_f32 v14, v15, v130
    v_fmac_f32 v14, v15, v131
    s_waitcnt lgkmcnt(1)
    v_pk_mul_f16 v115, v203, v219
    v_mfma_f32_32x32x16_f16 v[48:63], v[80:83], v[108:111], v[32:47]
    s_setprio 1
    v_exp_f32 v17, v133
    v_pk_mul_f16 v116, v220, v212
    v_pk_mul_f16 v117, v221, v213
    v_pk_mul_f16 v118, v222, v214
    v_pk_mul_f16 v119, v223, v215
    v_mfma_f32_32x32x16_f16 v[48:63], v[84:87], v[112:115], v[48:63]
    v_sad_u32 v99, v99, v66, v67
    v_add3_u32 v99, v99, v68, v69
    v_sad_u32 v99, v99, v70, v71
    v_add3_u32 v99, v99, v72, v73
    v_add3_u32 v99, v99, v74, v75
    v_add3_u32 v99, v99, v76, v77
    v_smfmac_f32_16x16x64_f16 v[124:127], v[88:91], v[108:115], v1
    ds_read_b128 v[128:131], v11 offset:2048
    v_sad_u32 v99, v99, v78, v79
    v_pk_mul_f16 v120, v224, v216
    v_pk_mul_f16 v121, v225, v217
    v_pk_mul_f16 v122, v226, v218
    v_mfma_f32_4x4x4_16b_bf16 v[164:167], v[100:101], v[156:157], 0
    v_pk_mul_f16 v123, v227, v219
    v_mfma_f32_4x4x4_16b_bf16 v[168:171], v[100:101], v[158:159], 0
    v_pk_mul_f16 v108, v180, v212
    v_mfma_f32_32x32x16_f16 v[64:79], v[80:83], v[116:119], v[32:47]
    v_pk_mul_f16 v109, v181, v213
    v_permlane32_swap_b32_e64 v98, v99
    v_add3_u32 v16, v98, v99, v252
    v_cvt_pk_f16_f32 v156, v164, v165
    v_cvt_pk_f16_f32 v157, v166, v167
    v_mfma_f32_32x32x16_f16 v[64:79], v[84:87], v[120:123], v[64:79]
    v_cvt_pk_f16_f32 v158, v168, v169
    v_cvt_pk_f16_f32 v159, v170, v171
    v_pk_mul_f16 v110, v182, v214
    v_pk_mul_f16 v111, v183, v215
    v_pk_mul_f16 v112, v184, v216
    v_pk_mul_f16 v113, v185, v217
    v_smfmac_f32_16x16x64_f16 v[124:127], v[92:95], v[116:123], v1
    ds_read_b128 v[232:235], v3 offset:12992
    v_pk_mul_f16 v114, v186, v218
    v_add_u32_e64 v98, v48, v49
    v_sad_u32 v98, v98, v50, v51
    v_add3_u32 v98, v98, v52, v53
    v_sad_u32 v98, v98, v54, v55
    v_add3_u32 v98, v98, v56, v57
    v_add3_u32 v98, v98, v58, v59
    v_add3_u32 v98, v98, v60, v61
    v_sad_u32 v98, v98, v62, v63
    s_setprio 0
    s_nop 0
    ds_write_b128 v13, v[156:159] offset:9344
    v_fmac_f32 v253, v16, v97
    v_add_u32 v99, v64, v65
    v_add_f32 v15, v15, v17
    v_fmac_f32 v14, v17, v134
    v_fmac_f32 v14, v17, v135
    s_waitcnt lgkmcnt(1)
    v_pk_mul_f16 v115, v187, v219
    v_mfma_f32_32x32x16_f16 v[48:63], v[80:83], v[108:111], v[32:47]
    s_setprio 1
    v_exp_f32 v17, v253
    v_pk_mul_f16 v116, v188, v212
    v_pk_mul_f16 v117, v189, v213
    v_pk_mul_f16 v118, v190, v214
    v_pk_mul_f16 v119, v191, v215
    v_mfma_f32_32x32x16_f16 v[48:63], v[84:87], v[112:115], v[48:63]
    v_sad_u32 v99, v99, v66, v67
    v_add3_u32 v99, v99, v68, v69
    v_sad_u32 v99, v99, v70, v71
    v_add3_u32 v99, v99, v72, v73
    v_add3_u32 v99, v99, v74, v75
    v_add3_u32 v99, v99, v76, v77
    v_smfmac_f32_16x16x64_f16 v[128:131], v[88:91], v[108:115], v1
    ds_read_b128 v[132:135], v11 offset:2048
    v_sad_u32 v99, v99, v78, v79
    v_pk_mul_f16 v120, v192, v216
    v_pk_mul_f16 v121, v193, v217
    v_pk_mul_f16 v122, v194, v218
    v_mfma_f32_4x4x4_16b_bf16 v[164:167], v[100:101], v[160:161], 0
    v_pk_mul_f16 v123, v195, v219
    v_mfma_f32_4x4x4_16b_bf16 v[168:171], v[100:101], v[162:163], 0
    v_pk_mul_f16 v108, v204, v228
    v_mfma_f32_32x32x16_f16 v[64:79], v[80:83], v[116:119], v[32:47]
    v_pk_mul_f16 v109, v205, v229
    v_permlane32_swap_b32_e64 v98, v99
    v_add3_u32 v16, v98, v99, v124
    v_cvt_pk_f16_f32 v160, v164, v165
    v_cvt_pk_f16_f32 v161, v166, v167
    v_mfma_f32_32x32x16_f16 v[64:79], v[84:87], v[120:123], v[64:79]
    v_cvt_pk_f16_f32 v162, v168, v169
    v_cvt_pk_f16_f32 v163, v170, v171
    v_pk_mul_f16 v110, v206, v230
    v_pk_mul_f16 v111, v207, v231
    v_pk_mul_f16 v112, v208, v232
    v_pk_mul_f16 v113, v209, v233
    v_smfmac_f32_16x16x64_f16 v[128:131], v[92:95], v[116:123], v1
    ds_read_b128 v[244:247], v4 offset:8832
    v_pk_mul_f16 v114, v210, v234
    v_add_u32_e64 v98, v48, v49
    v_sad_u32 v98, v98, v50, v51
    v_add3_u32 v98, v98, v52, v53
    v_sad_u32 v98, v98, v54, v55
    v_add3_u32 v98, v98, v56, v57
    v_add3_u32 v98, v98, v58, v59
    v_add3_u32 v98, v98, v60, v61
    v_sad_u32 v98, v98, v62, v63
    s_setprio 0
    s_nop 0
    ds_write_b128 v13, v[160:163] offset:9408
    v_fmac_f32 v125, v16, v97
    v_add_u32 v99, v64, v65
    v_add_f32 v15, v15, v17
    v_fmac_f32 v14, v17, v254
    v_fmac_f32 v14, v17, v255
    s_waitcnt lgkmcnt(2)
    v_pk_mul_f16 v115, v211, v235
    v_mfma_f32_32x32x16_f16 v[48:63], v[80:83], v[108:111], v[32:47]
    s_setprio 1
    v_exp_f32 v17, v125
    v_pk_mul_f16 v116, v220, v228
    v_pk_mul_f16 v117, v221, v229
    v_pk_mul_f16 v118, v222, v230
    v_pk_mul_f16 v119, v223, v231
    v_mfma_f32_32x32x16_f16 v[48:63], v[84:87], v[112:115], v[48:63]
    v_sad_u32 v99, v99, v66, v67
    v_add3_u32 v99, v99, v68, v69
    v_sad_u32 v99, v99, v70, v71
    v_add3_u32 v99, v99, v72, v73
    v_add3_u32 v99, v99, v74, v75
    v_add3_u32 v99, v99, v76, v77
    v_smfmac_f32_16x16x64_f16 v[132:135], v[88:91], v[108:115], v1
    ds_read_b128 v[252:255], v11 offset:2048
    v_sad_u32 v99, v99, v78, v79
    v_mfma_f32_32x32x16_f16 v[64:79], v[80:83], v[116:119], v[32:47]
    v_pk_mul_f16 v120, v224, v232
    v_pk_mul_f16 v121, v225, v233
    v_pk_mul_f16 v122, v226, v234
    v_pk_mul_f16 v123, v227, v235
    v_pk_mul_f16 v108, v212, v228
    v_pk_mul_f16 v109, v213, v229
    v_mfma_f32_32x32x16_f16 v[64:79], v[84:87], v[120:123], v[64:79]
    v_permlane32_swap_b32_e64 v98, v99
    v_add3_u32 v16, v98, v99, v128
    v_pk_mul_f16 v110, v214, v230
    v_pk_mul_f16 v111, v215, v231
    v_pk_mul_f16 v112, v216, v232
    v_smfmac_f32_16x16x64_f16 v[132:135], v[92:95], v[116:123], v1
    ds_read_b128 v[248:251], v4 offset:12992
    v_pk_mul_f16 v113, v217, v233
    v_pk_mul_f16 v114, v218, v234
    v_add_u32_e64 v98, v48, v49
    v_sad_u32 v98, v98, v50, v51
    v_add3_u32 v98, v98, v52, v53
    v_sad_u32 v98, v98, v54, v55
    v_add3_u32 v98, v98, v56, v57
    v_add3_u32 v98, v98, v58, v59
    v_add3_u32 v98, v98, v60, v61
    v_sad_u32 v98, v98, v62, v63
    s_setprio 0
    v_fmac_f32 v129, v16, v97
    v_add_u32 v99, v64, v65
    v_add_f32 v15, v15, v17
    v_fmac_f32_e64 v14, v17, v126
    v_fmac_f32 v14, v17, v127
    s_waitcnt lgkmcnt(0)
    v_pk_mul_f16 v115, v219, v235
    v_mfma_f32_32x32x16_f16 v[48:63], v[80:83], v[108:111], v[32:47]
    s_setprio 1
    v_exp_f32 v17, v129
    v_pk_mul_f16 v116, v204, v244
    v_pk_mul_f16 v117, v205, v245
    v_pk_mul_f16 v118, v206, v246
    v_pk_mul_f16 v119, v207, v247
    v_mfma_f32_32x32x16_f16 v[48:63], v[84:87], v[112:115], v[48:63]
    v_sad_u32 v99, v99, v66, v67
    v_add3_u32 v99, v99, v68, v69
    v_sad_u32 v99, v99, v70, v71
    v_add3_u32 v99, v99, v72, v73
    v_add3_u32 v99, v99, v74, v75
    v_add3_u32 v99, v99, v76, v77
    v_smfmac_f32_16x16x64_f16 v[252:255], v[88:91], v[108:115], v1
    ds_read_b128 v[124:127], v11 offset:2048
    v_sad_u32 v99, v99, v78, v79
    v_mfma_f32_32x32x16_f16 v[64:79], v[80:83], v[116:119], v[32:47]
    v_pk_mul_f16 v120, v208, v248
    v_pk_mul_f16 v121, v209, v249
    v_pk_mul_f16 v122, v210, v250
    v_pk_mul_f16 v123, v211, v251
    v_pk_mul_f16 v108, v196, v244
    v_pk_mul_f16 v109, v197, v245
    v_mfma_f32_32x32x16_f16 v[64:79], v[84:87], v[120:123], v[64:79]
    v_permlane32_swap_b32_e64 v98, v99
    v_add3_u32 v16, v98, v99, v132
    v_pk_mul_f16 v110, v198, v246
    v_pk_mul_f16 v111, v199, v247
    v_pk_mul_f16 v112, v200, v248
    v_smfmac_f32_16x16x64_f16 v[252:255], v[92:95], v[116:123], v1
    ds_read_b128 v[236:239], v2 offset:9344
    v_pk_mul_f16 v113, v201, v249
    v_pk_mul_f16 v114, v202, v250
    v_add_u32_e64 v98, v48, v49
    v_sad_u32 v98, v98, v50, v51
    v_add3_u32 v98, v98, v52, v53
    v_sad_u32 v98, v98, v54, v55
    v_add3_u32 v98, v98, v56, v57
    v_add3_u32 v98, v98, v58, v59
    v_add3_u32 v98, v98, v60, v61
    v_sad_u32 v98, v98, v62, v63
    s_setprio 0
    v_fmac_f32 v133, v16, v97
    v_add_u32 v99, v64, v65
    v_add_f32 v15, v15, v17
    v_fmac_f32_e64 v14, v17, v130
    v_fmac_f32 v14, v17, v131
    s_waitcnt lgkmcnt(1)
    v_pk_mul_f16 v115, v203, v251
    v_mfma_f32_32x32x16_f16 v[48:63], v[80:83], v[108:111], v[32:47]
    s_setprio 1
    v_exp_f32 v17, v133
    v_pk_mul_f16 v116, v212, v244
    v_pk_mul_f16 v117, v213, v245
    v_pk_mul_f16 v118, v214, v246
    v_pk_mul_f16 v119, v215, v247
    v_mfma_f32_32x32x16_f16 v[48:63], v[84:87], v[112:115], v[48:63]
    v_sad_u32 v99, v99, v66, v67
    v_add3_u32 v99, v99, v68, v69
    v_sad_u32 v99, v99, v70, v71
    v_add3_u32 v99, v99, v72, v73
    v_add3_u32 v99, v99, v74, v75
    v_add3_u32 v99, v99, v76, v77
    v_smfmac_f32_16x16x64_f16 v[124:127], v[88:91], v[108:115], v1
    ds_read_b128 v[128:131], v11 offset:2048
    v_sad_u32 v99, v99, v78, v79
    v_mfma_f32_32x32x16_f16 v[64:79], v[80:83], v[116:119], v[32:47]
    v_pk_mul_f16 v120, v216, v248
    v_pk_mul_f16 v121, v217, v249
    v_pk_mul_f16 v122, v218, v250
    v_pk_mul_f16 v123, v219, v251
    v_pk_mul_f16 v108, v228, v244
    v_pk_mul_f16 v109, v229, v245
    v_mfma_f32_32x32x16_f16 v[64:79], v[84:87], v[120:123], v[64:79]
    v_permlane32_swap_b32_e64 v98, v99
    v_add3_u32 v16, v98, v99, v252
    v_pk_mul_f16 v110, v230, v246
    v_pk_mul_f16 v111, v231, v247
    v_pk_mul_f16 v112, v232, v248
    v_smfmac_f32_16x16x64_f16 v[124:127], v[92:95], v[116:123], v1
    ds_read_b128 v[240:243], v2 offset:13504
    v_pk_mul_f16 v113, v233, v249
    v_pk_mul_f16 v114, v234, v250
    v_add_u32_e64 v98, v48, v49
    v_sad_u32 v98, v98, v50, v51
    v_add3_u32 v98, v98, v52, v53
    v_sad_u32 v98, v98, v54, v55
    v_add3_u32 v98, v98, v56, v57
    v_add3_u32 v98, v98, v58, v59
    v_add3_u32 v98, v98, v60, v61
    v_sad_u32 v98, v98, v62, v63
    s_setprio 0
    v_fmac_f32 v253, v16, v97
    v_add_u32 v99, v64, v65
    v_add_f32 v15, v15, v17
    v_fmac_f32_e64 v14, v17, v134
    v_fmac_f32 v14, v17, v135
    s_waitcnt lgkmcnt(0)
    v_pk_mul_f16 v115, v235, v251
    v_mfma_f32_32x32x16_f16 v[48:63], v[80:83], v[108:111], v[32:47]
    s_setprio 1
    v_exp_f32 v17, v253
    v_pk_mul_f16 v116, v180, v236
    v_pk_mul_f16 v117, v181, v237
    v_pk_mul_f16 v118, v182, v238
    v_pk_mul_f16 v119, v183, v239
    v_mfma_f32_32x32x16_f16 v[48:63], v[84:87], v[112:115], v[48:63]
    v_sad_u32 v99, v99, v66, v67
    v_add3_u32 v99, v99, v68, v69
    v_sad_u32 v99, v99, v70, v71
    v_add3_u32 v99, v99, v72, v73
    v_add3_u32 v99, v99, v74, v75
    v_add3_u32 v99, v99, v76, v77
    v_smfmac_f32_16x16x64_f16 v[128:131], v[88:91], v[108:115], v1
    ds_read_b128 v[132:135], v11 offset:2048
    v_sad_u32 v99, v99, v78, v79
    v_mfma_f32_32x32x16_f16 v[64:79], v[80:83], v[116:119], v[32:47]
    v_pk_mul_f16 v120, v184, v240
    v_pk_mul_f16 v121, v185, v241
    v_pk_mul_f16 v122, v186, v242
    v_pk_mul_f16 v123, v187, v243
    v_pk_mul_f16 v108, v188, v236
    v_pk_mul_f16 v109, v189, v237
    v_mfma_f32_32x32x16_f16 v[64:79], v[84:87], v[120:123], v[64:79]
    v_permlane32_swap_b32_e64 v98, v99
    v_add3_u32 v16, v98, v99, v124
    v_pk_mul_f16 v110, v190, v238
    v_pk_mul_f16 v111, v191, v239
    v_pk_mul_f16 v112, v192, v240
    v_smfmac_f32_16x16x64_f16 v[128:131], v[92:95], v[116:123], v1
    ds_read_b128 v[180:183], v4 offset:9344
    v_pk_mul_f16 v113, v193, v241
    v_pk_mul_f16 v114, v194, v242
    v_add_u32_e64 v98, v48, v49
    v_sad_u32 v98, v98, v50, v51
    v_add3_u32 v98, v98, v52, v53
    v_sad_u32 v98, v98, v54, v55
    v_add3_u32 v98, v98, v56, v57
    v_add3_u32 v98, v98, v58, v59
    v_add3_u32 v98, v98, v60, v61
    v_sad_u32 v98, v98, v62, v63
    s_setprio 0
    v_fmac_f32 v125, v16, v97
    v_add_u32 v99, v64, v65
    v_add_f32 v15, v15, v17
    v_fmac_f32_e64 v14, v17, v254
    v_fmac_f32 v14, v17, v255
    s_waitcnt lgkmcnt(1)
    v_pk_mul_f16 v115, v195, v243
    v_mfma_f32_32x32x16_f16 v[48:63], v[80:83], v[108:111], v[32:47]
    s_setprio 1
    v_exp_f32 v17, v125
    v_pk_mul_f16 v116, v196, v236
    v_pk_mul_f16 v117, v197, v237
    v_pk_mul_f16 v118, v198, v238
    v_pk_mul_f16 v119, v199, v239
    v_mfma_f32_32x32x16_f16 v[48:63], v[84:87], v[112:115], v[48:63]
    v_sad_u32 v99, v99, v66, v67
    v_add3_u32 v99, v99, v68, v69
    v_sad_u32 v99, v99, v70, v71
    v_add3_u32 v99, v99, v72, v73
    v_add3_u32 v99, v99, v74, v75
    v_add3_u32 v99, v99, v76, v77
    v_smfmac_f32_16x16x64_f16 v[132:135], v[88:91], v[108:115], v1
    ds_read_b128 v[252:255], v11 offset:2048
    v_sad_u32 v99, v99, v78, v79
    v_mfma_f32_32x32x16_f16 v[64:79], v[80:83], v[116:119], v[32:47]
    v_pk_mul_f16 v120, v200, v240
    v_pk_mul_f16 v121, v201, v241
    v_pk_mul_f16 v122, v202, v242
    v_pk_mul_f16 v123, v203, v243
    v_pk_mul_f16 v108, v228, v236
    v_pk_mul_f16 v109, v229, v237
    v_mfma_f32_32x32x16_f16 v[64:79], v[84:87], v[120:123], v[64:79]
    v_permlane32_swap_b32_e64 v98, v99
    v_add3_u32 v16, v98, v99, v128
    v_pk_mul_f16 v110, v230, v238
    v_pk_mul_f16 v111, v231, v239
    v_pk_mul_f16 v112, v232, v240
    v_smfmac_f32_16x16x64_f16 v[132:135], v[92:95], v[116:123], v1
    ds_read_b128 v[184:187], v4 offset:13504
    v_pk_mul_f16 v113, v233, v241
    v_pk_mul_f16 v114, v234, v242
    v_add_u32_e64 v98, v48, v49
    v_sad_u32 v98, v98, v50, v51
    v_add3_u32 v98, v98, v52, v53
    v_sad_u32 v98, v98, v54, v55
    v_add3_u32 v98, v98, v56, v57
    v_add3_u32 v98, v98, v58, v59
    v_add3_u32 v98, v98, v60, v61
    v_sad_u32 v98, v98, v62, v63
    s_setprio 0
    v_fmac_f32 v129, v16, v97
    v_add_u32 v99, v64, v65
    v_add_f32 v15, v15, v17
    v_fmac_f32_e64 v14, v17, v126
    v_fmac_f32 v14, v17, v127
    s_waitcnt lgkmcnt(1)
    v_pk_mul_f16 v115, v235, v243
    v_mfma_f32_32x32x16_f16 v[48:63], v[80:83], v[108:111], v[32:47]
    s_setprio 1
    v_exp_f32 v17, v129
    v_pk_mul_f16 v116, v204, v236
    v_pk_mul_f16 v117, v205, v237
    v_pk_mul_f16 v118, v206, v238
    v_pk_mul_f16 v119, v207, v239
    v_mfma_f32_32x32x16_f16 v[48:63], v[84:87], v[112:115], v[48:63]
    v_sad_u32 v99, v99, v66, v67
    v_add3_u32 v99, v99, v68, v69
    v_sad_u32 v99, v99, v70, v71
    v_add3_u32 v99, v99, v72, v73
    v_add3_u32 v99, v99, v74, v75
    v_add3_u32 v99, v99, v76, v77
    v_smfmac_f32_16x16x64_f16 v[252:255], v[88:91], v[108:115], v1
    ds_read_b128 v[124:127], v11 offset:2048
    v_sad_u32 v99, v99, v78, v79
    v_mfma_f32_32x32x16_f16 v[64:79], v[80:83], v[116:119], v[32:47]
    v_pk_mul_f16 v120, v208, v240
    v_pk_mul_f16 v121, v209, v241
    v_pk_mul_f16 v122, v210, v242
    v_pk_mul_f16 v123, v211, v243
    v_pk_mul_f16 v108, v212, v236
    v_pk_mul_f16 v109, v213, v237
    v_mfma_f32_32x32x16_f16 v[64:79], v[84:87], v[120:123], v[64:79]
    v_permlane32_swap_b32_e64 v98, v99
    v_add3_u32 v16, v98, v99, v132
    v_pk_mul_f16 v110, v214, v238
    v_pk_mul_f16 v111, v215, v239
    v_pk_mul_f16 v112, v216, v240
    v_smfmac_f32_16x16x64_f16 v[252:255], v[92:95], v[116:123], v1
    ds_read_b128 v[188:191], v5 offset:8320
    v_pk_mul_f16 v113, v217, v241
    v_pk_mul_f16 v114, v218, v242
    v_add_u32_e64 v98, v48, v49
    v_sad_u32 v98, v98, v50, v51
    v_add3_u32 v98, v98, v52, v53
    v_sad_u32 v98, v98, v54, v55
    v_add3_u32 v98, v98, v56, v57
    v_add3_u32 v98, v98, v58, v59
    v_add3_u32 v98, v98, v60, v61
    v_sad_u32 v98, v98, v62, v63
    s_setprio 0
    v_fmac_f32 v133, v16, v97
    v_add_u32 v99, v64, v65
    v_add_f32 v15, v15, v17
    v_fmac_f32_e64 v14, v17, v130
    v_fmac_f32 v14, v17, v131
    s_waitcnt lgkmcnt(1)
    v_pk_mul_f16 v115, v219, v243
    v_mfma_f32_32x32x16_f16 v[48:63], v[80:83], v[108:111], v[32:47]
    s_setprio 1
    v_exp_f32 v17, v133
    v_pk_mul_f16 v116, v220, v236
    v_pk_mul_f16 v117, v221, v237
    v_pk_mul_f16 v118, v222, v238
    v_pk_mul_f16 v119, v223, v239
    v_mfma_f32_32x32x16_f16 v[48:63], v[84:87], v[112:115], v[48:63]
    v_sad_u32 v99, v99, v66, v67
    v_add3_u32 v99, v99, v68, v69
    v_sad_u32 v99, v99, v70, v71
    v_add3_u32 v99, v99, v72, v73
    v_add3_u32 v99, v99, v74, v75
    v_add3_u32 v99, v99, v76, v77
    v_smfmac_f32_16x16x64_f16 v[124:127], v[88:91], v[108:115], v1
    ds_read_b128 v[128:131], v11 offset:2048
    v_sad_u32 v99, v99, v78, v79
    v_mfma_f32_32x32x16_f16 v[64:79], v[80:83], v[116:119], v[32:47]
    v_pk_mul_f16 v120, v224, v240
    v_pk_mul_f16 v121, v225, v241
    v_pk_mul_f16 v122, v226, v242
    v_pk_mul_f16 v123, v227, v243
    v_pk_mul_f16 v108, v244, v236
    v_pk_mul_f16 v109, v245, v237
    v_mfma_f32_32x32x16_f16 v[64:79], v[84:87], v[120:123], v[64:79]
    v_permlane32_swap_b32_e64 v98, v99
    v_add3_u32 v16, v98, v99, v252
    v_pk_mul_f16 v110, v246, v238
    v_pk_mul_f16 v111, v247, v239
    v_pk_mul_f16 v112, v248, v240
    v_smfmac_f32_16x16x64_f16 v[124:127], v[92:95], v[116:123], v1
    ds_read_b128 v[192:195], v5 offset:12480
    v_pk_mul_f16 v113, v249, v241
    v_pk_mul_f16 v114, v250, v242
    v_add_u32_e64 v98, v48, v49
    v_sad_u32 v98, v98, v50, v51
    v_add3_u32 v98, v98, v52, v53
    v_sad_u32 v98, v98, v54, v55
    v_add3_u32 v98, v98, v56, v57
    v_add3_u32 v98, v98, v58, v59
    v_add3_u32 v98, v98, v60, v61
    v_sad_u32 v98, v98, v62, v63
    s_setprio 0
    v_fmac_f32 v253, v16, v97
    v_add_u32 v99, v64, v65
    v_add_f32 v15, v15, v17
    v_fmac_f32_e64 v14, v17, v134
    v_fmac_f32 v14, v17, v135
    s_waitcnt lgkmcnt(1)
    v_pk_mul_f16 v115, v251, v243
    v_mfma_f32_32x32x16_f16 v[48:63], v[80:83], v[108:111], v[32:47]
    s_setprio 1
    v_exp_f32 v17, v253
    v_pk_mul_f16 v116, v196, v180
    v_pk_mul_f16 v117, v197, v181
    v_pk_mul_f16 v118, v198, v182
    v_pk_mul_f16 v119, v199, v183
    v_mfma_f32_32x32x16_f16 v[48:63], v[84:87], v[112:115], v[48:63]
    v_sad_u32 v99, v99, v66, v67
    v_add3_u32 v99, v99, v68, v69
    v_sad_u32 v99, v99, v70, v71
    v_add3_u32 v99, v99, v72, v73
    v_add3_u32 v99, v99, v74, v75
    v_add3_u32 v99, v99, v76, v77
    v_smfmac_f32_16x16x64_f16 v[128:131], v[88:91], v[108:115], v1
    ds_read_b128 v[132:135], v11 offset:2048
    v_sad_u32 v99, v99, v78, v79
    v_mfma_f32_32x32x16_f16 v[64:79], v[80:83], v[116:119], v[32:47]
    v_pk_mul_f16 v120, v200, v184
    v_pk_mul_f16 v121, v201, v185
    v_pk_mul_f16 v122, v202, v186
    v_pk_mul_f16 v123, v203, v187
    v_pk_mul_f16 v108, v228, v180
    v_pk_mul_f16 v109, v229, v181
    v_mfma_f32_32x32x16_f16 v[64:79], v[84:87], v[120:123], v[64:79]
    v_permlane32_swap_b32_e64 v98, v99
    v_add3_u32 v16, v98, v99, v124
    v_pk_mul_f16 v110, v230, v182
    v_pk_mul_f16 v111, v231, v183
    v_pk_mul_f16 v112, v232, v184
    v_smfmac_f32_16x16x64_f16 v[128:131], v[92:95], v[116:123], v1
    ds_read_b128 v[196:199], v3 offset:9344
    v_pk_mul_f16 v113, v233, v185
    v_pk_mul_f16 v114, v234, v186
    v_add_u32_e64 v98, v48, v49
    v_sad_u32 v98, v98, v50, v51
    v_add3_u32 v98, v98, v52, v53
    v_sad_u32 v98, v98, v54, v55
    v_add3_u32 v98, v98, v56, v57
    v_add3_u32 v98, v98, v58, v59
    v_add3_u32 v98, v98, v60, v61
    v_sad_u32 v98, v98, v62, v63
    s_setprio 0
    v_fmac_f32 v125, v16, v97
    v_add_u32 v99, v64, v65
    v_add_f32 v15, v15, v17
    v_fmac_f32_e64 v14, v17, v254
    v_fmac_f32 v14, v17, v255
    s_waitcnt lgkmcnt(1)
    v_pk_mul_f16 v115, v235, v187
    v_mfma_f32_32x32x16_f16 v[48:63], v[80:83], v[108:111], v[32:47]
    s_setprio 1
    v_exp_f32 v17, v125
    v_pk_mul_f16 v116, v204, v180
    v_pk_mul_f16 v117, v205, v181
    v_pk_mul_f16 v118, v206, v182
    v_pk_mul_f16 v119, v207, v183
    v_mfma_f32_32x32x16_f16 v[48:63], v[84:87], v[112:115], v[48:63]
    v_sad_u32 v99, v99, v66, v67
    v_add3_u32 v99, v99, v68, v69
    v_sad_u32 v99, v99, v70, v71
    v_add3_u32 v99, v99, v72, v73
    v_add3_u32 v99, v99, v74, v75
    v_add3_u32 v99, v99, v76, v77
    v_smfmac_f32_16x16x64_f16 v[132:135], v[88:91], v[108:115], v1
    ds_read_b128 v[252:255], v11 offset:2048
    v_sad_u32 v99, v99, v78, v79
    v_mfma_f32_32x32x16_f16 v[64:79], v[80:83], v[116:119], v[32:47]
    v_pk_mul_f16 v120, v208, v184
    v_pk_mul_f16 v121, v209, v185
    v_pk_mul_f16 v122, v210, v186
    v_pk_mul_f16 v123, v211, v187
    v_pk_mul_f16 v108, v212, v180
    v_pk_mul_f16 v109, v213, v181
    v_mfma_f32_32x32x16_f16 v[64:79], v[84:87], v[120:123], v[64:79]
    v_permlane32_swap_b32_e64 v98, v99
    v_add3_u32 v16, v98, v99, v128
    v_pk_mul_f16 v110, v214, v182
    v_pk_mul_f16 v111, v215, v183
    v_pk_mul_f16 v112, v216, v184
    v_smfmac_f32_16x16x64_f16 v[132:135], v[92:95], v[116:123], v1
    ds_read_b128 v[200:203], v3 offset:13504
    v_pk_mul_f16 v113, v217, v185
    v_pk_mul_f16 v114, v218, v186
    v_add_u32_e64 v98, v48, v49
    v_sad_u32 v98, v98, v50, v51
    v_add3_u32 v98, v98, v52, v53
    v_sad_u32 v98, v98, v54, v55
    v_add3_u32 v98, v98, v56, v57
    v_add3_u32 v98, v98, v58, v59
    v_add3_u32 v98, v98, v60, v61
    v_sad_u32 v98, v98, v62, v63
    s_setprio 0
    v_fmac_f32 v129, v16, v97
    v_add_u32 v99, v64, v65
    v_add_f32 v15, v15, v17
    v_fmac_f32_e64 v14, v17, v126
    v_fmac_f32 v14, v17, v127
    s_waitcnt lgkmcnt(1)
    v_pk_mul_f16 v115, v219, v187
    v_mfma_f32_32x32x16_f16 v[48:63], v[80:83], v[108:111], v[32:47]
    s_setprio 1
    v_exp_f32 v17, v129
    v_pk_mul_f16 v116, v236, v180
    v_pk_mul_f16 v117, v237, v181
    v_pk_mul_f16 v118, v238, v182
    v_pk_mul_f16 v119, v239, v183
    v_mfma_f32_32x32x16_f16 v[48:63], v[84:87], v[112:115], v[48:63]
    v_sad_u32 v99, v99, v66, v67
    v_add3_u32 v99, v99, v68, v69
    v_sad_u32 v99, v99, v70, v71
    v_add3_u32 v99, v99, v72, v73
    v_add3_u32 v99, v99, v74, v75
    v_add3_u32 v99, v99, v76, v77
    v_smfmac_f32_16x16x64_f16 v[252:255], v[88:91], v[108:115], v1
    ds_read_b128 v[124:127], v11 offset:2048
    v_sad_u32 v99, v99, v78, v79
    v_mfma_f32_32x32x16_f16 v[64:79], v[80:83], v[116:119], v[32:47]
    v_pk_mul_f16 v120, v240, v184
    v_pk_mul_f16 v121, v241, v185
    v_pk_mul_f16 v122, v242, v186
    v_pk_mul_f16 v123, v243, v187
    v_pk_mul_f16 v108, v188, v236
    v_pk_mul_f16 v109, v189, v237
    v_mfma_f32_32x32x16_f16 v[64:79], v[84:87], v[120:123], v[64:79]
    v_permlane32_swap_b32_e64 v98, v99
    v_add3_u32 v16, v98, v99, v132
    v_pk_mul_f16 v110, v190, v238
    v_pk_mul_f16 v111, v191, v239
    v_pk_mul_f16 v112, v192, v240
    v_smfmac_f32_16x16x64_f16 v[252:255], v[92:95], v[116:123], v1
    ds_read_b128 v[228:231], v6 offset:8832
    v_pk_mul_f16 v113, v193, v241
    v_pk_mul_f16 v114, v194, v242
    v_add_u32_e64 v98, v48, v49
    v_sad_u32 v98, v98, v50, v51
    v_add3_u32 v98, v98, v52, v53
    v_sad_u32 v98, v98, v54, v55
    v_add3_u32 v98, v98, v56, v57
    v_add3_u32 v98, v98, v58, v59
    v_add3_u32 v98, v98, v60, v61
    v_sad_u32 v98, v98, v62, v63
    s_setprio 0
    v_fmac_f32 v133, v16, v97
    v_add_u32 v99, v64, v65
    v_add_f32 v15, v15, v17
    v_fmac_f32_e64 v14, v17, v130
    v_fmac_f32 v14, v17, v131
    s_waitcnt lgkmcnt(1)
    v_pk_mul_f16 v115, v195, v243
    v_mfma_f32_32x32x16_f16 v[48:63], v[80:83], v[108:111], v[32:47]
    s_setprio 1
    v_exp_f32 v17, v133
    v_pk_mul_f16 v116, v188, v212
    v_pk_mul_f16 v117, v189, v213
    v_pk_mul_f16 v118, v190, v214
    v_pk_mul_f16 v119, v191, v215
    v_mfma_f32_32x32x16_f16 v[48:63], v[84:87], v[112:115], v[48:63]
    v_sad_u32 v99, v99, v66, v67
    v_add3_u32 v99, v99, v68, v69
    v_sad_u32 v99, v99, v70, v71
    v_add3_u32 v99, v99, v72, v73
    v_add3_u32 v99, v99, v74, v75
    v_add3_u32 v99, v99, v76, v77
    v_smfmac_f32_16x16x64_f16 v[124:127], v[88:91], v[108:115], v1
    ds_read_b128 v[128:131], v11 offset:2048
    v_sad_u32 v99, v99, v78, v79
    v_mfma_f32_32x32x16_f16 v[64:79], v[80:83], v[116:119], v[32:47]
    v_pk_mul_f16 v120, v192, v216
    v_pk_mul_f16 v121, v193, v217
    v_pk_mul_f16 v122, v194, v218
    v_pk_mul_f16 v123, v195, v219
    v_pk_mul_f16 v108, v196, v180
    v_pk_mul_f16 v109, v197, v181
    v_mfma_f32_32x32x16_f16 v[64:79], v[84:87], v[120:123], v[64:79]
    v_permlane32_swap_b32_e64 v98, v99
    v_add3_u32 v16, v98, v99, v252
    v_pk_mul_f16 v110, v198, v182
    v_pk_mul_f16 v111, v199, v183
    v_pk_mul_f16 v112, v200, v184
    v_smfmac_f32_16x16x64_f16 v[124:127], v[92:95], v[116:123], v1
    ds_read_b128 v[232:235], v6 offset:12992
    v_pk_mul_f16 v113, v201, v185
    v_pk_mul_f16 v114, v202, v186
    v_add_u32_e64 v98, v48, v49
    v_sad_u32 v98, v98, v50, v51
    v_add3_u32 v98, v98, v52, v53
    v_sad_u32 v98, v98, v54, v55
    v_add3_u32 v98, v98, v56, v57
    v_add3_u32 v98, v98, v58, v59
    v_add3_u32 v98, v98, v60, v61
    v_sad_u32 v98, v98, v62, v63
    s_setprio 0
    v_fmac_f32 v253, v16, v97
    v_add_u32 v99, v64, v65
    v_add_f32 v15, v15, v17
    v_fmac_f32_e64 v14, v17, v134
    v_fmac_f32 v14, v17, v135
    s_waitcnt lgkmcnt(1)
    v_pk_mul_f16 v115, v203, v187
    v_mfma_f32_32x32x16_f16 v[48:63], v[80:83], v[108:111], v[32:47]
    s_setprio 1
    v_exp_f32 v17, v253
    v_pk_mul_f16 v116, v220, v196
    v_pk_mul_f16 v117, v221, v197
    v_pk_mul_f16 v118, v222, v198
    v_pk_mul_f16 v119, v223, v199
    v_mfma_f32_32x32x16_f16 v[48:63], v[84:87], v[112:115], v[48:63]
    v_sad_u32 v99, v99, v66, v67
    v_add3_u32 v99, v99, v68, v69
    v_sad_u32 v99, v99, v70, v71
    v_add3_u32 v99, v99, v72, v73
    v_add3_u32 v99, v99, v74, v75
    v_add3_u32 v99, v99, v76, v77
    v_smfmac_f32_16x16x64_f16 v[128:131], v[88:91], v[108:115], v1
    ds_read_b128 v[132:135], v11 offset:2048
    v_sad_u32 v99, v99, v78, v79
    v_mfma_f32_32x32x16_f16 v[64:79], v[80:83], v[116:119], v[32:47]
    v_pk_mul_f16 v120, v224, v200
    v_pk_mul_f16 v121, v225, v201
    v_pk_mul_f16 v122, v226, v202
    v_pk_mul_f16 v123, v227, v203
    v_pk_mul_f16 v108, v244, v196
    v_pk_mul_f16 v109, v245, v197
    v_mfma_f32_32x32x16_f16 v[64:79], v[84:87], v[120:123], v[64:79]
    v_permlane32_swap_b32_e64 v98, v99
    v_add3_u32 v16, v98, v99, v124
    v_pk_mul_f16 v110, v246, v198
    v_pk_mul_f16 v111, v247, v199
    v_pk_mul_f16 v112, v248, v200
    v_smfmac_f32_16x16x64_f16 v[128:131], v[92:95], v[116:123], v1
    ds_read_b128 v[188:191], v7 offset:9344
    v_pk_mul_f16 v113, v249, v201
    v_pk_mul_f16 v114, v250, v202
    v_add_u32_e64 v98, v48, v49
    v_sad_u32 v98, v98, v50, v51
    v_add3_u32 v98, v98, v52, v53
    v_sad_u32 v98, v98, v54, v55
    v_add3_u32 v98, v98, v56, v57
    v_add3_u32 v98, v98, v58, v59
    v_add3_u32 v98, v98, v60, v61
    v_sad_u32 v98, v98, v62, v63
    s_setprio 0
    v_fmac_f32 v125, v16, v97
    v_add_u32 v99, v64, v65
    v_add_f32 v15, v15, v17
    v_fmac_f32_e64 v14, v17, v254
    v_fmac_f32 v14, v17, v255
    s_waitcnt lgkmcnt(1)
    v_pk_mul_f16 v115, v251, v203
    v_mfma_f32_32x32x16_f16 v[48:63], v[80:83], v[108:111], v[32:47]
    s_setprio 1
    v_exp_f32 v17, v125
    v_pk_mul_f16 v116, v204, v196
    v_pk_mul_f16 v117, v205, v197
    v_pk_mul_f16 v118, v206, v198
    v_pk_mul_f16 v119, v207, v199
    v_mfma_f32_32x32x16_f16 v[48:63], v[84:87], v[112:115], v[48:63]
    v_sad_u32 v99, v99, v66, v67
    v_add3_u32 v99, v99, v68, v69
    v_sad_u32 v99, v99, v70, v71
    v_add3_u32 v99, v99, v72, v73
    v_add3_u32 v99, v99, v74, v75
    v_add3_u32 v99, v99, v76, v77
    v_smfmac_f32_16x16x64_f16 v[132:135], v[88:91], v[108:115], v1
    ds_read_b128 v[252:255], v11 offset:2048
    v_sad_u32 v99, v99, v78, v79
    v_mfma_f32_32x32x16_f16 v[64:79], v[80:83], v[116:119], v[32:47]
    v_pk_mul_f16 v120, v208, v200
    v_pk_mul_f16 v121, v209, v201
    v_pk_mul_f16 v122, v210, v202
    v_pk_mul_f16 v123, v211, v203
    v_pk_mul_f16 v108, v212, v196
    v_pk_mul_f16 v109, v213, v197
    v_mfma_f32_32x32x16_f16 v[64:79], v[84:87], v[120:123], v[64:79]
    v_permlane32_swap_b32_e64 v98, v99
    v_add3_u32 v16, v98, v99, v128
    v_pk_mul_f16 v110, v214, v198
    v_pk_mul_f16 v111, v215, v199
    v_pk_mul_f16 v112, v216, v200
    v_smfmac_f32_16x16x64_f16 v[132:135], v[92:95], v[116:123], v1
    ds_read_b128 v[192:195], v7 offset:13504
    v_pk_mul_f16 v113, v217, v201
    v_pk_mul_f16 v114, v218, v202
    v_add_u32_e64 v98, v48, v49
    v_sad_u32 v98, v98, v50, v51
    v_add3_u32 v98, v98, v52, v53
    v_sad_u32 v98, v98, v54, v55
    v_add3_u32 v98, v98, v56, v57
    v_add3_u32 v98, v98, v58, v59
    v_add3_u32 v98, v98, v60, v61
    v_sad_u32 v98, v98, v62, v63
    s_setprio 0
    v_fmac_f32 v129, v16, v97
    v_add_u32 v99, v64, v65
    v_add_f32 v15, v15, v17
    v_fmac_f32_e64 v14, v17, v126
    v_fmac_f32 v14, v17, v127
    s_waitcnt lgkmcnt(1)
    v_pk_mul_f16 v115, v219, v203
    v_mfma_f32_32x32x16_f16 v[48:63], v[80:83], v[108:111], v[32:47]
    s_setprio 1
    v_exp_f32 v17, v129
    v_pk_mul_f16 v116, v236, v196
    v_pk_mul_f16 v117, v237, v197
    v_pk_mul_f16 v118, v238, v198
    v_pk_mul_f16 v119, v239, v199
    v_mfma_f32_32x32x16_f16 v[48:63], v[84:87], v[112:115], v[48:63]
    v_sad_u32 v99, v99, v66, v67
    v_add3_u32 v99, v99, v68, v69
    v_sad_u32 v99, v99, v70, v71
    v_add3_u32 v99, v99, v72, v73
    v_add3_u32 v99, v99, v74, v75
    v_add3_u32 v99, v99, v76, v77
    v_smfmac_f32_16x16x64_f16 v[252:255], v[88:91], v[108:115], v1
    ds_read_b128 v[124:127], v11 offset:2048
    v_sad_u32 v99, v99, v78, v79
    v_mfma_f32_32x32x16_f16 v[64:79], v[80:83], v[116:119], v[32:47]
    v_pk_mul_f16 v120, v240, v200
    v_pk_mul_f16 v121, v241, v201
    v_pk_mul_f16 v122, v242, v202
    v_pk_mul_f16 v123, v243, v203
    v_pk_mul_f16 v108, v228, v212
    v_pk_mul_f16 v109, v229, v213
    v_mfma_f32_32x32x16_f16 v[64:79], v[84:87], v[120:123], v[64:79]
    v_permlane32_swap_b32_e64 v98, v99
    v_add3_u32 v16, v98, v99, v132
    v_pk_mul_f16 v110, v230, v214
    v_pk_mul_f16 v111, v231, v215
    v_pk_mul_f16 v112, v232, v216
    v_smfmac_f32_16x16x64_f16 v[252:255], v[92:95], v[116:123], v1
    v_pk_mul_f16 v113, v233, v217
    v_pk_mul_f16 v114, v234, v218
    v_add_u32_e64 v98, v48, v49
    v_sad_u32 v98, v98, v50, v51
    v_add3_u32 v98, v98, v52, v53
    v_sad_u32 v98, v98, v54, v55
    v_add3_u32 v98, v98, v56, v57
    v_add3_u32 v98, v98, v58, v59
    v_add3_u32 v98, v98, v60, v61
    v_sad_u32 v98, v98, v62, v63
    s_setprio 0
    v_fmac_f32 v133, v16, v97
    v_add_u32 v99, v64, v65
    v_add_f32 v15, v15, v17
    v_fmac_f32_e64 v14, v17, v130
    v_fmac_f32 v14, v17, v131
    s_waitcnt lgkmcnt(0)
    v_pk_mul_f16 v115, v235, v219
    v_mfma_f32_32x32x16_f16 v[48:63], v[80:83], v[108:111], v[32:47]
    s_setprio 1
    v_exp_f32 v17, v133
    v_pk_mul_f16 v116, v188, v236
    v_pk_mul_f16 v117, v189, v237
    v_pk_mul_f16 v118, v190, v238
    v_pk_mul_f16 v119, v191, v239
    v_mfma_f32_32x32x16_f16 v[48:63], v[84:87], v[112:115], v[48:63]
    v_sad_u32 v99, v99, v66, v67
    v_add3_u32 v99, v99, v68, v69
    v_sad_u32 v99, v99, v70, v71
    v_add3_u32 v99, v99, v72, v73
    v_add3_u32 v99, v99, v74, v75
    v_add3_u32 v99, v99, v76, v77
    v_smfmac_f32_16x16x64_f16 v[124:127], v[88:91], v[108:115], v1
    v_sad_u32 v99, v99, v78, v79
    v_mfma_f32_32x32x16_f16 v[64:79], v[80:83], v[116:119], v[32:47]
    v_pk_mul_f16 v120, v192, v240
    v_pk_mul_f16 v121, v193, v241
    v_pk_mul_f16 v122, v194, v242
    v_pk_mul_f16 v123, v195, v243
    v_permlane32_swap_b32_e64 v98, v99
    v_add3_u32 v16, v98, v99, v252
    v_mfma_f32_32x32x16_f16 v[64:79], v[84:87], v[120:123], v[64:79]
    v_fmac_f32 v253, v16, v97
    v_add_f32 v15, v15, v17
    v_fmac_f32 v14, v17, v134
    v_fmac_f32 v14, v17, v135
    v_exp_f32_e64 v17, v253
    v_smfmac_f32_16x16x64_f16 v[124:127], v[92:95], v[116:123], v1
    v_add_u32_e64 v98, v48, v49
    v_sad_u32 v98, v98, v50, v51
    v_add3_u32 v98, v98, v52, v53
    v_sad_u32 v98, v98, v54, v55
    v_add3_u32 v98, v98, v56, v57
    v_add3_u32 v98, v98, v58, v59
    v_add3_u32 v98, v98, v60, v61
    v_sad_u32 v98, v98, v62, v63
    v_add_u32_e64 v99, v64, v65
    v_sad_u32 v99, v99, v66, v67
    v_add3_u32 v99, v99, v68, v69
    v_sad_u32 v99, v99, v70, v71
    v_add3_u32 v99, v99, v72, v73
    v_add3_u32 v99, v99, v74, v75
    v_add3_u32 v99, v99, v76, v77
    v_sad_u32 v99, v99, v78, v79
    v_add_f32 v15, v15, v17
    v_fmac_f32 v14, v17, v254
    v_fmac_f32 v14, v17, v255
    v_permlane32_swap_b32 v98, v99
    v_add3_u32 v16, v98, v99, v124
    v_fmac_f32 v125, v16, v97
    v_exp_f32 v17, v125
    s_nop 0
    v_add_f32 v15, v15, v17
    v_fmac_f32 v14, v17, v126
    v_fmac_f32 v14, v17, v127
    v_permlane32_swap_b32 v19, v15
    s_nop 0
    v_permlane32_swap_b32 v18, v14
    v_add_f32 v15, v19, v15
    v_add_f32 v14, v18, v14
    v_add_f32 v15, v21, v15
    v_add_f32 v14, v20, v14
    s_nop 0
    v_add_f32_dpp v15, v15, v15 quad_perm:[1,0,3,2] row_mask:0xf bank_mask:0xf
    v_add_f32_dpp v14, v14, v14 quad_perm:[1,0,3,2] row_mask:0xf bank_mask:0xf
    s_nop 0
    v_add_f32_dpp v15, v15, v15 quad_perm:[2,3,0,1] row_mask:0xf bank_mask:0xf
    v_add_f32_dpp v14, v14, v14 quad_perm:[2,3,0,1] row_mask:0xf bank_mask:0xf
    s_nop 0
    v_add_f32_dpp v15, v15, v15 row_half_mirror row_mask:0xf bank_mask:0xf
    v_add_f32_dpp v14, v14, v14 row_half_mirror row_mask:0xf bank_mask:0xf
    v_rcp_f32 v19, v15
    s_mov_b64 exec, s[30:31]
    v_mul_f32 v14, 0x37800000, v14
    v_mul_f32 v14, v14, v19
    v_cvt_pk_bf16_f32 v16, v14, v14
    global_store_short v23, v16, s[16:17]
    v_subrev_u32 v15, 528482304, v15
    s_movk_i32 s18, 0x207
    v_cmp_lt_u32 vcc, 1375731712, v15
    v_cmp_class_f32_e64 s[36:37], v14, s18
    s_cmp_lg_u32 s34, 0
    s_cbranch_scc1 L_slow
    s_or_b64 s[36:37], vcc, s[36:37]
    s_cbranch_scc1 L_slow
L_end:
    s_endpgm
L_y2:
    s_cmpk_gt_u32 s38, 384
    s_cbranch_scc1 L_y3
    s_cmpk_eq_u32 s38, 320
    s_cbranch_scc1 L_y2l
    v_bfm_b32 v235, v234, 0
    s_waitcnt vmcnt(2)
    v_cmp_lt_u32 vcc, 0x7fff, v233
    s_nop 0
    s_bcnt1_i32_b32 s85, vcc_lo
    s_not_b32 s84, vcc_lo
    s_sub_u32 s18, 32, s85
    s_mov_b32 s86, 0x80000000
    s_cmp_ge_u32 s85, 16
    s_cselect_b32 s84, vcc_lo, s84
    s_cselect_b32 s85, s85, s18
    s_cselect_b32 s86, 0x00000000, s86
    v_and_b32 v237, s84, v235
    s_mov_b32 s36, s84
    v_bcnt_u32_b32 v236, v237, 0
    s_mov_b32 s37, s84
    v_sub_u32 v237, v234, v236
    v_add_u32 v237, s85, v237
    v_cndmask_b32_e64 v236, v237, v236, s[36:37]
    v_and_or_b32 v236, v0, 32, v236
    v_lshl_or_b32 v240, v233, 16, v234
    v_lshlrev_b32 v236, 2, v236
    ds_permute_b32 v240, v236, v240
    s_mov_b32 s82, 60312
    s_mov_b32 s83, 310
    s_mov_b32 s90, 0x0c000000
    s_cmp_gt_u32 s85, 20
    s_cselect_b32 s18, 20, 14
    s_cselect_b32 s90, 0x0b0f0800, s90
    s_cselect_b32 s94, s83, s82
    s_sub_u32 s88, s85, s18
    s_min_u32 s87, s88, 3
    s_sub_u32 s88, s88, s87
    s_mov_b32 s89, 0x0b0f0800
    s_movk_i32 s19, 0x400
    s_bitcmp1_b32 s87, 0
    s_cselect_b32 s18, 3, 4
    s_or_b32 s89, s89, s18
    s_bitcmp1_b32 s87, 1
    s_cselect_b32 s18, 0x308, s19
    s_or_b32 s89, s89, s18
    s_lshl_b32 s87, s87, 2
    s_lshr_b32 s93, s83, s87
    s_and_b32 s91, s93, 15
    s_mul_i32 s91, s91, 0x800204
    s_and_b32 s91, s91, 0x04000c04
    s_bitcmp1_b32 s88, 0
    s_cselect_b32 s18, 3, 4
    s_or_b32 s90, s90, s18
    s_bitcmp1_b32 s88, 1
    s_cselect_b32 s18, 0x308, s19
    s_or_b32 s90, s90, s18
    s_lshl_b32 s88, s88, 2
    s_lshr_b32 s94, s94, s88
    s_and_b32 s92, s94, 15
    s_mul_i32 s92, s92, 0x800204
    s_and_b32 s92, s92, 0x04000c04
    s_lshl4_add_u32 s89, s90, s89
    v_and_b32 v237, s89, v235
    s_mov_b32 s36, s89
    v_bcnt_u32_b32 v238, v237, 0
    s_mov_b32 s37, s89
    v_sub_u32 v237, v234, v238
    v_add_u32 v237, s85, v237
    v_cndmask_b32_e64 v238, v237, v238, s[36:37]
    s_lshl4_add_u32 s32, s92, s91
    v_lshlrev_b32 v238, 2, v238
    s_or_b32 s32, s32, 0x88
    s_waitcnt lgkmcnt(0)
    ds_bpermute_b32 v240, v238, v240
    s_mov_b32 s33, s32
    s_bcnt1_i32_b32 s94, s32
    s_mul_i32 s93, s85, 2701131776
    s_lshl_b32 s94, s94, 31
    s_sub_u32 s93, 1233125376, s93
    s_xor_b32 s86, s86, s94
    s_xor_b32 s86, s86, s93
    s_cmp_gt_u32 s85, 26
    s_cselect_b32 s86, -1, s86
    v_lshrrev_b32 v238, 2, v226
    s_waitcnt lgkmcnt(0)
    v_bfe_u32 v239, v240, 1, 4
    v_lshlrev_b32 v236, 4, v240
    v_or_b32 v237, 0x80000000, v240
    v_and_b32 v240, 0x7fffffff, v240
    v_sub_u32 v239, v239, v238
    v_cndmask_b32_e64 v240, v237, v240, s[32:33]
    v_lshrrev_b32 v240, 16, v240
    v_lshlrev_b32 v240, v236, v240
    v_cmp_eq_u32_e64 s[30:31], 0, v239
    v_cmp_eq_u32_e64 s[32:33], 1, v239
    v_cmp_eq_u32_e64 s[36:37], 2, v239
    v_cmp_eq_u32_e64 s[82:83], 3, v239
    v_cndmask_b32_e64 v196, 0, v240, s[30:31]
    v_cndmask_b32_e64 v197, 0, v240, s[32:33]
    v_cndmask_b32_e64 v198, 0, v240, s[36:37]
    v_cndmask_b32_e64 v199, 0, v240, s[82:83]
    v_cmp_eq_u32_e64 s[30:31], 8, v239
    v_cmp_eq_u32_e64 s[32:33], 9, v239
    v_cmp_eq_u32_e64 s[36:37], 10, v239
    v_cmp_eq_u32_e64 s[82:83], 11, v239
    v_cndmask_b32_e64 v200, 0, v240, s[30:31]
    v_cndmask_b32_e64 v201, 0, v240, s[32:33]
    v_cndmask_b32_e64 v202, 0, v240, s[36:37]
    v_cndmask_b32_e64 v203, 0, v240, s[82:83]
    s_cmpk_eq_u32 s38, 384
    s_waitcnt vmcnt(0)
    s_cbranch_scc1 L_y2c
    v_mfma_f32_32x32x16_bf16 v[64:79], v[180:183], v[196:199], 0
    v_mfma_f32_32x32x16_bf16 v[64:79], v[184:187], v[200:203], v[64:79]
    s_mov_b32 s18, 0x4338aa3b
    s_mov_b32 s19, 0x3c317218
    s_mov_b32 s93, 0x4119b65b
    s_nop 8
    v_cmp_le_f32_e64 vcc, s19, |v64|
    v_mul_f32 v48, s18, v64
    v_mul_f32 v49, s18, v65
    s_cmp_eq_u64 vcc, 0
    s_cselect_b32 s86, -1, s86
    v_cvt_pk_bf16_f32 v80, v48, v49
    v_mul_f32 v50, s18, v66
    v_mul_f32 v51, s18, v67
    v_cvt_pk_bf16_f32 v81, v50, v51
    v_mul_f32 v52, s18, v68
    v_mul_f32 v53, s18, v69
    v_mfma_f32_4x4x4_16b_bf16 v[48:51], v[100:101], v[80:81], 0
    v_cvt_pk_bf16_f32 v82, v52, v53
    v_mul_f32 v54, s18, v70
    v_mul_f32 v55, s18, v71
    v_cvt_pk_bf16_f32 v83, v54, v55
    v_mul_f32 v56, s18, v72
    v_mul_f32 v57, s18, v73
    v_mfma_f32_4x4x4_16b_bf16 v[52:55], v[100:101], v[82:83], 0
    v_cvt_pk_bf16_f32 v84, v56, v57
    v_mul_f32 v58, s18, v74
    v_mul_f32 v59, s18, v75
    v_cvt_pk_bf16_f32 v85, v58, v59
    v_mul_f32 v60, s18, v76
    v_mul_f32 v61, s18, v77
    v_mfma_f32_4x4x4_16b_bf16 v[56:59], v[100:101], v[84:85], 0
    v_cvt_pk_bf16_f32 v86, v60, v61
    v_mul_f32 v62, s18, v78
    v_mul_f32 v63, s18, v79
    v_cvt_pk_bf16_f32 v87, v62, v63
    v_add_f32_e64 v244, |v64|, |v65|
    v_cvt_pk_f16_f32 v80, v48, v49
    v_add_f32_e64 v244, |v66|, v244
    v_add_f32_e64 v244, |v67|, v244
    v_mfma_f32_4x4x4_16b_bf16 v[60:63], v[100:101], v[86:87], 0
    v_cvt_pk_f16_f32 v81, v50, v51
    v_add_f32_e64 v244, |v68|, v244
    v_add_f32_e64 v244, |v69|, v244
    v_cvt_pk_f16_f32 v82, v52, v53
    v_add_f32_e64 v244, |v70|, v244
    v_add_f32_e64 v244, |v71|, v244
    v_cvt_pk_f16_f32 v83, v54, v55
    ds_write_b128 v21, v[80:83] offset:0
    v_add_f32_e64 v244, |v72|, v244
    v_add_f32_e64 v244, |v73|, v244
    v_cvt_pk_f16_f32 v84, v56, v57
    v_add_f32_e64 v244, |v74|, v244
    v_add_f32_e64 v244, |v75|, v244
    v_cvt_pk_f16_f32 v85, v58, v59
    v_add_f32_e64 v244, |v76|, v244
    v_add_f32_e64 v244, |v77|, v244
    v_cvt_pk_f16_f32 v86, v60, v61
    v_add_f32_e64 v244, |v78|, v244
    v_add_f32_e64 v244, |v79|, v244
    v_cmp_nlt_f32_e64 vcc, v244, s93
    v_cvt_pk_f16_f32 v87, v62, v63
    s_cmp_eq_u64 vcc, 0
    s_cselect_b32 s86, s86, -1
    v_mov_b32 v97, s86
    ds_write_b128 v21, v[84:87] offset:1024
    ds_write_b32 v21, v97 offset:6148
    s_branch L_y3
L_y2c:
    v_mfma_f32_32x32x16_bf16 v[32:47], v[196:199], v[180:183], 0
    v_mfma_f32_32x32x16_bf16 v[32:47], v[200:203], v[184:187], v[32:47]
    s_mov_b32 s82, 0
    s_mov_b32 s83, -1
    v_mov_b32 v241, s91
    v_mov_b32 v237, s92
    v_mov_b32 v243, 1350565888
    v_cndmask_b32_e64 v237, v241, v237, s[82:83]
    s_mov_b32 s94, 0x432fabd5
    s_mov_b32 s89, 0x4ab8aa3b
    v_lshrrev_b32 v235, 2, v237
    v_lshl_or_b32 v235, v235, 31, v243
    v_lshrrev_b32 v236, 10, v237
    v_lshl_or_b32 v236, v236, 31, v243
    v_lshrrev_b32 v238, 11, v237
    v_lshl_or_b32 v238, v238, 31, v243
    v_lshrrev_b32 v239, 26, v237
    v_lshl_or_b32 v239, v239, 31, v243
    v_add_f32_e64 v245, |v32|, |v33|
    v_fma_f32 v32, v32, s89, v243
    v_fma_f32 v33, v33, s89, v243
    v_add_f32_e64 v245, |v34|, v245
    v_add_f32_e64 v245, |v35|, v245
    v_fma_f32 v34, v34, s89, v235
    v_fma_f32 v35, v35, s89, -v243
    ds_write_b128 v21, v[32:35] offset:2048
    v_add_f32_e64 v245, |v36|, v245
    v_add_f32_e64 v245, |v37|, v245
    v_fma_f32 v36, v36, s89, v243
    v_fma_f32 v37, v37, s89, v243
    v_add_f32_e64 v245, |v38|, v245
    v_add_f32_e64 v245, |v39|, v245
    v_fma_f32 v38, v38, s89, v236
    v_fma_f32 v39, v39, s89, v238
    ds_write_b128 v21, v[36:39] offset:3072
    v_add_f32_e64 v245, |v40|, v245
    v_add_f32_e64 v245, |v41|, v245
    v_fma_f32 v40, v40, s89, v243
    v_fma_f32 v41, v41, s89, v243
    v_add_f32_e64 v245, |v42|, v245
    v_add_f32_e64 v245, |v43|, v245
    v_fma_f32 v42, v42, s89, v243
    v_fma_f32 v43, v43, s89, v243
    ds_write_b128 v21, v[40:43] offset:4096
    v_add_f32_e64 v245, |v44|, v245
    v_add_f32_e64 v245, |v45|, v245
    v_fma_f32 v44, v44, s89, v243
    v_fma_f32 v45, v45, s89, v243
    v_add_f32_e64 v245, |v46|, v245
    v_add_f32_e64 v245, |v47|, v245
    v_cmp_nlt_f32_e64 vcc, v245, s94
    v_fma_f32 v46, v46, s89, v239
    v_fma_f32 v47, v47, s89, v243
    s_cmp_eq_u64 vcc, 0
    s_cselect_b32 s18, 1.0, -1
    v_mov_b32 v245, s18
    ds_write_b128 v21, v[44:47] offset:5120
    ds_write_b32 v21, v245 offset:6144
    s_branch L_y3
L_y2l:
    s_waitcnt vmcnt(4)
    v_cmp_lt_u32 vcc, 0x7fff, v233
    s_nop 0
    s_bcnt1_i32_b32 s85, vcc_lo
    s_not_b32 s84, vcc_lo
    s_sub_u32 s18, 32, s85
    s_mov_b32 s86, 0xbf800000
    s_cmp_ge_u32 s85, 16
    s_cselect_b32 s84, vcc_lo, s84
    s_cselect_b32 s85, s85, s18
    s_cselect_b32 s86, 0x3f800000, s86
    s_waitcnt vmcnt(2)
    v_mfma_f32_4x4x4_16b_bf16 v[108:111], v[100:101], v[204:205], 0
    v_mfma_f32_4x4x4_16b_bf16 v[112:115], v[100:101], v[206:207], 0
    v_cndmask_b32_e64 v235, v208, v209, s[24:25]
    v_cndmask_b32_e64 v236, v210, v211, s[24:25]
    s_waitcnt vmcnt(0)
    s_mov_b32 s18, 0x3ab8aa3b
    v_mfma_f32_4x4x4_16b_bf16 v[64:67], v[100:101], v[196:197], 0
    v_mov_b32 v204, 0x3f803f80
    v_mfma_f32_4x4x4_16b_bf16 v[68:71], v[100:101], v[198:199], 0
    v_mov_b32 v205, 0x3f803f80
    v_mfma_f32_4x4x4_16b_bf16 v[72:75], v[100:101], v[200:201], 0
    v_mov_b32 v206, 0x3f803f80
    v_mfma_f32_4x4x4_16b_bf16 v[76:79], v[100:101], v[202:203], 0
    v_mov_b32 v207, 0x3f803f80
    v_mul_f32 v108, s18, v108
    v_mul_f32 v109, s18, v109
    v_mul_f32 v110, s18, v110
    v_mul_f32 v111, s18, v111
    v_mul_f32 v112, s18, v112
    v_mul_f32 v113, s18, v113
    v_mul_f32 v114, s18, v114
    v_mul_f32 v115, s18, v115
    v_mul_f32 v64, v64, v108
    v_mul_f32 v65, v65, v109
    v_cvt_pk_bf16_f32 v196, v64, v65
    v_mul_f32 v66, v66, v110
    v_mul_f32 v67, v67, v111
    v_cvt_pk_bf16_f32 v197, v66, v67
    v_mul_f32 v68, v68, v112
    v_mul_f32 v69, v69, v113
    v_cvt_pk_bf16_f32 v198, v68, v69
    v_mul_f32 v70, v70, v114
    v_mul_f32 v71, v71, v115
    v_cvt_pk_bf16_f32 v199, v70, v71
    v_mul_f32 v72, v72, v108
    v_mul_f32 v73, v73, v109
    v_cvt_pk_bf16_f32 v200, v72, v73
    v_mul_f32 v74, v74, v110
    v_mul_f32 v75, v75, v111
    v_cvt_pk_bf16_f32 v201, v74, v75
    v_mul_f32 v76, v76, v112
    v_mul_f32 v77, v77, v113
    v_cvt_pk_bf16_f32 v202, v76, v77
    v_mul_f32 v78, v78, v114
    v_mul_f32 v79, v79, v115
    v_cvt_pk_bf16_f32 v203, v78, v79
    v_mfma_f32_16x16x32_bf16 v[212:215], v[196:199], v[204:207], 0
    s_nop 0
    v_mfma_f32_16x16x32_bf16 v[216:219], v[200:203], v[204:207], 0
    v_lshlrev_b32 v238, 16, v235
    v_and_b32 v239, 0xffff0000, v235
    v_lshlrev_b32 v240, 16, v236
    v_and_b32 v241, 0xffff0000, v236
    v_mov_b32 v242, 0xc0800000
    v_mov_b32 v237, 0xba800000
    v_mul_f32 v242, s86, v242
    v_mov_b32 v49, 0xc5c00000
    v_cndmask_b32_e64 v242, v242, v237, s[24:25]
    v_mov_b32 v237, 0x42800000
    v_mov_b32 v48, 0x4bc00000
    v_cndmask_b32_e64 v242, v242, v237, s[26:27]
    v_mov_b64 v[50:51], 0
    v_cndmask_b32_e64 v212, v212, v216, s[24:25]
    v_cndmask_b32_e64 v212, v212, v238, s[26:27]
    v_cndmask_b32_e64 v213, v213, v217, s[24:25]
    v_cndmask_b32_e64 v213, v213, v239, s[26:27]
    v_cndmask_b32_e64 v214, v214, v218, s[24:25]
    v_cndmask_b32_e64 v214, v214, v240, s[26:27]
    v_cndmask_b32_e64 v215, v215, v219, s[24:25]
    v_cndmask_b32_e64 v215, v215, v241, s[26:27]
    v_add_f32_e64 v243, |v212|, |v213|
    v_add_f32_e64 v237, |v214|, |v215|
    s_mov_b32 s18, 0x41ddc28f
    v_add_f32 v243, v243, v237
    s_mov_b32 s19, 0x3a800000
    v_mov_b32 v237, v243
    v_mul_f32 v212, v242, v212
    v_mul_f32 v213, v242, v213
    v_permlane32_swap_b32 v243, v237
    v_add_f32 v243, v243, v237
    v_mov_b32 v237, v243
    v_mul_f32 v214, v242, v214
    v_mul_f32 v215, v242, v215
    v_permlane16_swap_b32 v243, v237
    v_add_f32 v243, v243, v237
    v_cvt_pk_f16_f32 v235, v212, v213
    v_cmp_nlt_f32_e64 vcc, v243, s18
    v_cmp_le_f32_e64 s[32:33], s19, v243
    v_cvt_pk_f16_f32 v236, v214, v215
    s_andn2_b64 vcc, vcc, s[26:27]
    s_cselect_b32 s86, -1, s86
    s_and_b64 vcc, s[32:33], s[26:27]
    s_cselect_b32 s86, s86, -1
    v_mov_b32 v237, 0xff800000
    v_mul_f32 v49, s86, v49
    v_cmp_eq_u32 vcc, v12, v11
    s_mov_b32 s30, 0x000f000f
    s_mov_b32 s31, s30
    v_cndmask_b32_e64 v88, 0, v235, s[30:31]
    v_cndmask_b32_e64 v89, 0, v236, s[30:31]
    s_lshl_b64 s[32:33], s[30:31], 4
    v_cndmask_b32_e64 v90, 0, v235, s[32:33]
    v_cndmask_b32_e64 v91, 0, v236, s[32:33]
    s_lshl_b64 s[36:37], s[30:31], 8
    v_cndmask_b32_e64 v92, 0, v235, s[36:37]
    v_cndmask_b32_e64 v93, 0, v236, s[36:37]
    s_lshl_b64 s[32:33], s[30:31], 12
    v_cndmask_b32_e64 v94, 0, v235, s[32:33]
    v_cndmask_b32_e64 v95, 0, v236, s[32:33]
    v_cndmask_b32_e64 v49, v237, v49, vcc
    ds_write_b128 v21, v[88:91] offset:7168
    ds_write_b128 v21, v[92:95] offset:8192
    ds_write_b128 v12, v[48:51] offset:2048
L_y3:
    s_waitcnt lgkmcnt(0)
    s_barrier
    ds_read_b128 v[80:83], v21 offset:0
    ds_read_b128 v[84:87], v21 offset:1024
    ds_read_b128 v[32:35], v21 offset:2048
    ds_read_b128 v[36:39], v21 offset:3072
    ds_read_b128 v[40:43], v21 offset:4096
    s_waitcnt lgkmcnt(0)
    global_load_dwordx4 v[24:27], v23, s[4:5] offset:0
    s_waitcnt vmcnt(0)
    ds_read_b128 v[44:47], v21 offset:5120
    ds_read_b64 v[96:97], v21 offset:6144
    ds_read_b128 v[88:91], v21 offset:7168
    ds_read_b128 v[92:95], v21 offset:8192
    s_waitcnt lgkmcnt(0)
    global_load_dword v30, v31, s[4:5] offset:96
    global_load_dwordx2 v[28:29], v23, s[4:5] offset:16
    s_waitcnt vmcnt(0)
    s_setprio 3
    v_lshl_add_u32 v24, v24, 6, v20
    buffer_load_dwordx4 v[136:139], v24, s[20:23], 0 offen
    v_lshl_add_u32 v25, v25, 6, v20
    buffer_load_dwordx4 v[140:143], v25, s[20:23], 0 offen
    v_lshl_add_u32 v30, v30, 6, v20
    buffer_load_dwordx4 v[144:147], v30, s[20:23], 0 offen
    v_lshl_add_u32 v26, v26, 6, v20
    buffer_load_dwordx4 v[148:151], v26, s[20:23], 0 offen
    v_lshl_add_u32 v27, v27, 6, v20
    buffer_load_dwordx4 v[152:155], v27, s[20:23], 0 offen
    s_branch L_p
L_slow:
    s_mov_b64 exec, -1
    s_setprio 0
    s_waitcnt vmcnt(0)
    v_lshrrev_b32 v221, 4, v0
    s_lshl_b32 s18, s2, 6
    v_bfe_u32 v220, v0, 2, 2
    v_add_u32 v221, s18, v221
    v_mul_u32_u24 v221, 104, v221
    v_and_b32 v225, 4, v0
    v_mad_u32_u24 v23, v220, 24, v221
    v_add_u32 v31, v221, v225
    v_and_b32 v222, 3, v0
    v_lshlrev_b32 v20, 4, v222
    global_load_dwordx4 v[24:27], v23, s[4:5] offset:0
    global_load_dword v30, v31, s[4:5] offset:96
    global_load_dwordx2 v[28:29], v23, s[4:5] offset:16
    v_lshrrev_b32 v226, 1, v0
    v_and_b32 v224, 8, v0
    v_and_b32 v228, 19, v0
    v_and_b32 v226, 16, v226
    v_lshl_add_u32 v228, v228, 6, v226
    v_lshl_add_u32 v228, v225, 7, v228
    v_lshl_add_u32 v228, v224, 5, v228
    global_load_dwordx4 v[180:183], v228, s[8:9]
    global_load_dwordx4 v[184:187], v228, s[8:9] offset:32
    global_load_dwordx4 v[188:191], v226, s[10:11]
    global_load_dwordx4 v[192:195], v226, s[10:11] offset:32
    v_and_b32 v227, 48, v0
    global_load_dwordx4 v[204:207], v227, s[12:13]
    global_load_dwordx4 v[208:211], v227, s[14:15]
    v_lshrrev_b32 v230, 6, v0
    s_movk_i32 s18, 2080
    v_mul_u32_u24 v11, 16640, v230
    v_mad_u32_u24 v13, v222, s18, v11
    v_bfe_u32 v230, v0, 4, 2
    v_lshl_add_u32 v13, v220, 4, v13
    v_lshl_add_u32 v13, v230, 7, v13
    v_bfe_u32 v230, v0, 5, 1
    v_mad_u32_u24 v8, v230, s18, v11
    v_and_b32 v230, 24, v0
    v_and_b32 v231, 7, v0
    v_lshl_add_u32 v8, v230, 4, v8
    v_lshl_add_u32 v2, v231, 4, v8
    v_xor_b32 v230, 4, v231
    v_lshl_add_u32 v5, v230, 4, v8
    v_add_u32 v230, 1, v231
    v_and_b32 v230, 7, v230
    v_lshl_add_u32 v3, v230, 4, v8
    v_add_u32 v230, 3, v231
    v_and_b32 v230, 7, v230
    v_lshl_add_u32 v4, v230, 4, v8
    v_lshlrev_b32 v230, 7, v225
    s_mov_b32 s28, 0xf0f0f0f0
    v_add_u32 v6, v5, v230
    s_mov_b32 s29, s28
    v_sub_u32 v7, v5, v230
    v_add_u32 v230, 1536, v8
    s_mov_b32 s31, 0xe0e0e0e0
    v_cndmask_b32_e64 v9, v2, v230, s[28:29]
    v_add_u32 v230, 16, v230
    s_mov_b32 s30, 0
    v_cndmask_b32_e64 v10, v5, v230, s[28:29]
    s_mov_b32 s24, 0xaaaaaaaa
    v_add_u32 v230, 16, v11
    s_mov_b32 s25, s24
    v_cndmask_b32_e64 v12, v11, v230, s[30:31]
    s_mov_b32 s31, -1
    v_cndmask_b32_e64 v22, v11, v230, s[30:31]
    v_mov_b32 v48, 0xff800000
    v_mov_b32 v49, 0
    v_cndmask_b32_e64 v48, 0, v48, s[30:31]
    v_mov_b64 v[50:51], 0
    ds_write_b128 v22, v[48:51] offset:2048
    v_mov_b32 v230, 0x4444
    v_mov_b32 v1, 0xeeee
    s_mov_b32 s26, 0xcccccccc
    v_cndmask_b32_e64 v1, v230, v1, s[24:25]
    v_mov_b32 v230, 16256
    s_mov_b32 s27, s26
    v_lshlrev_b32 v232, 16, v230
    v_cndmask_b32_e64 v232, v230, v232, s[24:25]
    s_mov_b32 s30, 3
    s_mov_b32 s31, 48
    v_cndmask_b32_e64 v100, 0, v232, s[30:31]
    s_lshl_b64 s[32:33], s[30:31], 2
    v_cndmask_b32_e64 v101, 0, v232, s[32:33]
    s_lshl_b64 s[36:37], s[30:31], 8
    v_cndmask_b32_e64 v102, 0, v232, s[36:37]
    s_lshl_b64 s[32:33], s[30:31], 10
    v_cndmask_b32_e64 v103, 0, v232, s[32:33]
    s_lshl_b64 s[36:37], s[30:31], 16
    v_cndmask_b32_e64 v104, 0, v232, s[36:37]
    s_lshl_b64 s[32:33], s[30:31], 18
    v_cndmask_b32_e64 v105, 0, v232, s[32:33]
    s_lshl_b64 s[36:37], s[30:31], 24
    v_cndmask_b32_e64 v106, 0, v232, s[36:37]
    s_lshl_b64 s[32:33], s[30:31], 26
    v_cndmask_b32_e64 v107, 0, v232, s[32:33]
    s_waitcnt vmcnt(8)
    v_lshl_add_u32 v24, v24, 6, v20
    buffer_load_dwordx4 v[136:139], v24, s[20:23], 0 offen
    v_lshl_add_u32 v25, v25, 6, v20
    buffer_load_dwordx4 v[140:143], v25, s[20:23], 0 offen
    s_waitcnt vmcnt(9)
    v_lshl_add_u32 v30, v30, 6, v20
    buffer_load_dwordx4 v[144:147], v30, s[20:23], 0 offen
    v_lshl_add_u32 v26, v26, 6, v20
    buffer_load_dwordx4 v[148:151], v26, s[20:23], 0 offen
    v_lshl_add_u32 v27, v27, 6, v20
    buffer_load_dwordx4 v[152:155], v27, s[20:23], 0 offen
    s_waitcnt vmcnt(11)
    v_lshl_add_u32 v28, v28, 6, v20
    buffer_load_dwordx4 v[156:159], v28, s[20:23], 0 offen
    v_lshl_add_u32 v29, v29, 6, v20
    buffer_load_dwordx4 v[160:163], v29, s[20:23], 0 offen
    s_waitcnt vmcnt(11)
    v_mfma_f32_32x32x16_bf16 v[64:79], v[180:183], v[100:103], 0
    v_mfma_f32_32x32x16_bf16 v[64:79], v[184:187], v[104:107], v[64:79]
    s_waitcnt vmcnt(9)
    v_mfma_f32_32x32x16_bf16 v[32:47], v[100:103], v[188:191], 0
    v_mfma_f32_32x32x16_bf16 v[32:47], v[104:107], v[192:195], v[32:47]
    s_waitcnt vmcnt(7)
    v_cndmask_b32_e64 v234, v204, v205, s[24:25]
    v_cndmask_b32_e64 v236, v208, v209, s[24:25]
    v_cndmask_b32_e64 v235, v206, v207, s[24:25]
    v_cndmask_b32_e64 v237, v210, v211, s[24:25]
    s_mov_b32 s30, 0x00030003
    s_mov_b32 s31, s30
    v_cndmask_b32_e64 v172, 0, v234, s[30:31]
    v_cndmask_b32_e64 v173, 0, v235, s[30:31]
    s_lshl_b64 s[32:33], s[30:31], 4
    v_cndmask_b32_e64 v174, 0, v234, s[32:33]
    v_cndmask_b32_e64 v175, 0, v235, s[32:33]
    s_lshl_b64 s[36:37], s[30:31], 8
    v_cndmask_b32_e64 v176, 0, v234, s[36:37]
    v_cndmask_b32_e64 v177, 0, v235, s[36:37]
    s_lshl_b64 s[32:33], s[30:31], 12
    v_cndmask_b32_e64 v178, 0, v234, s[32:33]
    v_cndmask_b32_e64 v179, 0, v235, s[32:33]
    v_cvt_pk_bf16_f32 v80, v64, v65
    v_cvt_pk_bf16_f32 v81, v66, v67
    v_cvt_pk_bf16_f32 v82, v68, v69
    v_cvt_pk_bf16_f32 v83, v70, v71
    v_cvt_pk_bf16_f32 v84, v72, v73
    v_cvt_pk_bf16_f32 v85, v74, v75
    v_cvt_pk_bf16_f32 v86, v76, v77
    v_cvt_pk_bf16_f32 v87, v78, v79
    s_mov_b32 s30, 0x000c000c
    s_mov_b32 s31, s30
    v_cndmask_b32_e64 v88, 0, v236, s[30:31]
    v_cndmask_b32_e64 v89, 0, v237, s[30:31]
    s_lshl_b64 s[32:33], s[30:31], 4
    v_cndmask_b32_e64 v90, 0, v236, s[32:33]
    v_cndmask_b32_e64 v91, 0, v237, s[32:33]
    s_lshl_b64 s[36:37], s[30:31], 8
    v_cndmask_b32_e64 v92, 0, v236, s[36:37]
    v_cndmask_b32_e64 v93, 0, v237, s[36:37]
    s_lshl_b64 s[32:33], s[30:31], 12
    v_cndmask_b32_e64 v94, 0, v236, s[32:33]
    v_cndmask_b32_e64 v95, 0, v237, s[32:33]
    s_mov_b32 s35, 0
L_job_x:
    ds_read_b128 v[124:127], v11 offset:2048
    ds_read_b128 v[128:131], v11 offset:2048
    ds_read_b128 v[132:135], v12 offset:2048
    s_waitcnt vmcnt(6)
    ds_write_b128 v13, v[136:139] offset:0
    s_waitcnt vmcnt(5)
    ds_write_b128 v13, v[140:143] offset:64
    s_waitcnt vmcnt(4)
    ds_write_b128 v13, v[144:147] offset:1536
    s_waitcnt vmcnt(3)
    ds_write_b128 v13, v[148:151] offset:512
    s_waitcnt vmcnt(2)
    ds_write_b128 v13, v[152:155] offset:576
    s_waitcnt vmcnt(1)
    ds_write_b128 v13, v[156:159] offset:1024
    s_waitcnt vmcnt(0)
    ds_write_b128 v13, v[160:163] offset:1088
    ds_read_b128 v[180:183], v2 offset:0
    ds_read_b128 v[184:187], v2 offset:4160
    ds_read_b128 v[188:191], v3 offset:0
    ds_read_b128 v[192:195], v3 offset:4160
    ds_read_b128 v[196:199], v4 offset:0
    ds_read_b128 v[200:203], v4 offset:4160
    s_cmp_lg_u32 s35, 0
.p2align 3
L_main_x:
    s_waitcnt lgkmcnt(2)
    v_lshlrev_b32 v16, 16, v180
    v_lshlrev_b32 v17, 16, v188
    v_mul_f32 v16, v16, v17
    v_and_b32 v17, 0xffff0000, v180
    v_and_b32 v21, 0xffff0000, v188
    v_mul_f32 v17, v17, v21
    v_cvt_pk_bf16_f32 v108, v16, v17
    v_lshlrev_b32 v16, 16, v181
    v_lshlrev_b32 v17, 16, v189
    v_mul_f32 v16, v16, v17
    v_and_b32 v17, 0xffff0000, v181
    v_and_b32 v21, 0xffff0000, v189
    v_mul_f32 v17, v17, v21
    v_cvt_pk_bf16_f32 v109, v16, v17
    v_lshlrev_b32 v16, 16, v182
    v_lshlrev_b32 v17, 16, v190
    v_mul_f32 v16, v16, v17
    v_and_b32 v17, 0xffff0000, v182
    v_and_b32 v21, 0xffff0000, v190
    v_mul_f32 v17, v17, v21
    v_cvt_pk_bf16_f32 v110, v16, v17
    v_lshlrev_b32 v16, 16, v183
    v_lshlrev_b32 v17, 16, v191
    v_mul_f32 v16, v16, v17
    v_and_b32 v17, 0xffff0000, v183
    v_and_b32 v21, 0xffff0000, v191
    v_mul_f32 v17, v17, v21
    v_cvt_pk_bf16_f32 v111, v16, v17
    v_lshlrev_b32 v16, 16, v184
    v_lshlrev_b32 v17, 16, v192
    v_mul_f32 v16, v16, v17
    v_and_b32 v17, 0xffff0000, v184
    v_and_b32 v21, 0xffff0000, v192
    v_mul_f32 v17, v17, v21
    v_cvt_pk_bf16_f32 v112, v16, v17
    v_lshlrev_b32 v16, 16, v185
    v_lshlrev_b32 v17, 16, v193
    v_mul_f32 v16, v16, v17
    v_and_b32 v17, 0xffff0000, v185
    v_and_b32 v21, 0xffff0000, v193
    v_mul_f32 v17, v17, v21
    v_cvt_pk_bf16_f32 v113, v16, v17
    v_lshlrev_b32 v16, 16, v186
    v_lshlrev_b32 v17, 16, v194
    v_mul_f32 v16, v16, v17
    v_and_b32 v17, 0xffff0000, v186
    v_and_b32 v21, 0xffff0000, v194
    v_mul_f32 v17, v17, v21
    v_cvt_pk_bf16_f32 v114, v16, v17
    v_lshlrev_b32 v16, 16, v187
    v_lshlrev_b32 v17, 16, v195
    v_mul_f32 v16, v16, v17
    v_and_b32 v17, 0xffff0000, v187
    v_and_b32 v21, 0xffff0000, v195
    v_mul_f32 v17, v17, v21
    v_cvt_pk_bf16_f32 v115, v16, v17
    v_mfma_f32_32x32x16_bf16 v[48:63], v[80:83], v[108:111], 0
    ds_read_b128 v[204:207], v8 offset:1536
    v_mfma_f32_32x32x16_bf16 v[48:63], v[84:87], v[112:115], v[48:63]
    s_waitcnt lgkmcnt(1)
    v_lshlrev_b32 v16, 16, v180
    v_lshlrev_b32 v17, 16, v196
    v_mul_f32 v16, v16, v17
    v_and_b32 v17, 0xffff0000, v180
    v_and_b32 v21, 0xffff0000, v196
    v_mul_f32 v17, v17, v21
    v_cvt_pk_bf16_f32 v116, v16, v17
    v_lshlrev_b32 v16, 16, v181
    v_lshlrev_b32 v17, 16, v197
    v_mul_f32 v16, v16, v17
    v_and_b32 v17, 0xffff0000, v181
    v_and_b32 v21, 0xffff0000, v197
    v_mul_f32 v17, v17, v21
    v_cvt_pk_bf16_f32 v117, v16, v17
    v_lshlrev_b32 v16, 16, v182
    v_lshlrev_b32 v17, 16, v198
    v_mul_f32 v16, v16, v17
    v_and_b32 v17, 0xffff0000, v182
    v_and_b32 v21, 0xffff0000, v198
    v_mul_f32 v17, v17, v21
    v_cvt_pk_bf16_f32 v118, v16, v17
    v_lshlrev_b32 v16, 16, v183
    v_lshlrev_b32 v17, 16, v199
    v_mul_f32 v16, v16, v17
    v_and_b32 v17, 0xffff0000, v183
    v_and_b32 v21, 0xffff0000, v199
    v_mul_f32 v17, v17, v21
    v_cvt_pk_bf16_f32 v119, v16, v17
    v_smfmac_f32_16x16x64_bf16 v[124:127], v[88:91], v[108:115], v1
    ds_read_b128 v[208:211], v8 offset:5696
    v_lshlrev_b32 v16, 16, v184
    v_lshlrev_b32 v17, 16, v200
    v_mul_f32 v16, v16, v17
    v_and_b32 v17, 0xffff0000, v184
    v_and_b32 v21, 0xffff0000, v200
    v_mul_f32 v17, v17, v21
    v_cvt_pk_bf16_f32 v120, v16, v17
    v_lshlrev_b32 v16, 16, v185
    v_lshlrev_b32 v17, 16, v201
    v_mul_f32 v16, v16, v17
    v_and_b32 v17, 0xffff0000, v185
    v_and_b32 v21, 0xffff0000, v201
    v_mul_f32 v17, v17, v21
    v_cvt_pk_bf16_f32 v121, v16, v17
    ds_read_b128 v[212:215], v8 offset:1552
    v_lshlrev_b32 v16, 16, v186
    v_lshlrev_b32 v17, 16, v202
    v_mul_f32 v16, v16, v17
    v_and_b32 v17, 0xffff0000, v186
    v_and_b32 v21, 0xffff0000, v202
    v_mul_f32 v17, v17, v21
    v_cvt_pk_bf16_f32 v122, v16, v17
    v_lshlrev_b32 v16, 16, v187
    v_lshlrev_b32 v17, 16, v203
    v_mul_f32 v16, v16, v17
    v_and_b32 v17, 0xffff0000, v187
    v_and_b32 v21, 0xffff0000, v203
    v_mul_f32 v17, v17, v21
    v_cvt_pk_bf16_f32 v123, v16, v17
    v_mfma_f32_32x32x16_bf16 v[64:79], v[80:83], v[116:119], 0
    ds_read_b128 v[216:219], v8 offset:5712
    v_cvt_pk_bf16_f32 v17, v48, v49
    v_lshlrev_b32 v16, 16, v17
    v_and_b32 v17, 0xffff0000, v17
    v_add_f32 v16, v16, v32
    v_add_f32 v17, v17, v33
    v_cvt_pk_bf16_f32 v164, v16, v17
    v_pk_max_i16 v164, v164, 0
    v_cvt_pk_bf16_f32 v17, v50, v51
    v_lshlrev_b32 v16, 16, v17
    v_and_b32 v17, 0xffff0000, v17
    v_add_f32 v16, v16, v34
    v_add_f32 v17, v17, v35
    v_cvt_pk_bf16_f32 v165, v16, v17
    v_pk_max_i16 v165, v165, 0
    v_cvt_pk_bf16_f32 v17, v52, v53
    v_lshlrev_b32 v16, 16, v17
    v_and_b32 v17, 0xffff0000, v17
    v_add_f32 v16, v16, v36
    v_add_f32 v17, v17, v37
    v_cvt_pk_bf16_f32 v166, v16, v17
    v_pk_max_i16 v166, v166, 0
    v_cvt_pk_bf16_f32 v17, v54, v55
    v_lshlrev_b32 v16, 16, v17
    v_and_b32 v17, 0xffff0000, v17
    v_add_f32 v16, v16, v38
    v_add_f32 v17, v17, v39
    v_cvt_pk_bf16_f32 v167, v16, v17
    v_pk_max_i16 v167, v167, 0
    v_cvt_pk_bf16_f32 v17, v56, v57
    v_lshlrev_b32 v16, 16, v17
    v_and_b32 v17, 0xffff0000, v17
    v_add_f32 v16, v16, v40
    v_add_f32 v17, v17, v41
    v_cvt_pk_bf16_f32 v168, v16, v17
    v_pk_max_i16 v168, v168, 0
    v_cvt_pk_bf16_f32 v17, v58, v59
    v_lshlrev_b32 v16, 16, v17
    v_and_b32 v17, 0xffff0000, v17
    v_add_f32 v16, v16, v42
    v_add_f32 v17, v17, v43
    v_cvt_pk_bf16_f32 v169, v16, v17
    v_pk_max_i16 v169, v169, 0
    v_mfma_f32_32x32x16_bf16 v[64:79], v[84:87], v[120:123], v[64:79]
    v_cvt_pk_bf16_f32 v17, v60, v61
    v_lshlrev_b32 v16, 16, v17
    v_and_b32 v17, 0xffff0000, v17
    v_add_f32 v16, v16, v44
    v_add_f32 v17, v17, v45
    v_cvt_pk_bf16_f32 v170, v16, v17
    v_pk_max_i16 v170, v170, 0
    v_cvt_pk_bf16_f32 v17, v62, v63
    v_lshlrev_b32 v16, 16, v17
    v_and_b32 v17, 0xffff0000, v17
    v_add_f32 v16, v16, v46
    v_add_f32 v17, v17, v47
    v_cvt_pk_bf16_f32 v171, v16, v17
    v_pk_max_i16 v171, v171, 0
    v_lshlrev_b32 v16, 16, v188
    v_lshlrev_b32 v17, 16, v196
    v_mul_f32 v16, v16, v17
    v_and_b32 v17, 0xffff0000, v188
    v_and_b32 v21, 0xffff0000, v196
    v_mul_f32 v17, v17, v21
    v_cvt_pk_bf16_f32 v108, v16, v17
    v_lshlrev_b32 v16, 16, v189
    v_lshlrev_b32 v17, 16, v197
    v_mul_f32 v16, v16, v17
    v_and_b32 v17, 0xffff0000, v189
    v_and_b32 v21, 0xffff0000, v197
    v_mul_f32 v17, v17, v21
    v_cvt_pk_bf16_f32 v109, v16, v17
    v_lshlrev_b32 v16, 16, v190
    v_lshlrev_b32 v17, 16, v198
    v_mul_f32 v16, v16, v17
    v_and_b32 v17, 0xffff0000, v190
    v_and_b32 v21, 0xffff0000, v198
    v_mul_f32 v17, v17, v21
    v_cvt_pk_bf16_f32 v110, v16, v17
    v_lshlrev_b32 v16, 16, v191
    v_lshlrev_b32 v17, 16, v199
    v_mul_f32 v16, v16, v17
    v_and_b32 v17, 0xffff0000, v191
    v_and_b32 v21, 0xffff0000, v199
    v_mul_f32 v17, v17, v21
    v_cvt_pk_bf16_f32 v111, v16, v17
    v_smfmac_f32_16x16x64_bf16 v[124:127], v[92:95], v[116:123], v1
    ds_read_b128 v[220:223], v9 offset:0
    v_lshlrev_b32 v16, 16, v192
    v_lshlrev_b32 v17, 16, v200
    v_mul_f32 v16, v16, v17
    v_and_b32 v17, 0xffff0000, v192
    v_and_b32 v21, 0xffff0000, v200
    v_mul_f32 v17, v17, v21
    v_cvt_pk_bf16_f32 v112, v16, v17
    v_lshlrev_b32 v16, 16, v193
    v_lshlrev_b32 v17, 16, v201
    v_mul_f32 v16, v16, v17
    v_and_b32 v17, 0xffff0000, v193
    v_and_b32 v21, 0xffff0000, v201
    v_mul_f32 v17, v17, v21
    v_cvt_pk_bf16_f32 v113, v16, v17
    v_smfmac_f32_16x16x64_bf16 v[124:127], v[172:175], v[164:171], v1
    ds_read_b128 v[224:227], v9 offset:4160
    v_lshlrev_b32 v16, 16, v194
    v_lshlrev_b32 v17, 16, v202
    v_mul_f32 v16, v16, v17
    v_and_b32 v17, 0xffff0000, v194
    v_and_b32 v21, 0xffff0000, v202
    v_mul_f32 v17, v17, v21
    v_cvt_pk_bf16_f32 v114, v16, v17
    v_lshlrev_b32 v16, 16, v195
    v_lshlrev_b32 v17, 16, v203
    v_mul_f32 v16, v16, v17
    v_and_b32 v17, 0xffff0000, v195
    v_and_b32 v21, 0xffff0000, v203
    v_mul_f32 v17, v17, v21
    v_cvt_pk_bf16_f32 v115, v16, v17
    v_mfma_f32_32x32x16_bf16 v[48:63], v[80:83], v[108:111], 0
    ds_read_b128 v[228:231], v10 offset:0
    v_cvt_pk_bf16_f32 v17, v64, v65
    v_lshlrev_b32 v16, 16, v17
    v_and_b32 v17, 0xffff0000, v17
    v_add_f32 v16, v16, v32
    v_add_f32 v17, v17, v33
    v_cvt_pk_bf16_f32 v164, v16, v17
    v_pk_max_i16 v164, v164, 0
    v_cvt_pk_bf16_f32 v17, v66, v67
    v_lshlrev_b32 v16, 16, v17
    v_and_b32 v17, 0xffff0000, v17
    v_add_f32 v16, v16, v34
    v_add_f32 v17, v17, v35
    v_cvt_pk_bf16_f32 v165, v16, v17
    v_pk_max_i16 v165, v165, 0
    v_cvt_pk_bf16_f32 v17, v68, v69
    v_lshlrev_b32 v16, 16, v17
    v_and_b32 v17, 0xffff0000, v17
    v_add_f32 v16, v16, v36
    v_add_f32 v17, v17, v37
    v_cvt_pk_bf16_f32 v166, v16, v17
    v_pk_max_i16 v166, v166, 0
    v_cvt_pk_bf16_f32 v17, v70, v71
    v_lshlrev_b32 v16, 16, v17
    v_and_b32 v17, 0xffff0000, v17
    v_add_f32 v16, v16, v38
    v_add_f32 v17, v17, v39
    v_cvt_pk_bf16_f32 v167, v16, v17
    v_pk_max_i16 v167, v167, 0
    v_cvt_pk_bf16_f32 v17, v72, v73
    v_lshlrev_b32 v16, 16, v17
    v_and_b32 v17, 0xffff0000, v17
    v_add_f32 v16, v16, v40
    v_add_f32 v17, v17, v41
    v_cvt_pk_bf16_f32 v168, v16, v17
    v_pk_max_i16 v168, v168, 0
    v_cvt_pk_bf16_f32 v17, v74, v75
    v_lshlrev_b32 v16, 16, v17
    v_and_b32 v17, 0xffff0000, v17
    v_add_f32 v16, v16, v42
    v_add_f32 v17, v17, v43
    v_cvt_pk_bf16_f32 v169, v16, v17
    v_pk_max_i16 v169, v169, 0
    v_mfma_f32_32x32x16_bf16 v[48:63], v[84:87], v[112:115], v[48:63]
    s_waitcnt lgkmcnt(5)
    v_cvt_pk_bf16_f32 v17, v76, v77
    v_lshlrev_b32 v16, 16, v17
    v_and_b32 v17, 0xffff0000, v17
    v_add_f32 v16, v16, v44
    v_add_f32 v17, v17, v45
    v_cvt_pk_bf16_f32 v170, v16, v17
    v_pk_max_i16 v170, v170, 0
    v_cvt_pk_bf16_f32 v17, v78, v79
    v_lshlrev_b32 v16, 16, v17
    v_and_b32 v17, 0xffff0000, v17
    v_add_f32 v16, v16, v46
    v_add_f32 v17, v17, v47
    v_cvt_pk_bf16_f32 v171, v16, v17
    v_pk_max_i16 v171, v171, 0
    v_lshlrev_b32 v16, 16, v204
    v_lshlrev_b32 v17, 16, v180
    v_mul_f32 v16, v16, v17
    v_and_b32 v17, 0xffff0000, v204
    v_and_b32 v21, 0xffff0000, v180
    v_mul_f32 v17, v17, v21
    v_cvt_pk_bf16_f32 v116, v16, v17
    v_lshlrev_b32 v16, 16, v205
    v_lshlrev_b32 v17, 16, v181
    v_mul_f32 v16, v16, v17
    v_and_b32 v17, 0xffff0000, v205
    v_and_b32 v21, 0xffff0000, v181
    v_mul_f32 v17, v17, v21
    v_cvt_pk_bf16_f32 v117, v16, v17
    v_lshlrev_b32 v16, 16, v206
    v_lshlrev_b32 v17, 16, v182
    v_mul_f32 v16, v16, v17
    v_and_b32 v17, 0xffff0000, v206
    v_and_b32 v21, 0xffff0000, v182
    v_mul_f32 v17, v17, v21
    v_cvt_pk_bf16_f32 v118, v16, v17
    v_lshlrev_b32 v16, 16, v207
    v_lshlrev_b32 v17, 16, v183
    v_mul_f32 v16, v16, v17
    v_and_b32 v17, 0xffff0000, v207
    v_and_b32 v21, 0xffff0000, v183
    v_mul_f32 v17, v17, v21
    v_cvt_pk_bf16_f32 v119, v16, v17
    v_smfmac_f32_16x16x64_bf16 v[128:131], v[88:91], v[108:115], v1
    ds_read_b128 v[232:235], v10 offset:4160
    v_lshlrev_b32 v16, 16, v208
    v_lshlrev_b32 v17, 16, v184
    v_mul_f32 v16, v16, v17
    v_and_b32 v17, 0xffff0000, v208
    v_and_b32 v21, 0xffff0000, v184
    v_mul_f32 v17, v17, v21
    v_cvt_pk_bf16_f32 v120, v16, v17
    v_lshlrev_b32 v16, 16, v209
    v_lshlrev_b32 v17, 16, v185
    v_mul_f32 v16, v16, v17
    v_and_b32 v17, 0xffff0000, v209
    v_and_b32 v21, 0xffff0000, v185
    v_mul_f32 v17, v17, v21
    v_cvt_pk_bf16_f32 v121, v16, v17
    v_smfmac_f32_16x16x64_bf16 v[124:127], v[176:179], v[164:171], v1
    ds_read_b128 v[236:239], v2 offset:512
    v_lshlrev_b32 v16, 16, v210
    v_lshlrev_b32 v17, 16, v186
    v_mul_f32 v16, v16, v17
    v_and_b32 v17, 0xffff0000, v210
    v_and_b32 v21, 0xffff0000, v186
    v_mul_f32 v17, v17, v21
    v_cvt_pk_bf16_f32 v122, v16, v17
    v_lshlrev_b32 v16, 16, v211
    v_lshlrev_b32 v17, 16, v187
    v_mul_f32 v16, v16, v17
    v_and_b32 v17, 0xffff0000, v211
    v_and_b32 v21, 0xffff0000, v187
    v_mul_f32 v17, v17, v21
    v_cvt_pk_bf16_f32 v123, v16, v17
    v_mfma_f32_32x32x16_bf16 v[64:79], v[80:83], v[116:119], 0
    v_cvt_pk_bf16_f32 v17, v48, v49
    v_lshlrev_b32 v16, 16, v17
    v_and_b32 v17, 0xffff0000, v17
    v_add_f32 v16, v16, v32
    v_add_f32 v17, v17, v33
    v_cvt_pk_bf16_f32 v164, v16, v17
    v_pk_max_i16 v164, v164, 0
    v_cvt_pk_bf16_f32 v17, v50, v51
    v_lshlrev_b32 v16, 16, v17
    v_and_b32 v17, 0xffff0000, v17
    v_add_f32 v16, v16, v34
    v_add_f32 v17, v17, v35
    v_cvt_pk_bf16_f32 v165, v16, v17
    v_pk_max_i16 v165, v165, 0
    v_cvt_pk_bf16_f32 v17, v52, v53
    v_lshlrev_b32 v16, 16, v17
    v_and_b32 v17, 0xffff0000, v17
    v_add_f32 v16, v16, v36
    v_add_f32 v17, v17, v37
    v_cvt_pk_bf16_f32 v166, v16, v17
    v_pk_max_i16 v166, v166, 0
    v_cvt_pk_bf16_f32 v17, v54, v55
    v_lshlrev_b32 v16, 16, v17
    v_and_b32 v17, 0xffff0000, v17
    v_add_f32 v16, v16, v38
    v_add_f32 v17, v17, v39
    v_cvt_pk_bf16_f32 v167, v16, v17
    v_pk_max_i16 v167, v167, 0
    v_cvt_pk_bf16_f32 v17, v56, v57
    v_lshlrev_b32 v16, 16, v17
    v_and_b32 v17, 0xffff0000, v17
    v_add_f32 v16, v16, v40
    v_add_f32 v17, v17, v41
    v_cvt_pk_bf16_f32 v168, v16, v17
    v_pk_max_i16 v168, v168, 0
    v_cvt_pk_bf16_f32 v17, v58, v59
    v_lshlrev_b32 v16, 16, v17
    v_and_b32 v17, 0xffff0000, v17
    v_add_f32 v16, v16, v42
    v_add_f32 v17, v17, v43
    v_cvt_pk_bf16_f32 v169, v16, v17
    v_pk_max_i16 v169, v169, 0
    v_mfma_f32_32x32x16_bf16 v[64:79], v[84:87], v[120:123], v[64:79]
    s_waitcnt lgkmcnt(5)
    v_add_f32 v136, v124, v125
    v_add_f32 v157, v126, v127
    v_cvt_pk_bf16_f32 v136, 0, v136
    v_cvt_pk_bf16_f32 v17, v60, v61
    v_lshlrev_b32 v16, 16, v17
    v_and_b32 v17, 0xffff0000, v17
    v_add_f32 v16, v16, v44
    v_add_f32 v17, v17, v45
    v_cvt_pk_bf16_f32 v170, v16, v17
    v_pk_max_i16 v170, v170, 0
    v_cvt_pk_bf16_f32 v17, v62, v63
    v_lshlrev_b32 v16, 16, v17
    v_and_b32 v17, 0xffff0000, v17
    v_add_f32 v16, v16, v46
    v_add_f32 v17, v17, v47
    v_cvt_pk_bf16_f32 v171, v16, v17
    v_pk_max_i16 v171, v171, 0
    v_lshlrev_b32 v16, 16, v212
    v_lshlrev_b32 v17, 16, v180
    v_mul_f32 v16, v16, v17
    v_and_b32 v17, 0xffff0000, v212
    v_and_b32 v21, 0xffff0000, v180
    v_mul_f32 v17, v17, v21
    v_cvt_pk_bf16_f32 v108, v16, v17
    v_lshlrev_b32 v16, 16, v213
    v_lshlrev_b32 v17, 16, v181
    v_mul_f32 v16, v16, v17
    v_and_b32 v17, 0xffff0000, v213
    v_and_b32 v21, 0xffff0000, v181
    v_mul_f32 v17, v17, v21
    v_cvt_pk_bf16_f32 v109, v16, v17
    v_lshlrev_b32 v16, 16, v214
    v_lshlrev_b32 v17, 16, v182
    v_mul_f32 v16, v16, v17
    v_and_b32 v17, 0xffff0000, v214
    v_and_b32 v21, 0xffff0000, v182
    v_mul_f32 v17, v17, v21
    v_cvt_pk_bf16_f32 v110, v16, v17
    v_lshlrev_b32 v16, 16, v215
    v_lshlrev_b32 v17, 16, v183
    v_mul_f32 v16, v16, v17
    v_and_b32 v17, 0xffff0000, v215
    v_and_b32 v21, 0xffff0000, v183
    v_mul_f32 v17, v17, v21
    v_cvt_pk_bf16_f32 v111, v16, v17
    v_smfmac_f32_16x16x64_bf16 v[128:131], v[92:95], v[116:123], v1
    ds_read_b128 v[240:243], v2 offset:4672
    v_lshlrev_b32 v16, 16, v216
    v_lshlrev_b32 v17, 16, v184
    v_mul_f32 v16, v16, v17
    v_and_b32 v17, 0xffff0000, v216
    v_and_b32 v21, 0xffff0000, v184
    v_mul_f32 v17, v17, v21
    v_cvt_pk_bf16_f32 v112, v16, v17
    v_lshlrev_b32 v16, 16, v217
    v_lshlrev_b32 v17, 16, v185
    v_mul_f32 v16, v16, v17
    v_and_b32 v17, 0xffff0000, v217
    v_and_b32 v21, 0xffff0000, v185
    v_mul_f32 v17, v17, v21
    v_cvt_pk_bf16_f32 v113, v16, v17
    v_smfmac_f32_16x16x64_bf16 v[128:131], v[172:175], v[164:171], v1
    ds_read_b128 v[124:127], v11 offset:2048
    v_lshlrev_b32 v16, 16, v218
    v_lshlrev_b32 v17, 16, v186
    v_mul_f32 v16, v16, v17
    v_and_b32 v17, 0xffff0000, v218
    v_and_b32 v21, 0xffff0000, v186
    v_mul_f32 v17, v17, v21
    v_cvt_pk_bf16_f32 v114, v16, v17
    v_lshlrev_b32 v16, 16, v219
    v_lshlrev_b32 v17, 16, v187
    v_mul_f32 v16, v16, v17
    v_and_b32 v17, 0xffff0000, v219
    v_and_b32 v21, 0xffff0000, v187
    v_mul_f32 v17, v17, v21
    v_cvt_pk_bf16_f32 v115, v16, v17
    v_mfma_f32_32x32x16_bf16 v[48:63], v[80:83], v[108:111], 0
    v_cvt_pk_bf16_f32 v17, v64, v65
    v_lshlrev_b32 v16, 16, v17
    v_and_b32 v17, 0xffff0000, v17
    v_add_f32 v16, v16, v32
    v_add_f32 v17, v17, v33
    v_cvt_pk_bf16_f32 v164, v16, v17
    v_pk_max_i16 v164, v164, 0
    v_cvt_pk_bf16_f32 v17, v66, v67
    v_lshlrev_b32 v16, 16, v17
    v_and_b32 v17, 0xffff0000, v17
    v_add_f32 v16, v16, v34
    v_add_f32 v17, v17, v35
    v_cvt_pk_bf16_f32 v165, v16, v17
    v_pk_max_i16 v165, v165, 0
    v_cvt_pk_bf16_f32 v17, v68, v69
    v_lshlrev_b32 v16, 16, v17
    v_and_b32 v17, 0xffff0000, v17
    v_add_f32 v16, v16, v36
    v_add_f32 v17, v17, v37
    v_cvt_pk_bf16_f32 v166, v16, v17
    v_pk_max_i16 v166, v166, 0
    v_cvt_pk_bf16_f32 v17, v70, v71
    v_lshlrev_b32 v16, 16, v17
    v_and_b32 v17, 0xffff0000, v17
    v_add_f32 v16, v16, v38
    v_add_f32 v17, v17, v39
    v_cvt_pk_bf16_f32 v167, v16, v17
    v_pk_max_i16 v167, v167, 0
    v_cvt_pk_bf16_f32 v17, v72, v73
    v_lshlrev_b32 v16, 16, v17
    v_and_b32 v17, 0xffff0000, v17
    v_add_f32 v16, v16, v40
    v_add_f32 v17, v17, v41
    v_cvt_pk_bf16_f32 v168, v16, v17
    v_pk_max_i16 v168, v168, 0
    v_cvt_pk_bf16_f32 v17, v74, v75
    v_lshlrev_b32 v16, 16, v17
    v_and_b32 v17, 0xffff0000, v17
    v_add_f32 v16, v16, v42
    v_add_f32 v17, v17, v43
    v_cvt_pk_bf16_f32 v169, v16, v17
    v_pk_max_i16 v169, v169, 0
    v_mfma_f32_32x32x16_bf16 v[48:63], v[84:87], v[112:115], v[48:63]
    s_waitcnt lgkmcnt(3)
    v_cvt_pk_bf16_f32 v17, v76, v77
    v_lshlrev_b32 v16, 16, v17
    v_and_b32 v17, 0xffff0000, v17
    v_add_f32 v16, v16, v44
    v_add_f32 v17, v17, v45
    v_cvt_pk_bf16_f32 v170, v16, v17
    v_pk_max_i16 v170, v170, 0
    v_cvt_pk_bf16_f32 v17, v78, v79
    v_lshlrev_b32 v16, 16, v17
    v_and_b32 v17, 0xffff0000, v17
    v_add_f32 v16, v16, v46
    v_add_f32 v17, v17, v47
    v_cvt_pk_bf16_f32 v171, v16, v17
    v_pk_max_i16 v171, v171, 0
    v_lshlrev_b32 v16, 16, v220
    v_lshlrev_b32 v17, 16, v228
    v_mul_f32 v16, v16, v17
    v_and_b32 v17, 0xffff0000, v220
    v_and_b32 v21, 0xffff0000, v228
    v_mul_f32 v17, v17, v21
    v_cvt_pk_bf16_f32 v116, v16, v17
    v_lshlrev_b32 v16, 16, v221
    v_lshlrev_b32 v17, 16, v229
    v_mul_f32 v16, v16, v17
    v_and_b32 v17, 0xffff0000, v221
    v_and_b32 v21, 0xffff0000, v229
    v_mul_f32 v17, v17, v21
    v_cvt_pk_bf16_f32 v117, v16, v17
    v_lshlrev_b32 v16, 16, v222
    v_lshlrev_b32 v17, 16, v230
    v_mul_f32 v16, v16, v17
    v_and_b32 v17, 0xffff0000, v222
    v_and_b32 v21, 0xffff0000, v230
    v_mul_f32 v17, v17, v21
    v_cvt_pk_bf16_f32 v118, v16, v17
    v_lshlrev_b32 v16, 16, v223
    v_lshlrev_b32 v17, 16, v231
    v_mul_f32 v16, v16, v17
    v_and_b32 v17, 0xffff0000, v223
    v_and_b32 v21, 0xffff0000, v231
    v_mul_f32 v17, v17, v21
    v_cvt_pk_bf16_f32 v119, v16, v17
    v_smfmac_f32_16x16x64_bf16 v[132:135], v[88:91], v[108:115], v1
    ds_read_b128 v[244:247], v3 offset:512
    v_lshlrev_b32 v16, 16, v224
    v_lshlrev_b32 v17, 16, v232
    v_mul_f32 v16, v16, v17
    v_and_b32 v17, 0xffff0000, v224
    v_and_b32 v21, 0xffff0000, v232
    v_mul_f32 v17, v17, v21
    v_cvt_pk_bf16_f32 v120, v16, v17
    v_lshlrev_b32 v16, 16, v225
    v_lshlrev_b32 v17, 16, v233
    v_mul_f32 v16, v16, v17
    v_and_b32 v17, 0xffff0000, v225
    v_and_b32 v21, 0xffff0000, v233
    v_mul_f32 v17, v17, v21
    v_cvt_pk_bf16_f32 v121, v16, v17
    v_smfmac_f32_16x16x64_bf16 v[128:131], v[176:179], v[164:171], v1
    ds_read_b128 v[248:251], v3 offset:4672
    v_lshlrev_b32 v16, 16, v226
    v_lshlrev_b32 v17, 16, v234
    v_mul_f32 v16, v16, v17
    v_and_b32 v17, 0xffff0000, v226
    v_and_b32 v21, 0xffff0000, v234
    v_mul_f32 v17, v17, v21
    v_cvt_pk_bf16_f32 v122, v16, v17
    v_lshlrev_b32 v16, 16, v227
    v_lshlrev_b32 v17, 16, v235
    v_mul_f32 v16, v16, v17
    v_and_b32 v17, 0xffff0000, v227
    v_and_b32 v21, 0xffff0000, v235
    v_mul_f32 v17, v17, v21
    v_cvt_pk_bf16_f32 v123, v16, v17
    v_mfma_f32_32x32x16_bf16 v[64:79], v[80:83], v[116:119], 0
    v_cvt_pk_bf16_f32 v17, v48, v49
    v_lshlrev_b32 v16, 16, v17
    v_and_b32 v17, 0xffff0000, v17
    v_add_f32 v16, v16, v32
    v_add_f32 v17, v17, v33
    v_cvt_pk_bf16_f32 v164, v16, v17
    v_pk_max_i16 v164, v164, 0
    v_cvt_pk_bf16_f32 v17, v50, v51
    v_lshlrev_b32 v16, 16, v17
    v_and_b32 v17, 0xffff0000, v17
    v_add_f32 v16, v16, v34
    v_add_f32 v17, v17, v35
    v_cvt_pk_bf16_f32 v165, v16, v17
    v_pk_max_i16 v165, v165, 0
    v_cvt_pk_bf16_f32 v17, v52, v53
    v_lshlrev_b32 v16, 16, v17
    v_and_b32 v17, 0xffff0000, v17
    v_add_f32 v16, v16, v36
    v_add_f32 v17, v17, v37
    v_cvt_pk_bf16_f32 v166, v16, v17
    v_pk_max_i16 v166, v166, 0
    v_cvt_pk_bf16_f32 v17, v54, v55
    v_lshlrev_b32 v16, 16, v17
    v_and_b32 v17, 0xffff0000, v17
    v_add_f32 v16, v16, v38
    v_add_f32 v17, v17, v39
    v_cvt_pk_bf16_f32 v167, v16, v17
    v_pk_max_i16 v167, v167, 0
    v_cvt_pk_bf16_f32 v17, v56, v57
    v_lshlrev_b32 v16, 16, v17
    v_and_b32 v17, 0xffff0000, v17
    v_add_f32 v16, v16, v40
    v_add_f32 v17, v17, v41
    v_cvt_pk_bf16_f32 v168, v16, v17
    v_pk_max_i16 v168, v168, 0
    v_cvt_pk_bf16_f32 v17, v58, v59
    v_lshlrev_b32 v16, 16, v17
    v_and_b32 v17, 0xffff0000, v17
    v_add_f32 v16, v16, v42
    v_add_f32 v17, v17, v43
    v_cvt_pk_bf16_f32 v169, v16, v17
    v_pk_max_i16 v169, v169, 0
    v_mfma_f32_32x32x16_bf16 v[64:79], v[84:87], v[120:123], v[64:79]
    s_waitcnt lgkmcnt(3)
    v_add_f32 v137, v128, v129
    v_add_f32 v158, v130, v131
    v_cvt_pk_bf16_f32 v137, 0, v137
    v_cvt_pk_bf16_f32 v17, v60, v61
    v_lshlrev_b32 v16, 16, v17
    v_and_b32 v17, 0xffff0000, v17
    v_add_f32 v16, v16, v44
    v_add_f32 v17, v17, v45
    v_cvt_pk_bf16_f32 v170, v16, v17
    v_pk_max_i16 v170, v170, 0
    v_cvt_pk_bf16_f32 v17, v62, v63
    v_lshlrev_b32 v16, 16, v17
    v_and_b32 v17, 0xffff0000, v17
    v_add_f32 v16, v16, v46
    v_add_f32 v17, v17, v47
    v_cvt_pk_bf16_f32 v171, v16, v17
    v_pk_max_i16 v171, v171, 0
    v_lshlrev_b32 v16, 16, v180
    v_lshlrev_b32 v17, 16, v236
    v_mul_f32 v16, v16, v17
    v_and_b32 v17, 0xffff0000, v180
    v_and_b32 v21, 0xffff0000, v236
    v_mul_f32 v17, v17, v21
    v_cvt_pk_bf16_f32 v108, v16, v17
    v_lshlrev_b32 v16, 16, v181
    v_lshlrev_b32 v17, 16, v237
    v_mul_f32 v16, v16, v17
    v_and_b32 v17, 0xffff0000, v181
    v_and_b32 v21, 0xffff0000, v237
    v_mul_f32 v17, v17, v21
    v_cvt_pk_bf16_f32 v109, v16, v17
    v_lshlrev_b32 v16, 16, v182
    v_lshlrev_b32 v17, 16, v238
    v_mul_f32 v16, v16, v17
    v_and_b32 v17, 0xffff0000, v182
    v_and_b32 v21, 0xffff0000, v238
    v_mul_f32 v17, v17, v21
    v_cvt_pk_bf16_f32 v110, v16, v17
    v_lshlrev_b32 v16, 16, v183
    v_lshlrev_b32 v17, 16, v239
    v_mul_f32 v16, v16, v17
    v_and_b32 v17, 0xffff0000, v183
    v_and_b32 v21, 0xffff0000, v239
    v_mul_f32 v17, v17, v21
    v_cvt_pk_bf16_f32 v111, v16, v17
    v_smfmac_f32_16x16x64_bf16 v[132:135], v[92:95], v[116:123], v1
    ds_read_b128 v[128:131], v11 offset:2048
    v_lshlrev_b32 v16, 16, v184
    v_lshlrev_b32 v17, 16, v240
    v_mul_f32 v16, v16, v17
    v_and_b32 v17, 0xffff0000, v184
    v_and_b32 v21, 0xffff0000, v240
    v_mul_f32 v17, v17, v21
    v_cvt_pk_bf16_f32 v112, v16, v17
    v_lshlrev_b32 v16, 16, v185
    v_lshlrev_b32 v17, 16, v241
    v_mul_f32 v16, v16, v17
    v_and_b32 v17, 0xffff0000, v185
    v_and_b32 v21, 0xffff0000, v241
    v_mul_f32 v17, v17, v21
    v_cvt_pk_bf16_f32 v113, v16, v17
    v_smfmac_f32_16x16x64_bf16 v[132:135], v[172:175], v[164:171], v1
    ds_read_b128 v[220:223], v4 offset:512
    v_lshlrev_b32 v16, 16, v186
    v_lshlrev_b32 v17, 16, v242
    v_mul_f32 v16, v16, v17
    v_and_b32 v17, 0xffff0000, v186
    v_and_b32 v21, 0xffff0000, v242
    v_mul_f32 v17, v17, v21
    v_cvt_pk_bf16_f32 v114, v16, v17
    v_lshlrev_b32 v16, 16, v187
    v_lshlrev_b32 v17, 16, v243
    v_mul_f32 v16, v16, v17
    v_and_b32 v17, 0xffff0000, v187
    v_and_b32 v21, 0xffff0000, v243
    v_mul_f32 v17, v17, v21
    v_cvt_pk_bf16_f32 v115, v16, v17
    v_mfma_f32_32x32x16_bf16 v[48:63], v[80:83], v[108:111], 0
    v_cvt_pk_bf16_f32 v17, v64, v65
    v_lshlrev_b32 v16, 16, v17
    v_and_b32 v17, 0xffff0000, v17
    v_add_f32 v16, v16, v32
    v_add_f32 v17, v17, v33
    v_cvt_pk_bf16_f32 v164, v16, v17
    v_pk_max_i16 v164, v164, 0
    v_cvt_pk_bf16_f32 v17, v66, v67
    v_lshlrev_b32 v16, 16, v17
    v_and_b32 v17, 0xffff0000, v17
    v_add_f32 v16, v16, v34
    v_add_f32 v17, v17, v35
    v_cvt_pk_bf16_f32 v165, v16, v17
    v_pk_max_i16 v165, v165, 0
    v_cvt_pk_bf16_f32 v17, v68, v69
    v_lshlrev_b32 v16, 16, v17
    v_and_b32 v17, 0xffff0000, v17
    v_add_f32 v16, v16, v36
    v_add_f32 v17, v17, v37
    v_cvt_pk_bf16_f32 v166, v16, v17
    v_pk_max_i16 v166, v166, 0
    v_cvt_pk_bf16_f32 v17, v70, v71
    v_lshlrev_b32 v16, 16, v17
    v_and_b32 v17, 0xffff0000, v17
    v_add_f32 v16, v16, v38
    v_add_f32 v17, v17, v39
    v_cvt_pk_bf16_f32 v167, v16, v17
    v_pk_max_i16 v167, v167, 0
    v_cvt_pk_bf16_f32 v17, v72, v73
    v_lshlrev_b32 v16, 16, v17
    v_and_b32 v17, 0xffff0000, v17
    v_add_f32 v16, v16, v40
    v_add_f32 v17, v17, v41
    v_cvt_pk_bf16_f32 v168, v16, v17
    v_pk_max_i16 v168, v168, 0
    v_cvt_pk_bf16_f32 v17, v74, v75
    v_lshlrev_b32 v16, 16, v17
    v_and_b32 v17, 0xffff0000, v17
    v_add_f32 v16, v16, v42
    v_add_f32 v17, v17, v43
    v_cvt_pk_bf16_f32 v169, v16, v17
    v_pk_max_i16 v169, v169, 0
    v_mfma_f32_32x32x16_bf16 v[48:63], v[84:87], v[112:115], v[48:63]
    s_waitcnt lgkmcnt(4)
    v_cvt_pk_bf16_f32 v17, v76, v77
    v_lshlrev_b32 v16, 16, v17
    v_and_b32 v17, 0xffff0000, v17
    v_add_f32 v16, v16, v44
    v_add_f32 v17, v17, v45
    v_cvt_pk_bf16_f32 v170, v16, v17
    v_pk_max_i16 v170, v170, 0
    v_cvt_pk_bf16_f32 v17, v78, v79
    v_lshlrev_b32 v16, 16, v17
    v_and_b32 v17, 0xffff0000, v17
    v_add_f32 v16, v16, v46
    v_add_f32 v17, v17, v47
    v_cvt_pk_bf16_f32 v171, v16, v17
    v_pk_max_i16 v171, v171, 0
    v_lshlrev_b32 v16, 16, v188
    v_lshlrev_b32 v17, 16, v236
    v_mul_f32 v16, v16, v17
    v_and_b32 v17, 0xffff0000, v188
    v_and_b32 v21, 0xffff0000, v236
    v_mul_f32 v17, v17, v21
    v_cvt_pk_bf16_f32 v116, v16, v17
    v_lshlrev_b32 v16, 16, v189
    v_lshlrev_b32 v17, 16, v237
    v_mul_f32 v16, v16, v17
    v_and_b32 v17, 0xffff0000, v189
    v_and_b32 v21, 0xffff0000, v237
    v_mul_f32 v17, v17, v21
    v_cvt_pk_bf16_f32 v117, v16, v17
    v_lshlrev_b32 v16, 16, v190
    v_lshlrev_b32 v17, 16, v238
    v_mul_f32 v16, v16, v17
    v_and_b32 v17, 0xffff0000, v190
    v_and_b32 v21, 0xffff0000, v238
    v_mul_f32 v17, v17, v21
    v_cvt_pk_bf16_f32 v118, v16, v17
    v_lshlrev_b32 v16, 16, v191
    v_lshlrev_b32 v17, 16, v239
    v_mul_f32 v16, v16, v17
    v_and_b32 v17, 0xffff0000, v191
    v_and_b32 v21, 0xffff0000, v239
    v_mul_f32 v17, v17, v21
    v_cvt_pk_bf16_f32 v119, v16, v17
    v_smfmac_f32_16x16x64_bf16 v[124:127], v[88:91], v[108:115], v1
    ds_read_b128 v[224:227], v4 offset:4672
    v_lshlrev_b32 v16, 16, v192
    v_lshlrev_b32 v17, 16, v240
    v_mul_f32 v16, v16, v17
    v_and_b32 v17, 0xffff0000, v192
    v_and_b32 v21, 0xffff0000, v240
    v_mul_f32 v17, v17, v21
    v_cvt_pk_bf16_f32 v120, v16, v17
    v_lshlrev_b32 v16, 16, v193
    v_lshlrev_b32 v17, 16, v241
    v_mul_f32 v16, v16, v17
    v_and_b32 v17, 0xffff0000, v193
    v_and_b32 v21, 0xffff0000, v241
    v_mul_f32 v17, v17, v21
    v_cvt_pk_bf16_f32 v121, v16, v17
    v_smfmac_f32_16x16x64_bf16 v[132:135], v[176:179], v[164:171], v1
    ds_read_b128 v[228:231], v2 offset:1024
    v_lshlrev_b32 v16, 16, v194
    v_lshlrev_b32 v17, 16, v242
    v_mul_f32 v16, v16, v17
    v_and_b32 v17, 0xffff0000, v194
    v_and_b32 v21, 0xffff0000, v242
    v_mul_f32 v17, v17, v21
    v_cvt_pk_bf16_f32 v122, v16, v17
    v_lshlrev_b32 v16, 16, v195
    v_lshlrev_b32 v17, 16, v243
    v_mul_f32 v16, v16, v17
    v_and_b32 v17, 0xffff0000, v195
    v_and_b32 v21, 0xffff0000, v243
    v_mul_f32 v17, v17, v21
    v_cvt_pk_bf16_f32 v123, v16, v17
    v_mfma_f32_32x32x16_bf16 v[64:79], v[80:83], v[116:119], 0
    v_cvt_pk_bf16_f32 v17, v48, v49
    v_lshlrev_b32 v16, 16, v17
    v_and_b32 v17, 0xffff0000, v17
    v_add_f32 v16, v16, v32
    v_add_f32 v17, v17, v33
    v_cvt_pk_bf16_f32 v164, v16, v17
    v_pk_max_i16 v164, v164, 0
    v_cvt_pk_bf16_f32 v17, v50, v51
    v_lshlrev_b32 v16, 16, v17
    v_and_b32 v17, 0xffff0000, v17
    v_add_f32 v16, v16, v34
    v_add_f32 v17, v17, v35
    v_cvt_pk_bf16_f32 v165, v16, v17
    v_pk_max_i16 v165, v165, 0
    v_cvt_pk_bf16_f32 v17, v52, v53
    v_lshlrev_b32 v16, 16, v17
    v_and_b32 v17, 0xffff0000, v17
    v_add_f32 v16, v16, v36
    v_add_f32 v17, v17, v37
    v_cvt_pk_bf16_f32 v166, v16, v17
    v_pk_max_i16 v166, v166, 0
    v_cvt_pk_bf16_f32 v17, v54, v55
    v_lshlrev_b32 v16, 16, v17
    v_and_b32 v17, 0xffff0000, v17
    v_add_f32 v16, v16, v38
    v_add_f32 v17, v17, v39
    v_cvt_pk_bf16_f32 v167, v16, v17
    v_pk_max_i16 v167, v167, 0
    v_cvt_pk_bf16_f32 v17, v56, v57
    v_lshlrev_b32 v16, 16, v17
    v_and_b32 v17, 0xffff0000, v17
    v_add_f32 v16, v16, v40
    v_add_f32 v17, v17, v41
    v_cvt_pk_bf16_f32 v168, v16, v17
    v_pk_max_i16 v168, v168, 0
    v_cvt_pk_bf16_f32 v17, v58, v59
    v_lshlrev_b32 v16, 16, v17
    v_and_b32 v17, 0xffff0000, v17
    v_add_f32 v16, v16, v42
    v_add_f32 v17, v17, v43
    v_cvt_pk_bf16_f32 v169, v16, v17
    v_pk_max_i16 v169, v169, 0
    v_mfma_f32_32x32x16_bf16 v[64:79], v[84:87], v[120:123], v[64:79]
    v_add_f32 v138, v132, v133
    v_add_f32 v159, v134, v135
    v_cvt_pk_bf16_f32 v138, 0, v138
    v_cvt_pk_bf16_f32 v17, v60, v61
    v_lshlrev_b32 v16, 16, v17
    v_and_b32 v17, 0xffff0000, v17
    v_add_f32 v16, v16, v44
    v_add_f32 v17, v17, v45
    v_cvt_pk_bf16_f32 v170, v16, v17
    v_pk_max_i16 v170, v170, 0
    v_cvt_pk_bf16_f32 v17, v62, v63
    v_lshlrev_b32 v16, 16, v17
    v_and_b32 v17, 0xffff0000, v17
    v_add_f32 v16, v16, v46
    v_add_f32 v17, v17, v47
    v_cvt_pk_bf16_f32 v171, v16, v17
    v_pk_max_i16 v171, v171, 0
    v_lshlrev_b32 v16, 16, v196
    v_lshlrev_b32 v17, 16, v236
    v_mul_f32 v16, v16, v17
    v_and_b32 v17, 0xffff0000, v196
    v_and_b32 v21, 0xffff0000, v236
    v_mul_f32 v17, v17, v21
    v_cvt_pk_bf16_f32 v108, v16, v17
    v_lshlrev_b32 v16, 16, v197
    v_lshlrev_b32 v17, 16, v237
    v_mul_f32 v16, v16, v17
    v_and_b32 v17, 0xffff0000, v197
    v_and_b32 v21, 0xffff0000, v237
    v_mul_f32 v17, v17, v21
    v_cvt_pk_bf16_f32 v109, v16, v17
    v_lshlrev_b32 v16, 16, v198
    v_lshlrev_b32 v17, 16, v238
    v_mul_f32 v16, v16, v17
    v_and_b32 v17, 0xffff0000, v198
    v_and_b32 v21, 0xffff0000, v238
    v_mul_f32 v17, v17, v21
    v_cvt_pk_bf16_f32 v110, v16, v17
    v_lshlrev_b32 v16, 16, v199
    v_lshlrev_b32 v17, 16, v239
    v_mul_f32 v16, v16, v17
    v_and_b32 v17, 0xffff0000, v199
    v_and_b32 v21, 0xffff0000, v239
    v_mul_f32 v17, v17, v21
    v_cvt_pk_bf16_f32 v111, v16, v17
    v_smfmac_f32_16x16x64_bf16 v[124:127], v[92:95], v[116:123], v1
    ds_read_b128 v[132:135], v11 offset:2048
    v_lshlrev_b32 v16, 16, v200
    v_lshlrev_b32 v17, 16, v240
    v_mul_f32 v16, v16, v17
    v_and_b32 v17, 0xffff0000, v200
    v_and_b32 v21, 0xffff0000, v240
    v_mul_f32 v17, v17, v21
    v_cvt_pk_bf16_f32 v112, v16, v17
    v_lshlrev_b32 v16, 16, v201
    v_lshlrev_b32 v17, 16, v241
    v_mul_f32 v16, v16, v17
    v_and_b32 v17, 0xffff0000, v201
    v_and_b32 v21, 0xffff0000, v241
    v_mul_f32 v17, v17, v21
    v_cvt_pk_bf16_f32 v113, v16, v17
    v_smfmac_f32_16x16x64_bf16 v[124:127], v[172:175], v[164:171], v1
    ds_read_b128 v[232:235], v2 offset:5184
    v_lshlrev_b32 v16, 16, v202
    v_lshlrev_b32 v17, 16, v242
    v_mul_f32 v16, v16, v17
    v_and_b32 v17, 0xffff0000, v202
    v_and_b32 v21, 0xffff0000, v242
    v_mul_f32 v17, v17, v21
    v_cvt_pk_bf16_f32 v114, v16, v17
    v_lshlrev_b32 v16, 16, v203
    v_lshlrev_b32 v17, 16, v243
    v_mul_f32 v16, v16, v17
    v_and_b32 v17, 0xffff0000, v203
    v_and_b32 v21, 0xffff0000, v243
    v_mul_f32 v17, v17, v21
    v_cvt_pk_bf16_f32 v115, v16, v17
    v_mfma_f32_32x32x16_bf16 v[48:63], v[80:83], v[108:111], 0
    v_cvt_pk_bf16_f32 v17, v64, v65
    v_lshlrev_b32 v16, 16, v17
    v_and_b32 v17, 0xffff0000, v17
    v_add_f32 v16, v16, v32
    v_add_f32 v17, v17, v33
    v_cvt_pk_bf16_f32 v164, v16, v17
    v_pk_max_i16 v164, v164, 0
    v_cvt_pk_bf16_f32 v17, v66, v67
    v_lshlrev_b32 v16, 16, v17
    v_and_b32 v17, 0xffff0000, v17
    v_add_f32 v16, v16, v34
    v_add_f32 v17, v17, v35
    v_cvt_pk_bf16_f32 v165, v16, v17
    v_pk_max_i16 v165, v165, 0
    v_cvt_pk_bf16_f32 v17, v68, v69
    v_lshlrev_b32 v16, 16, v17
    v_and_b32 v17, 0xffff0000, v17
    v_add_f32 v16, v16, v36
    v_add_f32 v17, v17, v37
    v_cvt_pk_bf16_f32 v166, v16, v17
    v_pk_max_i16 v166, v166, 0
    v_cvt_pk_bf16_f32 v17, v70, v71
    v_lshlrev_b32 v16, 16, v17
    v_and_b32 v17, 0xffff0000, v17
    v_add_f32 v16, v16, v38
    v_add_f32 v17, v17, v39
    v_cvt_pk_bf16_f32 v167, v16, v17
    v_pk_max_i16 v167, v167, 0
    v_cvt_pk_bf16_f32 v17, v72, v73
    v_lshlrev_b32 v16, 16, v17
    v_and_b32 v17, 0xffff0000, v17
    v_add_f32 v16, v16, v40
    v_add_f32 v17, v17, v41
    v_cvt_pk_bf16_f32 v168, v16, v17
    v_pk_max_i16 v168, v168, 0
    v_cvt_pk_bf16_f32 v17, v74, v75
    v_lshlrev_b32 v16, 16, v17
    v_and_b32 v17, 0xffff0000, v17
    v_add_f32 v16, v16, v42
    v_add_f32 v17, v17, v43
    v_cvt_pk_bf16_f32 v169, v16, v17
    v_pk_max_i16 v169, v169, 0
    v_mfma_f32_32x32x16_bf16 v[48:63], v[84:87], v[112:115], v[48:63]
    s_waitcnt lgkmcnt(5)
    v_cvt_pk_bf16_f32 v17, v76, v77
    v_lshlrev_b32 v16, 16, v17
    v_and_b32 v17, 0xffff0000, v17
    v_add_f32 v16, v16, v44
    v_add_f32 v17, v17, v45
    v_cvt_pk_bf16_f32 v170, v16, v17
    v_pk_max_i16 v170, v170, 0
    v_cvt_pk_bf16_f32 v17, v78, v79
    v_lshlrev_b32 v16, 16, v17
    v_and_b32 v17, 0xffff0000, v17
    v_add_f32 v16, v16, v46
    v_add_f32 v17, v17, v47
    v_cvt_pk_bf16_f32 v171, v16, v17
    v_pk_max_i16 v171, v171, 0
    v_lshlrev_b32 v16, 16, v204
    v_lshlrev_b32 v17, 16, v236
    v_mul_f32 v16, v16, v17
    v_and_b32 v17, 0xffff0000, v204
    v_and_b32 v21, 0xffff0000, v236
    v_mul_f32 v17, v17, v21
    v_cvt_pk_bf16_f32 v116, v16, v17
    v_lshlrev_b32 v16, 16, v205
    v_lshlrev_b32 v17, 16, v237
    v_mul_f32 v16, v16, v17
    v_and_b32 v17, 0xffff0000, v205
    v_and_b32 v21, 0xffff0000, v237
    v_mul_f32 v17, v17, v21
    v_cvt_pk_bf16_f32 v117, v16, v17
    v_lshlrev_b32 v16, 16, v206
    v_lshlrev_b32 v17, 16, v238
    v_mul_f32 v16, v16, v17
    v_and_b32 v17, 0xffff0000, v206
    v_and_b32 v21, 0xffff0000, v238
    v_mul_f32 v17, v17, v21
    v_cvt_pk_bf16_f32 v118, v16, v17
    v_lshlrev_b32 v16, 16, v207
    v_lshlrev_b32 v17, 16, v239
    v_mul_f32 v16, v16, v17
    v_and_b32 v17, 0xffff0000, v207
    v_and_b32 v21, 0xffff0000, v239
    v_mul_f32 v17, v17, v21
    v_cvt_pk_bf16_f32 v119, v16, v17
    v_smfmac_f32_16x16x64_bf16 v[128:131], v[88:91], v[108:115], v1
    v_lshlrev_b32 v16, 16, v208
    v_lshlrev_b32 v17, 16, v240
    v_mul_f32 v16, v16, v17
    v_and_b32 v17, 0xffff0000, v208
    v_and_b32 v21, 0xffff0000, v240
    v_mul_f32 v17, v17, v21
    v_cvt_pk_bf16_f32 v120, v16, v17
    v_lshlrev_b32 v16, 16, v209
    v_lshlrev_b32 v17, 16, v241
    v_mul_f32 v16, v16, v17
    v_and_b32 v17, 0xffff0000, v209
    v_and_b32 v21, 0xffff0000, v241
    v_mul_f32 v17, v17, v21
    v_cvt_pk_bf16_f32 v121, v16, v17
    v_smfmac_f32_16x16x64_bf16 v[124:127], v[176:179], v[164:171], v1
    v_lshlrev_b32 v16, 16, v210
    v_lshlrev_b32 v17, 16, v242
    v_mul_f32 v16, v16, v17
    v_and_b32 v17, 0xffff0000, v210
    v_and_b32 v21, 0xffff0000, v242
    v_mul_f32 v17, v17, v21
    v_cvt_pk_bf16_f32 v122, v16, v17
    v_lshlrev_b32 v16, 16, v211
    v_lshlrev_b32 v17, 16, v243
    v_mul_f32 v16, v16, v17
    v_and_b32 v17, 0xffff0000, v211
    v_and_b32 v21, 0xffff0000, v243
    v_mul_f32 v17, v17, v21
    v_cvt_pk_bf16_f32 v123, v16, v17
    v_mfma_f32_32x32x16_bf16 v[64:79], v[80:83], v[116:119], 0
    v_cvt_pk_bf16_f32 v17, v48, v49
    v_lshlrev_b32 v16, 16, v17
    v_and_b32 v17, 0xffff0000, v17
    v_add_f32 v16, v16, v32
    v_add_f32 v17, v17, v33
    v_cvt_pk_bf16_f32 v164, v16, v17
    v_pk_max_i16 v164, v164, 0
    v_cvt_pk_bf16_f32 v17, v50, v51
    v_lshlrev_b32 v16, 16, v17
    v_and_b32 v17, 0xffff0000, v17
    v_add_f32 v16, v16, v34
    v_add_f32 v17, v17, v35
    v_cvt_pk_bf16_f32 v165, v16, v17
    v_pk_max_i16 v165, v165, 0
    v_cvt_pk_bf16_f32 v17, v52, v53
    v_lshlrev_b32 v16, 16, v17
    v_and_b32 v17, 0xffff0000, v17
    v_add_f32 v16, v16, v36
    v_add_f32 v17, v17, v37
    v_cvt_pk_bf16_f32 v166, v16, v17
    v_pk_max_i16 v166, v166, 0
    v_cvt_pk_bf16_f32 v17, v54, v55
    v_lshlrev_b32 v16, 16, v17
    v_and_b32 v17, 0xffff0000, v17
    v_add_f32 v16, v16, v38
    v_add_f32 v17, v17, v39
    v_cvt_pk_bf16_f32 v167, v16, v17
    v_pk_max_i16 v167, v167, 0
    v_cvt_pk_bf16_f32 v17, v56, v57
    v_lshlrev_b32 v16, 16, v17
    v_and_b32 v17, 0xffff0000, v17
    v_add_f32 v16, v16, v40
    v_add_f32 v17, v17, v41
    v_cvt_pk_bf16_f32 v168, v16, v17
    v_pk_max_i16 v168, v168, 0
    v_cvt_pk_bf16_f32 v17, v58, v59
    v_lshlrev_b32 v16, 16, v17
    v_and_b32 v17, 0xffff0000, v17
    v_add_f32 v16, v16, v42
    v_add_f32 v17, v17, v43
    v_cvt_pk_bf16_f32 v169, v16, v17
    v_pk_max_i16 v169, v169, 0
    v_mfma_f32_32x32x16_bf16 v[64:79], v[84:87], v[120:123], v[64:79]
    v_add_f32 v139, v124, v125
    v_add_f32 v160, v126, v127
    v_cvt_pk_bf16_f32 v139, 0, v139
    v_cvt_pk_bf16_f32 v17, v60, v61
    v_lshlrev_b32 v16, 16, v17
    v_and_b32 v17, 0xffff0000, v17
    v_add_f32 v16, v16, v44
    v_add_f32 v17, v17, v45
    v_cvt_pk_bf16_f32 v170, v16, v17
    v_pk_max_i16 v170, v170, 0
    v_cvt_pk_bf16_f32 v17, v62, v63
    v_lshlrev_b32 v16, 16, v17
    v_and_b32 v17, 0xffff0000, v17
    v_add_f32 v16, v16, v46
    v_add_f32 v17, v17, v47
    v_cvt_pk_bf16_f32 v171, v16, v17
    v_pk_max_i16 v171, v171, 0
    v_lshlrev_b32 v16, 16, v212
    v_lshlrev_b32 v17, 16, v236
    v_mul_f32 v16, v16, v17
    v_and_b32 v17, 0xffff0000, v212
    v_and_b32 v21, 0xffff0000, v236
    v_mul_f32 v17, v17, v21
    v_cvt_pk_bf16_f32 v108, v16, v17
    v_lshlrev_b32 v16, 16, v213
    v_lshlrev_b32 v17, 16, v237
    v_mul_f32 v16, v16, v17
    v_and_b32 v17, 0xffff0000, v213
    v_and_b32 v21, 0xffff0000, v237
    v_mul_f32 v17, v17, v21
    v_cvt_pk_bf16_f32 v109, v16, v17
    v_lshlrev_b32 v16, 16, v214
    v_lshlrev_b32 v17, 16, v238
    v_mul_f32 v16, v16, v17
    v_and_b32 v17, 0xffff0000, v214
    v_and_b32 v21, 0xffff0000, v238
    v_mul_f32 v17, v17, v21
    v_cvt_pk_bf16_f32 v110, v16, v17
    v_lshlrev_b32 v16, 16, v215
    v_lshlrev_b32 v17, 16, v239
    v_mul_f32 v16, v16, v17
    v_and_b32 v17, 0xffff0000, v215
    v_and_b32 v21, 0xffff0000, v239
    v_mul_f32 v17, v17, v21
    v_cvt_pk_bf16_f32 v111, v16, v17
    v_smfmac_f32_16x16x64_bf16 v[128:131], v[92:95], v[116:123], v1
    ds_read_b128 v[124:127], v11 offset:2048
    v_lshlrev_b32 v16, 16, v216
    v_lshlrev_b32 v17, 16, v240
    v_mul_f32 v16, v16, v17
    v_and_b32 v17, 0xffff0000, v216
    v_and_b32 v21, 0xffff0000, v240
    v_mul_f32 v17, v17, v21
    v_cvt_pk_bf16_f32 v112, v16, v17
    v_lshlrev_b32 v16, 16, v217
    v_lshlrev_b32 v17, 16, v241
    v_mul_f32 v16, v16, v17
    v_and_b32 v17, 0xffff0000, v217
    v_and_b32 v21, 0xffff0000, v241
    v_mul_f32 v17, v17, v21
    v_cvt_pk_bf16_f32 v113, v16, v17
    v_smfmac_f32_16x16x64_bf16 v[128:131], v[172:175], v[164:171], v1
    v_lshlrev_b32 v16, 16, v218
    v_lshlrev_b32 v17, 16, v242
    v_mul_f32 v16, v16, v17
    v_and_b32 v17, 0xffff0000, v218
    v_and_b32 v21, 0xffff0000, v242
    v_mul_f32 v17, v17, v21
    v_cvt_pk_bf16_f32 v114, v16, v17
    v_lshlrev_b32 v16, 16, v219
    v_lshlrev_b32 v17, 16, v243
    v_mul_f32 v16, v16, v17
    v_and_b32 v17, 0xffff0000, v219
    v_and_b32 v21, 0xffff0000, v243
    v_mul_f32 v17, v17, v21
    v_cvt_pk_bf16_f32 v115, v16, v17
    v_mfma_f32_32x32x16_bf16 v[48:63], v[80:83], v[108:111], 0
    v_cvt_pk_bf16_f32 v17, v64, v65
    v_lshlrev_b32 v16, 16, v17
    v_and_b32 v17, 0xffff0000, v17
    v_add_f32 v16, v16, v32
    v_add_f32 v17, v17, v33
    v_cvt_pk_bf16_f32 v164, v16, v17
    v_pk_max_i16 v164, v164, 0
    v_cvt_pk_bf16_f32 v17, v66, v67
    v_lshlrev_b32 v16, 16, v17
    v_and_b32 v17, 0xffff0000, v17
    v_add_f32 v16, v16, v34
    v_add_f32 v17, v17, v35
    v_cvt_pk_bf16_f32 v165, v16, v17
    v_pk_max_i16 v165, v165, 0
    v_cvt_pk_bf16_f32 v17, v68, v69
    v_lshlrev_b32 v16, 16, v17
    v_and_b32 v17, 0xffff0000, v17
    v_add_f32 v16, v16, v36
    v_add_f32 v17, v17, v37
    v_cvt_pk_bf16_f32 v166, v16, v17
    v_pk_max_i16 v166, v166, 0
    v_cvt_pk_bf16_f32 v17, v70, v71
    v_lshlrev_b32 v16, 16, v17
    v_and_b32 v17, 0xffff0000, v17
    v_add_f32 v16, v16, v38
    v_add_f32 v17, v17, v39
    v_cvt_pk_bf16_f32 v167, v16, v17
    v_pk_max_i16 v167, v167, 0
    v_cvt_pk_bf16_f32 v17, v72, v73
    v_lshlrev_b32 v16, 16, v17
    v_and_b32 v17, 0xffff0000, v17
    v_add_f32 v16, v16, v40
    v_add_f32 v17, v17, v41
    v_cvt_pk_bf16_f32 v168, v16, v17
    v_pk_max_i16 v168, v168, 0
    v_cvt_pk_bf16_f32 v17, v74, v75
    v_lshlrev_b32 v16, 16, v17
    v_and_b32 v17, 0xffff0000, v17
    v_add_f32 v16, v16, v42
    v_add_f32 v17, v17, v43
    v_cvt_pk_bf16_f32 v169, v16, v17
    v_pk_max_i16 v169, v169, 0
    v_mfma_f32_32x32x16_bf16 v[48:63], v[84:87], v[112:115], v[48:63]
    s_waitcnt lgkmcnt(2)
    v_cvt_pk_bf16_f32 v17, v76, v77
    v_lshlrev_b32 v16, 16, v17
    v_and_b32 v17, 0xffff0000, v17
    v_add_f32 v16, v16, v44
    v_add_f32 v17, v17, v45
    v_cvt_pk_bf16_f32 v170, v16, v17
    v_pk_max_i16 v170, v170, 0
    v_cvt_pk_bf16_f32 v17, v78, v79
    v_lshlrev_b32 v16, 16, v17
    v_and_b32 v17, 0xffff0000, v17
    v_add_f32 v16, v16, v46
    v_add_f32 v17, v17, v47
    v_cvt_pk_bf16_f32 v171, v16, v17
    v_pk_max_i16 v171, v171, 0
    v_lshlrev_b32 v16, 16, v180
    v_lshlrev_b32 v17, 16, v244
    v_mul_f32 v16, v16, v17
    v_and_b32 v17, 0xffff0000, v180
    v_and_b32 v21, 0xffff0000, v244
    v_mul_f32 v17, v17, v21
    v_cvt_pk_bf16_f32 v116, v16, v17
    v_lshlrev_b32 v16, 16, v181
    v_lshlrev_b32 v17, 16, v245
    v_mul_f32 v16, v16, v17
    v_and_b32 v17, 0xffff0000, v181
    v_and_b32 v21, 0xffff0000, v245
    v_mul_f32 v17, v17, v21
    v_cvt_pk_bf16_f32 v117, v16, v17
    v_lshlrev_b32 v16, 16, v182
    v_lshlrev_b32 v17, 16, v246
    v_mul_f32 v16, v16, v17
    v_and_b32 v17, 0xffff0000, v182
    v_and_b32 v21, 0xffff0000, v246
    v_mul_f32 v17, v17, v21
    v_cvt_pk_bf16_f32 v118, v16, v17
    v_lshlrev_b32 v16, 16, v183
    v_lshlrev_b32 v17, 16, v247
    v_mul_f32 v16, v16, v17
    v_and_b32 v17, 0xffff0000, v183
    v_and_b32 v21, 0xffff0000, v247
    v_mul_f32 v17, v17, v21
    v_cvt_pk_bf16_f32 v119, v16, v17
    v_smfmac_f32_16x16x64_bf16 v[132:135], v[88:91], v[108:115], v1
    v_lshlrev_b32 v16, 16, v184
    v_lshlrev_b32 v17, 16, v248
    v_mul_f32 v16, v16, v17
    v_and_b32 v17, 0xffff0000, v184
    v_and_b32 v21, 0xffff0000, v248
    v_mul_f32 v17, v17, v21
    v_cvt_pk_bf16_f32 v120, v16, v17
    v_lshlrev_b32 v16, 16, v185
    v_lshlrev_b32 v17, 16, v249
    v_mul_f32 v16, v16, v17
    v_and_b32 v17, 0xffff0000, v185
    v_and_b32 v21, 0xffff0000, v249
    v_mul_f32 v17, v17, v21
    v_cvt_pk_bf16_f32 v121, v16, v17
    v_smfmac_f32_16x16x64_bf16 v[128:131], v[176:179], v[164:171], v1
    v_lshlrev_b32 v16, 16, v186
    v_lshlrev_b32 v17, 16, v250
    v_mul_f32 v16, v16, v17
    v_and_b32 v17, 0xffff0000, v186
    v_and_b32 v21, 0xffff0000, v250
    v_mul_f32 v17, v17, v21
    v_cvt_pk_bf16_f32 v122, v16, v17
    v_lshlrev_b32 v16, 16, v187
    v_lshlrev_b32 v17, 16, v251
    v_mul_f32 v16, v16, v17
    v_and_b32 v17, 0xffff0000, v187
    v_and_b32 v21, 0xffff0000, v251
    v_mul_f32 v17, v17, v21
    v_cvt_pk_bf16_f32 v123, v16, v17
    v_mfma_f32_32x32x16_bf16 v[64:79], v[80:83], v[116:119], 0
    v_cvt_pk_bf16_f32 v17, v48, v49
    v_lshlrev_b32 v16, 16, v17
    v_and_b32 v17, 0xffff0000, v17
    v_add_f32 v16, v16, v32
    v_add_f32 v17, v17, v33
    v_cvt_pk_bf16_f32 v164, v16, v17
    v_pk_max_i16 v164, v164, 0
    v_cvt_pk_bf16_f32 v17, v50, v51
    v_lshlrev_b32 v16, 16, v17
    v_and_b32 v17, 0xffff0000, v17
    v_add_f32 v16, v16, v34
    v_add_f32 v17, v17, v35
    v_cvt_pk_bf16_f32 v165, v16, v17
    v_pk_max_i16 v165, v165, 0
    v_cvt_pk_bf16_f32 v17, v52, v53
    v_lshlrev_b32 v16, 16, v17
    v_and_b32 v17, 0xffff0000, v17
    v_add_f32 v16, v16, v36
    v_add_f32 v17, v17, v37
    v_cvt_pk_bf16_f32 v166, v16, v17
    v_pk_max_i16 v166, v166, 0
    v_cvt_pk_bf16_f32 v17, v54, v55
    v_lshlrev_b32 v16, 16, v17
    v_and_b32 v17, 0xffff0000, v17
    v_add_f32 v16, v16, v38
    v_add_f32 v17, v17, v39
    v_cvt_pk_bf16_f32 v167, v16, v17
    v_pk_max_i16 v167, v167, 0
    v_cvt_pk_bf16_f32 v17, v56, v57
    v_lshlrev_b32 v16, 16, v17
    v_and_b32 v17, 0xffff0000, v17
    v_add_f32 v16, v16, v40
    v_add_f32 v17, v17, v41
    v_cvt_pk_bf16_f32 v168, v16, v17
    v_pk_max_i16 v168, v168, 0
    v_cvt_pk_bf16_f32 v17, v58, v59
    v_lshlrev_b32 v16, 16, v17
    v_and_b32 v17, 0xffff0000, v17
    v_add_f32 v16, v16, v42
    v_add_f32 v17, v17, v43
    v_cvt_pk_bf16_f32 v169, v16, v17
    v_pk_max_i16 v169, v169, 0
    v_mfma_f32_32x32x16_bf16 v[64:79], v[84:87], v[120:123], v[64:79]
    v_add_f32 v140, v128, v129
    v_add_f32 v161, v130, v131
    v_cvt_pk_bf16_f32 v140, 0, v140
    v_cvt_pk_bf16_f32 v17, v60, v61
    v_lshlrev_b32 v16, 16, v17
    v_and_b32 v17, 0xffff0000, v17
    v_add_f32 v16, v16, v44
    v_add_f32 v17, v17, v45
    v_cvt_pk_bf16_f32 v170, v16, v17
    v_pk_max_i16 v170, v170, 0
    v_cvt_pk_bf16_f32 v17, v62, v63
    v_lshlrev_b32 v16, 16, v17
    v_and_b32 v17, 0xffff0000, v17
    v_add_f32 v16, v16, v46
    v_add_f32 v17, v17, v47
    v_cvt_pk_bf16_f32 v171, v16, v17
    v_pk_max_i16 v171, v171, 0
    v_lshlrev_b32 v16, 16, v196
    v_lshlrev_b32 v17, 16, v244
    v_mul_f32 v16, v16, v17
    v_and_b32 v17, 0xffff0000, v196
    v_and_b32 v21, 0xffff0000, v244
    v_mul_f32 v17, v17, v21
    v_cvt_pk_bf16_f32 v108, v16, v17
    v_lshlrev_b32 v16, 16, v197
    v_lshlrev_b32 v17, 16, v245
    v_mul_f32 v16, v16, v17
    v_and_b32 v17, 0xffff0000, v197
    v_and_b32 v21, 0xffff0000, v245
    v_mul_f32 v17, v17, v21
    v_cvt_pk_bf16_f32 v109, v16, v17
    v_lshlrev_b32 v16, 16, v198
    v_lshlrev_b32 v17, 16, v246
    v_mul_f32 v16, v16, v17
    v_and_b32 v17, 0xffff0000, v198
    v_and_b32 v21, 0xffff0000, v246
    v_mul_f32 v17, v17, v21
    v_cvt_pk_bf16_f32 v110, v16, v17
    v_lshlrev_b32 v16, 16, v199
    v_lshlrev_b32 v17, 16, v247
    v_mul_f32 v16, v16, v17
    v_and_b32 v17, 0xffff0000, v199
    v_and_b32 v21, 0xffff0000, v247
    v_mul_f32 v17, v17, v21
    v_cvt_pk_bf16_f32 v111, v16, v17
    v_smfmac_f32_16x16x64_bf16 v[132:135], v[92:95], v[116:123], v1
    ds_read_b128 v[128:131], v11 offset:2048
    v_lshlrev_b32 v16, 16, v200
    v_lshlrev_b32 v17, 16, v248
    v_mul_f32 v16, v16, v17
    v_and_b32 v17, 0xffff0000, v200
    v_and_b32 v21, 0xffff0000, v248
    v_mul_f32 v17, v17, v21
    v_cvt_pk_bf16_f32 v112, v16, v17
    v_lshlrev_b32 v16, 16, v201
    v_lshlrev_b32 v17, 16, v249
    v_mul_f32 v16, v16, v17
    v_and_b32 v17, 0xffff0000, v201
    v_and_b32 v21, 0xffff0000, v249
    v_mul_f32 v17, v17, v21
    v_cvt_pk_bf16_f32 v113, v16, v17
    v_smfmac_f32_16x16x64_bf16 v[132:135], v[172:175], v[164:171], v1
    v_lshlrev_b32 v16, 16, v202
    v_lshlrev_b32 v17, 16, v250
    v_mul_f32 v16, v16, v17
    v_and_b32 v17, 0xffff0000, v202
    v_and_b32 v21, 0xffff0000, v250
    v_mul_f32 v17, v17, v21
    v_cvt_pk_bf16_f32 v114, v16, v17
    v_lshlrev_b32 v16, 16, v203
    v_lshlrev_b32 v17, 16, v251
    v_mul_f32 v16, v16, v17
    v_and_b32 v17, 0xffff0000, v203
    v_and_b32 v21, 0xffff0000, v251
    v_mul_f32 v17, v17, v21
    v_cvt_pk_bf16_f32 v115, v16, v17
    v_mfma_f32_32x32x16_bf16 v[48:63], v[80:83], v[108:111], 0
    v_cvt_pk_bf16_f32 v17, v64, v65
    v_lshlrev_b32 v16, 16, v17
    v_and_b32 v17, 0xffff0000, v17
    v_add_f32 v16, v16, v32
    v_add_f32 v17, v17, v33
    v_cvt_pk_bf16_f32 v164, v16, v17
    v_pk_max_i16 v164, v164, 0
    v_cvt_pk_bf16_f32 v17, v66, v67
    v_lshlrev_b32 v16, 16, v17
    v_and_b32 v17, 0xffff0000, v17
    v_add_f32 v16, v16, v34
    v_add_f32 v17, v17, v35
    v_cvt_pk_bf16_f32 v165, v16, v17
    v_pk_max_i16 v165, v165, 0
    v_cvt_pk_bf16_f32 v17, v68, v69
    v_lshlrev_b32 v16, 16, v17
    v_and_b32 v17, 0xffff0000, v17
    v_add_f32 v16, v16, v36
    v_add_f32 v17, v17, v37
    v_cvt_pk_bf16_f32 v166, v16, v17
    v_pk_max_i16 v166, v166, 0
    v_cvt_pk_bf16_f32 v17, v70, v71
    v_lshlrev_b32 v16, 16, v17
    v_and_b32 v17, 0xffff0000, v17
    v_add_f32 v16, v16, v38
    v_add_f32 v17, v17, v39
    v_cvt_pk_bf16_f32 v167, v16, v17
    v_pk_max_i16 v167, v167, 0
    v_cvt_pk_bf16_f32 v17, v72, v73
    v_lshlrev_b32 v16, 16, v17
    v_and_b32 v17, 0xffff0000, v17
    v_add_f32 v16, v16, v40
    v_add_f32 v17, v17, v41
    v_cvt_pk_bf16_f32 v168, v16, v17
    v_pk_max_i16 v168, v168, 0
    v_cvt_pk_bf16_f32 v17, v74, v75
    v_lshlrev_b32 v16, 16, v17
    v_and_b32 v17, 0xffff0000, v17
    v_add_f32 v16, v16, v42
    v_add_f32 v17, v17, v43
    v_cvt_pk_bf16_f32 v169, v16, v17
    v_pk_max_i16 v169, v169, 0
    v_mfma_f32_32x32x16_bf16 v[48:63], v[84:87], v[112:115], v[48:63]
    s_waitcnt lgkmcnt(1)
    v_cvt_pk_bf16_f32 v17, v76, v77
    v_lshlrev_b32 v16, 16, v17
    v_and_b32 v17, 0xffff0000, v17
    v_add_f32 v16, v16, v44
    v_add_f32 v17, v17, v45
    v_cvt_pk_bf16_f32 v170, v16, v17
    v_pk_max_i16 v170, v170, 0
    v_cvt_pk_bf16_f32 v17, v78, v79
    v_lshlrev_b32 v16, 16, v17
    v_and_b32 v17, 0xffff0000, v17
    v_add_f32 v16, v16, v46
    v_add_f32 v17, v17, v47
    v_cvt_pk_bf16_f32 v171, v16, v17
    v_pk_max_i16 v171, v171, 0
    v_lshlrev_b32 v16, 16, v236
    v_lshlrev_b32 v17, 16, v244
    v_mul_f32 v16, v16, v17
    v_and_b32 v17, 0xffff0000, v236
    v_and_b32 v21, 0xffff0000, v244
    v_mul_f32 v17, v17, v21
    v_cvt_pk_bf16_f32 v116, v16, v17
    v_lshlrev_b32 v16, 16, v237
    v_lshlrev_b32 v17, 16, v245
    v_mul_f32 v16, v16, v17
    v_and_b32 v17, 0xffff0000, v237
    v_and_b32 v21, 0xffff0000, v245
    v_mul_f32 v17, v17, v21
    v_cvt_pk_bf16_f32 v117, v16, v17
    v_lshlrev_b32 v16, 16, v238
    v_lshlrev_b32 v17, 16, v246
    v_mul_f32 v16, v16, v17
    v_and_b32 v17, 0xffff0000, v238
    v_and_b32 v21, 0xffff0000, v246
    v_mul_f32 v17, v17, v21
    v_cvt_pk_bf16_f32 v118, v16, v17
    v_lshlrev_b32 v16, 16, v239
    v_lshlrev_b32 v17, 16, v247
    v_mul_f32 v16, v16, v17
    v_and_b32 v17, 0xffff0000, v239
    v_and_b32 v21, 0xffff0000, v247
    v_mul_f32 v17, v17, v21
    v_cvt_pk_bf16_f32 v119, v16, v17
    v_smfmac_f32_16x16x64_bf16 v[124:127], v[88:91], v[108:115], v1
    v_lshlrev_b32 v16, 16, v240
    v_lshlrev_b32 v17, 16, v248
    v_mul_f32 v16, v16, v17
    v_and_b32 v17, 0xffff0000, v240
    v_and_b32 v21, 0xffff0000, v248
    v_mul_f32 v17, v17, v21
    v_cvt_pk_bf16_f32 v120, v16, v17
    v_lshlrev_b32 v16, 16, v241
    v_lshlrev_b32 v17, 16, v249
    v_mul_f32 v16, v16, v17
    v_and_b32 v17, 0xffff0000, v241
    v_and_b32 v21, 0xffff0000, v249
    v_mul_f32 v17, v17, v21
    v_cvt_pk_bf16_f32 v121, v16, v17
    v_smfmac_f32_16x16x64_bf16 v[132:135], v[176:179], v[164:171], v1
    v_lshlrev_b32 v16, 16, v242
    v_lshlrev_b32 v17, 16, v250
    v_mul_f32 v16, v16, v17
    v_and_b32 v17, 0xffff0000, v242
    v_and_b32 v21, 0xffff0000, v250
    v_mul_f32 v17, v17, v21
    v_cvt_pk_bf16_f32 v122, v16, v17
    v_lshlrev_b32 v16, 16, v243
    v_lshlrev_b32 v17, 16, v251
    v_mul_f32 v16, v16, v17
    v_and_b32 v17, 0xffff0000, v243
    v_and_b32 v21, 0xffff0000, v251
    v_mul_f32 v17, v17, v21
    v_cvt_pk_bf16_f32 v123, v16, v17
    v_mfma_f32_32x32x16_bf16 v[64:79], v[80:83], v[116:119], 0
    v_cvt_pk_bf16_f32 v17, v48, v49
    v_lshlrev_b32 v16, 16, v17
    v_and_b32 v17, 0xffff0000, v17
    v_add_f32 v16, v16, v32
    v_add_f32 v17, v17, v33
    v_cvt_pk_bf16_f32 v164, v16, v17
    v_pk_max_i16 v164, v164, 0
    v_cvt_pk_bf16_f32 v17, v50, v51
    v_lshlrev_b32 v16, 16, v17
    v_and_b32 v17, 0xffff0000, v17
    v_add_f32 v16, v16, v34
    v_add_f32 v17, v17, v35
    v_cvt_pk_bf16_f32 v165, v16, v17
    v_pk_max_i16 v165, v165, 0
    v_cvt_pk_bf16_f32 v17, v52, v53
    v_lshlrev_b32 v16, 16, v17
    v_and_b32 v17, 0xffff0000, v17
    v_add_f32 v16, v16, v36
    v_add_f32 v17, v17, v37
    v_cvt_pk_bf16_f32 v166, v16, v17
    v_pk_max_i16 v166, v166, 0
    v_cvt_pk_bf16_f32 v17, v54, v55
    v_lshlrev_b32 v16, 16, v17
    v_and_b32 v17, 0xffff0000, v17
    v_add_f32 v16, v16, v38
    v_add_f32 v17, v17, v39
    v_cvt_pk_bf16_f32 v167, v16, v17
    v_pk_max_i16 v167, v167, 0
    v_cvt_pk_bf16_f32 v17, v56, v57
    v_lshlrev_b32 v16, 16, v17
    v_and_b32 v17, 0xffff0000, v17
    v_add_f32 v16, v16, v40
    v_add_f32 v17, v17, v41
    v_cvt_pk_bf16_f32 v168, v16, v17
    v_pk_max_i16 v168, v168, 0
    v_cvt_pk_bf16_f32 v17, v58, v59
    v_lshlrev_b32 v16, 16, v17
    v_and_b32 v17, 0xffff0000, v17
    v_add_f32 v16, v16, v42
    v_add_f32 v17, v17, v43
    v_cvt_pk_bf16_f32 v169, v16, v17
    v_pk_max_i16 v169, v169, 0
    v_mfma_f32_32x32x16_bf16 v[64:79], v[84:87], v[120:123], v[64:79]
    v_add_f32 v141, v132, v133
    v_add_f32 v162, v134, v135
    v_cvt_pk_bf16_f32 v141, 0, v141
    v_cvt_pk_bf16_f32 v17, v60, v61
    v_lshlrev_b32 v16, 16, v17
    v_and_b32 v17, 0xffff0000, v17
    v_add_f32 v16, v16, v44
    v_add_f32 v17, v17, v45
    v_cvt_pk_bf16_f32 v170, v16, v17
    v_pk_max_i16 v170, v170, 0
    v_cvt_pk_bf16_f32 v17, v62, v63
    v_lshlrev_b32 v16, 16, v17
    v_and_b32 v17, 0xffff0000, v17
    v_add_f32 v16, v16, v46
    v_add_f32 v17, v17, v47
    v_cvt_pk_bf16_f32 v171, v16, v17
    v_pk_max_i16 v171, v171, 0
    v_lshlrev_b32 v16, 16, v180
    v_lshlrev_b32 v17, 16, v220
    v_mul_f32 v16, v16, v17
    v_and_b32 v17, 0xffff0000, v180
    v_and_b32 v21, 0xffff0000, v220
    v_mul_f32 v17, v17, v21
    v_cvt_pk_bf16_f32 v108, v16, v17
    v_lshlrev_b32 v16, 16, v181
    v_lshlrev_b32 v17, 16, v221
    v_mul_f32 v16, v16, v17
    v_and_b32 v17, 0xffff0000, v181
    v_and_b32 v21, 0xffff0000, v221
    v_mul_f32 v17, v17, v21
    v_cvt_pk_bf16_f32 v109, v16, v17
    v_lshlrev_b32 v16, 16, v182
    v_lshlrev_b32 v17, 16, v222
    v_mul_f32 v16, v16, v17
    v_and_b32 v17, 0xffff0000, v182
    v_and_b32 v21, 0xffff0000, v222
    v_mul_f32 v17, v17, v21
    v_cvt_pk_bf16_f32 v110, v16, v17
    v_lshlrev_b32 v16, 16, v183
    v_lshlrev_b32 v17, 16, v223
    v_mul_f32 v16, v16, v17
    v_and_b32 v17, 0xffff0000, v183
    v_and_b32 v21, 0xffff0000, v223
    v_mul_f32 v17, v17, v21
    v_cvt_pk_bf16_f32 v111, v16, v17
    v_smfmac_f32_16x16x64_bf16 v[124:127], v[92:95], v[116:123], v1
    ds_read_b128 v[132:135], v11 offset:2048
    v_lshlrev_b32 v16, 16, v184
    v_lshlrev_b32 v17, 16, v224
    v_mul_f32 v16, v16, v17
    v_and_b32 v17, 0xffff0000, v184
    v_and_b32 v21, 0xffff0000, v224
    v_mul_f32 v17, v17, v21
    v_cvt_pk_bf16_f32 v112, v16, v17
    v_lshlrev_b32 v16, 16, v185
    v_lshlrev_b32 v17, 16, v225
    v_mul_f32 v16, v16, v17
    v_and_b32 v17, 0xffff0000, v185
    v_and_b32 v21, 0xffff0000, v225
    v_mul_f32 v17, v17, v21
    v_cvt_pk_bf16_f32 v113, v16, v17
    v_smfmac_f32_16x16x64_bf16 v[124:127], v[172:175], v[164:171], v1
    v_lshlrev_b32 v16, 16, v186
    v_lshlrev_b32 v17, 16, v226
    v_mul_f32 v16, v16, v17
    v_and_b32 v17, 0xffff0000, v186
    v_and_b32 v21, 0xffff0000, v226
    v_mul_f32 v17, v17, v21
    v_cvt_pk_bf16_f32 v114, v16, v17
    v_lshlrev_b32 v16, 16, v187
    v_lshlrev_b32 v17, 16, v227
    v_mul_f32 v16, v16, v17
    v_and_b32 v17, 0xffff0000, v187
    v_and_b32 v21, 0xffff0000, v227
    v_mul_f32 v17, v17, v21
    v_cvt_pk_bf16_f32 v115, v16, v17
    v_mfma_f32_32x32x16_bf16 v[48:63], v[80:83], v[108:111], 0
    v_cvt_pk_bf16_f32 v17, v64, v65
    v_lshlrev_b32 v16, 16, v17
    v_and_b32 v17, 0xffff0000, v17
    v_add_f32 v16, v16, v32
    v_add_f32 v17, v17, v33
    v_cvt_pk_bf16_f32 v164, v16, v17
    v_pk_max_i16 v164, v164, 0
    v_cvt_pk_bf16_f32 v17, v66, v67
    v_lshlrev_b32 v16, 16, v17
    v_and_b32 v17, 0xffff0000, v17
    v_add_f32 v16, v16, v34
    v_add_f32 v17, v17, v35
    v_cvt_pk_bf16_f32 v165, v16, v17
    v_pk_max_i16 v165, v165, 0
    v_cvt_pk_bf16_f32 v17, v68, v69
    v_lshlrev_b32 v16, 16, v17
    v_and_b32 v17, 0xffff0000, v17
    v_add_f32 v16, v16, v36
    v_add_f32 v17, v17, v37
    v_cvt_pk_bf16_f32 v166, v16, v17
    v_pk_max_i16 v166, v166, 0
    v_cvt_pk_bf16_f32 v17, v70, v71
    v_lshlrev_b32 v16, 16, v17
    v_and_b32 v17, 0xffff0000, v17
    v_add_f32 v16, v16, v38
    v_add_f32 v17, v17, v39
    v_cvt_pk_bf16_f32 v167, v16, v17
    v_pk_max_i16 v167, v167, 0
    v_cvt_pk_bf16_f32 v17, v72, v73
    v_lshlrev_b32 v16, 16, v17
    v_and_b32 v17, 0xffff0000, v17
    v_add_f32 v16, v16, v40
    v_add_f32 v17, v17, v41
    v_cvt_pk_bf16_f32 v168, v16, v17
    v_pk_max_i16 v168, v168, 0
    v_cvt_pk_bf16_f32 v17, v74, v75
    v_lshlrev_b32 v16, 16, v17
    v_and_b32 v17, 0xffff0000, v17
    v_add_f32 v16, v16, v42
    v_add_f32 v17, v17, v43
    v_cvt_pk_bf16_f32 v169, v16, v17
    v_pk_max_i16 v169, v169, 0
    v_mfma_f32_32x32x16_bf16 v[48:63], v[84:87], v[112:115], v[48:63]
    s_waitcnt lgkmcnt(1)
    v_cvt_pk_bf16_f32 v17, v76, v77
    v_lshlrev_b32 v16, 16, v17
    v_and_b32 v17, 0xffff0000, v17
    v_add_f32 v16, v16, v44
    v_add_f32 v17, v17, v45
    v_cvt_pk_bf16_f32 v170, v16, v17
    v_pk_max_i16 v170, v170, 0
    v_cvt_pk_bf16_f32 v17, v78, v79
    v_lshlrev_b32 v16, 16, v17
    v_and_b32 v17, 0xffff0000, v17
    v_add_f32 v16, v16, v46
    v_add_f32 v17, v17, v47
    v_cvt_pk_bf16_f32 v171, v16, v17
    v_pk_max_i16 v171, v171, 0
    v_lshlrev_b32 v16, 16, v188
    v_lshlrev_b32 v17, 16, v220
    v_mul_f32 v16, v16, v17
    v_and_b32 v17, 0xffff0000, v188
    v_and_b32 v21, 0xffff0000, v220
    v_mul_f32 v17, v17, v21
    v_cvt_pk_bf16_f32 v116, v16, v17
    v_lshlrev_b32 v16, 16, v189
    v_lshlrev_b32 v17, 16, v221
    v_mul_f32 v16, v16, v17
    v_and_b32 v17, 0xffff0000, v189
    v_and_b32 v21, 0xffff0000, v221
    v_mul_f32 v17, v17, v21
    v_cvt_pk_bf16_f32 v117, v16, v17
    v_lshlrev_b32 v16, 16, v190
    v_lshlrev_b32 v17, 16, v222
    v_mul_f32 v16, v16, v17
    v_and_b32 v17, 0xffff0000, v190
    v_and_b32 v21, 0xffff0000, v222
    v_mul_f32 v17, v17, v21
    v_cvt_pk_bf16_f32 v118, v16, v17
    v_lshlrev_b32 v16, 16, v191
    v_lshlrev_b32 v17, 16, v223
    v_mul_f32 v16, v16, v17
    v_and_b32 v17, 0xffff0000, v191
    v_and_b32 v21, 0xffff0000, v223
    v_mul_f32 v17, v17, v21
    v_cvt_pk_bf16_f32 v119, v16, v17
    v_smfmac_f32_16x16x64_bf16 v[128:131], v[88:91], v[108:115], v1
    v_lshlrev_b32 v16, 16, v192
    v_lshlrev_b32 v17, 16, v224
    v_mul_f32 v16, v16, v17
    v_and_b32 v17, 0xffff0000, v192
    v_and_b32 v21, 0xffff0000, v224
    v_mul_f32 v17, v17, v21
    v_cvt_pk_bf16_f32 v120, v16, v17
    v_lshlrev_b32 v16, 16, v193
    v_lshlrev_b32 v17, 16, v225
    v_mul_f32 v16, v16, v17
    v_and_b32 v17, 0xffff0000, v193
    v_and_b32 v21, 0xffff0000, v225
    v_mul_f32 v17, v17, v21
    v_cvt_pk_bf16_f32 v121, v16, v17
    v_smfmac_f32_16x16x64_bf16 v[124:127], v[176:179], v[164:171], v1
    v_lshlrev_b32 v16, 16, v194
    v_lshlrev_b32 v17, 16, v226
    v_mul_f32 v16, v16, v17
    v_and_b32 v17, 0xffff0000, v194
    v_and_b32 v21, 0xffff0000, v226
    v_mul_f32 v17, v17, v21
    v_cvt_pk_bf16_f32 v122, v16, v17
    v_lshlrev_b32 v16, 16, v195
    v_lshlrev_b32 v17, 16, v227
    v_mul_f32 v16, v16, v17
    v_and_b32 v17, 0xffff0000, v195
    v_and_b32 v21, 0xffff0000, v227
    v_mul_f32 v17, v17, v21
    v_cvt_pk_bf16_f32 v123, v16, v17
    v_mfma_f32_32x32x16_bf16 v[64:79], v[80:83], v[116:119], 0
    v_cvt_pk_bf16_f32 v17, v48, v49
    v_lshlrev_b32 v16, 16, v17
    v_and_b32 v17, 0xffff0000, v17
    v_add_f32 v16, v16, v32
    v_add_f32 v17, v17, v33
    v_cvt_pk_bf16_f32 v164, v16, v17
    v_pk_max_i16 v164, v164, 0
    v_cvt_pk_bf16_f32 v17, v50, v51
    v_lshlrev_b32 v16, 16, v17
    v_and_b32 v17, 0xffff0000, v17
    v_add_f32 v16, v16, v34
    v_add_f32 v17, v17, v35
    v_cvt_pk_bf16_f32 v165, v16, v17
    v_pk_max_i16 v165, v165, 0
    v_cvt_pk_bf16_f32 v17, v52, v53
    v_lshlrev_b32 v16, 16, v17
    v_and_b32 v17, 0xffff0000, v17
    v_add_f32 v16, v16, v36
    v_add_f32 v17, v17, v37
    v_cvt_pk_bf16_f32 v166, v16, v17
    v_pk_max_i16 v166, v166, 0
    v_cvt_pk_bf16_f32 v17, v54, v55
    v_lshlrev_b32 v16, 16, v17
    v_and_b32 v17, 0xffff0000, v17
    v_add_f32 v16, v16, v38
    v_add_f32 v17, v17, v39
    v_cvt_pk_bf16_f32 v167, v16, v17
    v_pk_max_i16 v167, v167, 0
    v_cvt_pk_bf16_f32 v17, v56, v57
    v_lshlrev_b32 v16, 16, v17
    v_and_b32 v17, 0xffff0000, v17
    v_add_f32 v16, v16, v40
    v_add_f32 v17, v17, v41
    v_cvt_pk_bf16_f32 v168, v16, v17
    v_pk_max_i16 v168, v168, 0
    v_cvt_pk_bf16_f32 v17, v58, v59
    v_lshlrev_b32 v16, 16, v17
    v_and_b32 v17, 0xffff0000, v17
    v_add_f32 v16, v16, v42
    v_add_f32 v17, v17, v43
    v_cvt_pk_bf16_f32 v169, v16, v17
    v_pk_max_i16 v169, v169, 0
    v_mfma_f32_32x32x16_bf16 v[64:79], v[84:87], v[120:123], v[64:79]
    v_add_f32 v142, v124, v125
    v_add_f32 v163, v126, v127
    v_cvt_pk_bf16_f32 v142, 0, v142
    v_cvt_pk_bf16_f32 v17, v60, v61
    v_lshlrev_b32 v16, 16, v17
    v_and_b32 v17, 0xffff0000, v17
    v_add_f32 v16, v16, v44
    v_add_f32 v17, v17, v45
    v_cvt_pk_bf16_f32 v170, v16, v17
    v_pk_max_i16 v170, v170, 0
    v_cvt_pk_bf16_f32 v17, v62, v63
    v_lshlrev_b32 v16, 16, v17
    v_and_b32 v17, 0xffff0000, v17
    v_add_f32 v16, v16, v46
    v_add_f32 v17, v17, v47
    v_cvt_pk_bf16_f32 v171, v16, v17
    v_pk_max_i16 v171, v171, 0
    v_lshlrev_b32 v16, 16, v236
    v_lshlrev_b32 v17, 16, v220
    v_mul_f32 v16, v16, v17
    v_and_b32 v17, 0xffff0000, v236
    v_and_b32 v21, 0xffff0000, v220
    v_mul_f32 v17, v17, v21
    v_cvt_pk_bf16_f32 v108, v16, v17
    v_lshlrev_b32 v16, 16, v237
    v_lshlrev_b32 v17, 16, v221
    v_mul_f32 v16, v16, v17
    v_and_b32 v17, 0xffff0000, v237
    v_and_b32 v21, 0xffff0000, v221
    v_mul_f32 v17, v17, v21
    v_cvt_pk_bf16_f32 v109, v16, v17
    v_lshlrev_b32 v16, 16, v238
    v_lshlrev_b32 v17, 16, v222
    v_mul_f32 v16, v16, v17
    v_and_b32 v17, 0xffff0000, v238
    v_and_b32 v21, 0xffff0000, v222
    v_mul_f32 v17, v17, v21
    v_cvt_pk_bf16_f32 v110, v16, v17
    v_lshlrev_b32 v16, 16, v239
    v_lshlrev_b32 v17, 16, v223
    v_mul_f32 v16, v16, v17
    v_and_b32 v17, 0xffff0000, v239
    v_and_b32 v21, 0xffff0000, v223
    v_mul_f32 v17, v17, v21
    v_cvt_pk_bf16_f32 v111, v16, v17
    v_smfmac_f32_16x16x64_bf16 v[128:131], v[92:95], v[116:123], v1
    ds_read_b128 v[124:127], v11 offset:2048
    v_lshlrev_b32 v16, 16, v240
    v_lshlrev_b32 v17, 16, v224
    v_mul_f32 v16, v16, v17
    v_and_b32 v17, 0xffff0000, v240
    v_and_b32 v21, 0xffff0000, v224
    v_mul_f32 v17, v17, v21
    v_cvt_pk_bf16_f32 v112, v16, v17
    v_lshlrev_b32 v16, 16, v241
    v_lshlrev_b32 v17, 16, v225
    v_mul_f32 v16, v16, v17
    v_and_b32 v17, 0xffff0000, v241
    v_and_b32 v21, 0xffff0000, v225
    v_mul_f32 v17, v17, v21
    v_cvt_pk_bf16_f32 v113, v16, v17
    v_smfmac_f32_16x16x64_bf16 v[128:131], v[172:175], v[164:171], v1
    v_lshlrev_b32 v16, 16, v242
    v_lshlrev_b32 v17, 16, v226
    v_mul_f32 v16, v16, v17
    v_and_b32 v17, 0xffff0000, v242
    v_and_b32 v21, 0xffff0000, v226
    v_mul_f32 v17, v17, v21
    v_cvt_pk_bf16_f32 v114, v16, v17
    v_lshlrev_b32 v16, 16, v243
    v_lshlrev_b32 v17, 16, v227
    v_mul_f32 v16, v16, v17
    v_and_b32 v17, 0xffff0000, v243
    v_and_b32 v21, 0xffff0000, v227
    v_mul_f32 v17, v17, v21
    v_cvt_pk_bf16_f32 v115, v16, v17
    v_mfma_f32_32x32x16_bf16 v[48:63], v[80:83], v[108:111], 0
    v_cvt_pk_bf16_f32 v17, v64, v65
    v_lshlrev_b32 v16, 16, v17
    v_and_b32 v17, 0xffff0000, v17
    v_add_f32 v16, v16, v32
    v_add_f32 v17, v17, v33
    v_cvt_pk_bf16_f32 v164, v16, v17
    v_pk_max_i16 v164, v164, 0
    v_cvt_pk_bf16_f32 v17, v66, v67
    v_lshlrev_b32 v16, 16, v17
    v_and_b32 v17, 0xffff0000, v17
    v_add_f32 v16, v16, v34
    v_add_f32 v17, v17, v35
    v_cvt_pk_bf16_f32 v165, v16, v17
    v_pk_max_i16 v165, v165, 0
    v_cvt_pk_bf16_f32 v17, v68, v69
    v_lshlrev_b32 v16, 16, v17
    v_and_b32 v17, 0xffff0000, v17
    v_add_f32 v16, v16, v36
    v_add_f32 v17, v17, v37
    v_cvt_pk_bf16_f32 v166, v16, v17
    v_pk_max_i16 v166, v166, 0
    v_cvt_pk_bf16_f32 v17, v70, v71
    v_lshlrev_b32 v16, 16, v17
    v_and_b32 v17, 0xffff0000, v17
    v_add_f32 v16, v16, v38
    v_add_f32 v17, v17, v39
    v_cvt_pk_bf16_f32 v167, v16, v17
    v_pk_max_i16 v167, v167, 0
    v_cvt_pk_bf16_f32 v17, v72, v73
    v_lshlrev_b32 v16, 16, v17
    v_and_b32 v17, 0xffff0000, v17
    v_add_f32 v16, v16, v40
    v_add_f32 v17, v17, v41
    v_cvt_pk_bf16_f32 v168, v16, v17
    v_pk_max_i16 v168, v168, 0
    v_cvt_pk_bf16_f32 v17, v74, v75
    v_lshlrev_b32 v16, 16, v17
    v_and_b32 v17, 0xffff0000, v17
    v_add_f32 v16, v16, v42
    v_add_f32 v17, v17, v43
    v_cvt_pk_bf16_f32 v169, v16, v17
    v_pk_max_i16 v169, v169, 0
    v_mfma_f32_32x32x16_bf16 v[48:63], v[84:87], v[112:115], v[48:63]
    s_waitcnt lgkmcnt(1)
    v_cvt_pk_bf16_f32 v17, v76, v77
    v_lshlrev_b32 v16, 16, v17
    v_and_b32 v17, 0xffff0000, v17
    v_add_f32 v16, v16, v44
    v_add_f32 v17, v17, v45
    v_cvt_pk_bf16_f32 v170, v16, v17
    v_pk_max_i16 v170, v170, 0
    v_cvt_pk_bf16_f32 v17, v78, v79
    v_lshlrev_b32 v16, 16, v17
    v_and_b32 v17, 0xffff0000, v17
    v_add_f32 v16, v16, v46
    v_add_f32 v17, v17, v47
    v_cvt_pk_bf16_f32 v171, v16, v17
    v_pk_max_i16 v171, v171, 0
    v_lshlrev_b32 v16, 16, v244
    v_lshlrev_b32 v17, 16, v220
    v_mul_f32 v16, v16, v17
    v_and_b32 v17, 0xffff0000, v244
    v_and_b32 v21, 0xffff0000, v220
    v_mul_f32 v17, v17, v21
    v_cvt_pk_bf16_f32 v116, v16, v17
    v_lshlrev_b32 v16, 16, v245
    v_lshlrev_b32 v17, 16, v221
    v_mul_f32 v16, v16, v17
    v_and_b32 v17, 0xffff0000, v245
    v_and_b32 v21, 0xffff0000, v221
    v_mul_f32 v17, v17, v21
    v_cvt_pk_bf16_f32 v117, v16, v17
    v_lshlrev_b32 v16, 16, v246
    v_lshlrev_b32 v17, 16, v222
    v_mul_f32 v16, v16, v17
    v_and_b32 v17, 0xffff0000, v246
    v_and_b32 v21, 0xffff0000, v222
    v_mul_f32 v17, v17, v21
    v_cvt_pk_bf16_f32 v118, v16, v17
    v_lshlrev_b32 v16, 16, v247
    v_lshlrev_b32 v17, 16, v223
    v_mul_f32 v16, v16, v17
    v_and_b32 v17, 0xffff0000, v247
    v_and_b32 v21, 0xffff0000, v223
    v_mul_f32 v17, v17, v21
    v_cvt_pk_bf16_f32 v119, v16, v17
    v_smfmac_f32_16x16x64_bf16 v[132:135], v[88:91], v[108:115], v1
    v_lshlrev_b32 v16, 16, v248
    v_lshlrev_b32 v17, 16, v224
    v_mul_f32 v16, v16, v17
    v_and_b32 v17, 0xffff0000, v248
    v_and_b32 v21, 0xffff0000, v224
    v_mul_f32 v17, v17, v21
    v_cvt_pk_bf16_f32 v120, v16, v17
    v_lshlrev_b32 v16, 16, v249
    v_lshlrev_b32 v17, 16, v225
    v_mul_f32 v16, v16, v17
    v_and_b32 v17, 0xffff0000, v249
    v_and_b32 v21, 0xffff0000, v225
    v_mul_f32 v17, v17, v21
    v_cvt_pk_bf16_f32 v121, v16, v17
    v_smfmac_f32_16x16x64_bf16 v[128:131], v[176:179], v[164:171], v1
    v_lshlrev_b32 v16, 16, v250
    v_lshlrev_b32 v17, 16, v226
    v_mul_f32 v16, v16, v17
    v_and_b32 v17, 0xffff0000, v250
    v_and_b32 v21, 0xffff0000, v226
    v_mul_f32 v17, v17, v21
    v_cvt_pk_bf16_f32 v122, v16, v17
    v_lshlrev_b32 v16, 16, v251
    v_lshlrev_b32 v17, 16, v227
    v_mul_f32 v16, v16, v17
    v_and_b32 v17, 0xffff0000, v251
    v_and_b32 v21, 0xffff0000, v227
    v_mul_f32 v17, v17, v21
    v_cvt_pk_bf16_f32 v123, v16, v17
    v_mfma_f32_32x32x16_bf16 v[64:79], v[80:83], v[116:119], 0
    v_cvt_pk_bf16_f32 v17, v48, v49
    v_lshlrev_b32 v16, 16, v17
    v_and_b32 v17, 0xffff0000, v17
    v_add_f32 v16, v16, v32
    v_add_f32 v17, v17, v33
    v_cvt_pk_bf16_f32 v164, v16, v17
    v_pk_max_i16 v164, v164, 0
    v_cvt_pk_bf16_f32 v17, v50, v51
    v_lshlrev_b32 v16, 16, v17
    v_and_b32 v17, 0xffff0000, v17
    v_add_f32 v16, v16, v34
    v_add_f32 v17, v17, v35
    v_cvt_pk_bf16_f32 v165, v16, v17
    v_pk_max_i16 v165, v165, 0
    v_cvt_pk_bf16_f32 v17, v52, v53
    v_lshlrev_b32 v16, 16, v17
    v_and_b32 v17, 0xffff0000, v17
    v_add_f32 v16, v16, v36
    v_add_f32 v17, v17, v37
    v_cvt_pk_bf16_f32 v166, v16, v17
    v_pk_max_i16 v166, v166, 0
    v_cvt_pk_bf16_f32 v17, v54, v55
    v_lshlrev_b32 v16, 16, v17
    v_and_b32 v17, 0xffff0000, v17
    v_add_f32 v16, v16, v38
    v_add_f32 v17, v17, v39
    v_cvt_pk_bf16_f32 v167, v16, v17
    v_pk_max_i16 v167, v167, 0
    v_cvt_pk_bf16_f32 v17, v56, v57
    v_lshlrev_b32 v16, 16, v17
    v_and_b32 v17, 0xffff0000, v17
    v_add_f32 v16, v16, v40
    v_add_f32 v17, v17, v41
    v_cvt_pk_bf16_f32 v168, v16, v17
    v_pk_max_i16 v168, v168, 0
    v_cvt_pk_bf16_f32 v17, v58, v59
    v_lshlrev_b32 v16, 16, v17
    v_and_b32 v17, 0xffff0000, v17
    v_add_f32 v16, v16, v42
    v_add_f32 v17, v17, v43
    v_cvt_pk_bf16_f32 v169, v16, v17
    v_pk_max_i16 v169, v169, 0
    v_mfma_f32_32x32x16_bf16 v[64:79], v[84:87], v[120:123], v[64:79]
    v_add_f32 v143, v128, v129
    v_add_f32 v100, v130, v131
    v_cvt_pk_bf16_f32 v143, 0, v143
    v_cvt_pk_bf16_f32 v17, v60, v61
    v_lshlrev_b32 v16, 16, v17
    v_and_b32 v17, 0xffff0000, v17
    v_add_f32 v16, v16, v44
    v_add_f32 v17, v17, v45
    v_cvt_pk_bf16_f32 v170, v16, v17
    v_pk_max_i16 v170, v170, 0
    v_cvt_pk_bf16_f32 v17, v62, v63
    v_lshlrev_b32 v16, 16, v17
    v_and_b32 v17, 0xffff0000, v17
    v_add_f32 v16, v16, v46
    v_add_f32 v17, v17, v47
    v_cvt_pk_bf16_f32 v171, v16, v17
    v_pk_max_i16 v171, v171, 0
    v_lshlrev_b32 v16, 16, v204
    v_lshlrev_b32 v17, 16, v228
    v_mul_f32 v16, v16, v17
    v_and_b32 v17, 0xffff0000, v204
    v_and_b32 v21, 0xffff0000, v228
    v_mul_f32 v17, v17, v21
    v_cvt_pk_bf16_f32 v108, v16, v17
    v_lshlrev_b32 v16, 16, v205
    v_lshlrev_b32 v17, 16, v229
    v_mul_f32 v16, v16, v17
    v_and_b32 v17, 0xffff0000, v205
    v_and_b32 v21, 0xffff0000, v229
    v_mul_f32 v17, v17, v21
    v_cvt_pk_bf16_f32 v109, v16, v17
    v_lshlrev_b32 v16, 16, v206
    v_lshlrev_b32 v17, 16, v230
    v_mul_f32 v16, v16, v17
    v_and_b32 v17, 0xffff0000, v206
    v_and_b32 v21, 0xffff0000, v230
    v_mul_f32 v17, v17, v21
    v_cvt_pk_bf16_f32 v110, v16, v17
    v_lshlrev_b32 v16, 16, v207
    v_lshlrev_b32 v17, 16, v231
    v_mul_f32 v16, v16, v17
    v_and_b32 v17, 0xffff0000, v207
    v_and_b32 v21, 0xffff0000, v231
    v_mul_f32 v17, v17, v21
    v_cvt_pk_bf16_f32 v111, v16, v17
    v_smfmac_f32_16x16x64_bf16 v[132:135], v[92:95], v[116:123], v1
    ds_read_b128 v[128:131], v11 offset:2048
    v_lshlrev_b32 v16, 16, v208
    v_lshlrev_b32 v17, 16, v232
    v_mul_f32 v16, v16, v17
    v_and_b32 v17, 0xffff0000, v208
    v_and_b32 v21, 0xffff0000, v232
    v_mul_f32 v17, v17, v21
    v_cvt_pk_bf16_f32 v112, v16, v17
    v_lshlrev_b32 v16, 16, v209
    v_lshlrev_b32 v17, 16, v233
    v_mul_f32 v16, v16, v17
    v_and_b32 v17, 0xffff0000, v209
    v_and_b32 v21, 0xffff0000, v233
    v_mul_f32 v17, v17, v21
    v_cvt_pk_bf16_f32 v113, v16, v17
    v_smfmac_f32_16x16x64_bf16 v[132:135], v[172:175], v[164:171], v1
    v_lshlrev_b32 v16, 16, v210
    v_lshlrev_b32 v17, 16, v234
    v_mul_f32 v16, v16, v17
    v_and_b32 v17, 0xffff0000, v210
    v_and_b32 v21, 0xffff0000, v234
    v_mul_f32 v17, v17, v21
    v_cvt_pk_bf16_f32 v114, v16, v17
    v_lshlrev_b32 v16, 16, v211
    v_lshlrev_b32 v17, 16, v235
    v_mul_f32 v16, v16, v17
    v_and_b32 v17, 0xffff0000, v211
    v_and_b32 v21, 0xffff0000, v235
    v_mul_f32 v17, v17, v21
    v_cvt_pk_bf16_f32 v115, v16, v17
    v_mfma_f32_32x32x16_bf16 v[48:63], v[80:83], v[108:111], 0
    v_cvt_pk_bf16_f32 v17, v64, v65
    v_lshlrev_b32 v16, 16, v17
    v_and_b32 v17, 0xffff0000, v17
    v_add_f32 v16, v16, v32
    v_add_f32 v17, v17, v33
    v_cvt_pk_bf16_f32 v164, v16, v17
    v_pk_max_i16 v164, v164, 0
    v_cvt_pk_bf16_f32 v17, v66, v67
    v_lshlrev_b32 v16, 16, v17
    v_and_b32 v17, 0xffff0000, v17
    v_add_f32 v16, v16, v34
    v_add_f32 v17, v17, v35
    v_cvt_pk_bf16_f32 v165, v16, v17
    v_pk_max_i16 v165, v165, 0
    v_cvt_pk_bf16_f32 v17, v68, v69
    v_lshlrev_b32 v16, 16, v17
    v_and_b32 v17, 0xffff0000, v17
    v_add_f32 v16, v16, v36
    v_add_f32 v17, v17, v37
    v_cvt_pk_bf16_f32 v166, v16, v17
    v_pk_max_i16 v166, v166, 0
    v_cvt_pk_bf16_f32 v17, v70, v71
    v_lshlrev_b32 v16, 16, v17
    v_and_b32 v17, 0xffff0000, v17
    v_add_f32 v16, v16, v38
    v_add_f32 v17, v17, v39
    v_cvt_pk_bf16_f32 v167, v16, v17
    v_pk_max_i16 v167, v167, 0
    v_cvt_pk_bf16_f32 v17, v72, v73
    v_lshlrev_b32 v16, 16, v17
    v_and_b32 v17, 0xffff0000, v17
    v_add_f32 v16, v16, v40
    v_add_f32 v17, v17, v41
    v_cvt_pk_bf16_f32 v168, v16, v17
    v_pk_max_i16 v168, v168, 0
    v_cvt_pk_bf16_f32 v17, v74, v75
    v_lshlrev_b32 v16, 16, v17
    v_and_b32 v17, 0xffff0000, v17
    v_add_f32 v16, v16, v42
    v_add_f32 v17, v17, v43
    v_cvt_pk_bf16_f32 v169, v16, v17
    v_pk_max_i16 v169, v169, 0
    v_mfma_f32_32x32x16_bf16 v[48:63], v[84:87], v[112:115], v[48:63]
    s_waitcnt lgkmcnt(1)
    v_cvt_pk_bf16_f32 v17, v76, v77
    v_lshlrev_b32 v16, 16, v17
    v_and_b32 v17, 0xffff0000, v17
    v_add_f32 v16, v16, v44
    v_add_f32 v17, v17, v45
    v_cvt_pk_bf16_f32 v170, v16, v17
    v_pk_max_i16 v170, v170, 0
    v_cvt_pk_bf16_f32 v17, v78, v79
    v_lshlrev_b32 v16, 16, v17
    v_and_b32 v17, 0xffff0000, v17
    v_add_f32 v16, v16, v46
    v_add_f32 v17, v17, v47
    v_cvt_pk_bf16_f32 v171, v16, v17
    v_pk_max_i16 v171, v171, 0
    v_lshlrev_b32 v16, 16, v212
    v_lshlrev_b32 v17, 16, v228
    v_mul_f32 v16, v16, v17
    v_and_b32 v17, 0xffff0000, v212
    v_and_b32 v21, 0xffff0000, v228
    v_mul_f32 v17, v17, v21
    v_cvt_pk_bf16_f32 v116, v16, v17
    v_lshlrev_b32 v16, 16, v213
    v_lshlrev_b32 v17, 16, v229
    v_mul_f32 v16, v16, v17
    v_and_b32 v17, 0xffff0000, v213
    v_and_b32 v21, 0xffff0000, v229
    v_mul_f32 v17, v17, v21
    v_cvt_pk_bf16_f32 v117, v16, v17
    v_lshlrev_b32 v16, 16, v214
    v_lshlrev_b32 v17, 16, v230
    v_mul_f32 v16, v16, v17
    v_and_b32 v17, 0xffff0000, v214
    v_and_b32 v21, 0xffff0000, v230
    v_mul_f32 v17, v17, v21
    v_cvt_pk_bf16_f32 v118, v16, v17
    v_lshlrev_b32 v16, 16, v215
    v_lshlrev_b32 v17, 16, v231
    v_mul_f32 v16, v16, v17
    v_and_b32 v17, 0xffff0000, v215
    v_and_b32 v21, 0xffff0000, v231
    v_mul_f32 v17, v17, v21
    v_cvt_pk_bf16_f32 v119, v16, v17
    v_smfmac_f32_16x16x64_bf16 v[124:127], v[88:91], v[108:115], v1
    ds_read_b128 v[204:207], v4 offset:1024
    v_lshlrev_b32 v16, 16, v216
    v_lshlrev_b32 v17, 16, v232
    v_mul_f32 v16, v16, v17
    v_and_b32 v17, 0xffff0000, v216
    v_and_b32 v21, 0xffff0000, v232
    v_mul_f32 v17, v17, v21
    v_cvt_pk_bf16_f32 v120, v16, v17
    v_lshlrev_b32 v16, 16, v217
    v_lshlrev_b32 v17, 16, v233
    v_mul_f32 v16, v16, v17
    v_and_b32 v17, 0xffff0000, v217
    v_and_b32 v21, 0xffff0000, v233
    v_mul_f32 v17, v17, v21
    v_cvt_pk_bf16_f32 v121, v16, v17
    v_smfmac_f32_16x16x64_bf16 v[132:135], v[176:179], v[164:171], v1
    ds_read_b128 v[208:211], v4 offset:5184
    v_lshlrev_b32 v16, 16, v218
    v_lshlrev_b32 v17, 16, v234
    v_mul_f32 v16, v16, v17
    v_and_b32 v17, 0xffff0000, v218
    v_and_b32 v21, 0xffff0000, v234
    v_mul_f32 v17, v17, v21
    v_cvt_pk_bf16_f32 v122, v16, v17
    v_lshlrev_b32 v16, 16, v219
    v_lshlrev_b32 v17, 16, v235
    v_mul_f32 v16, v16, v17
    v_and_b32 v17, 0xffff0000, v219
    v_and_b32 v21, 0xffff0000, v235
    v_mul_f32 v17, v17, v21
    v_cvt_pk_bf16_f32 v123, v16, v17
    v_mfma_f32_32x32x16_bf16 v[64:79], v[80:83], v[116:119], 0
    v_cvt_pk_bf16_f32 v17, v48, v49
    v_lshlrev_b32 v16, 16, v17
    v_and_b32 v17, 0xffff0000, v17
    v_add_f32 v16, v16, v32
    v_add_f32 v17, v17, v33
    v_cvt_pk_bf16_f32 v164, v16, v17
    v_pk_max_i16 v164, v164, 0
    v_cvt_pk_bf16_f32 v17, v50, v51
    v_lshlrev_b32 v16, 16, v17
    v_and_b32 v17, 0xffff0000, v17
    v_add_f32 v16, v16, v34
    v_add_f32 v17, v17, v35
    v_cvt_pk_bf16_f32 v165, v16, v17
    v_pk_max_i16 v165, v165, 0
    v_cvt_pk_bf16_f32 v17, v52, v53
    v_lshlrev_b32 v16, 16, v17
    v_and_b32 v17, 0xffff0000, v17
    v_add_f32 v16, v16, v36
    v_add_f32 v17, v17, v37
    v_cvt_pk_bf16_f32 v166, v16, v17
    v_pk_max_i16 v166, v166, 0
    v_cvt_pk_bf16_f32 v17, v54, v55
    v_lshlrev_b32 v16, 16, v17
    v_and_b32 v17, 0xffff0000, v17
    v_add_f32 v16, v16, v38
    v_add_f32 v17, v17, v39
    v_cvt_pk_bf16_f32 v167, v16, v17
    v_pk_max_i16 v167, v167, 0
    v_cvt_pk_bf16_f32 v17, v56, v57
    v_lshlrev_b32 v16, 16, v17
    v_and_b32 v17, 0xffff0000, v17
    v_add_f32 v16, v16, v40
    v_add_f32 v17, v17, v41
    v_cvt_pk_bf16_f32 v168, v16, v17
    v_pk_max_i16 v168, v168, 0
    v_cvt_pk_bf16_f32 v17, v58, v59
    v_lshlrev_b32 v16, 16, v17
    v_and_b32 v17, 0xffff0000, v17
    v_add_f32 v16, v16, v42
    v_add_f32 v17, v17, v43
    v_cvt_pk_bf16_f32 v169, v16, v17
    v_pk_max_i16 v169, v169, 0
    v_mfma_f32_32x32x16_bf16 v[64:79], v[84:87], v[120:123], v[64:79]
    v_add_f32 v144, v132, v133
    v_add_f32 v101, v134, v135
    v_cvt_pk_bf16_f32 v144, 0, v144
    v_cvt_pk_bf16_f32 v17, v60, v61
    v_lshlrev_b32 v16, 16, v17
    v_and_b32 v17, 0xffff0000, v17
    v_add_f32 v16, v16, v44
    v_add_f32 v17, v17, v45
    v_cvt_pk_bf16_f32 v170, v16, v17
    v_pk_max_i16 v170, v170, 0
    v_cvt_pk_bf16_f32 v17, v62, v63
    v_lshlrev_b32 v16, 16, v17
    v_and_b32 v17, 0xffff0000, v17
    v_add_f32 v16, v16, v46
    v_add_f32 v17, v17, v47
    v_cvt_pk_bf16_f32 v171, v16, v17
    v_pk_max_i16 v171, v171, 0
    v_lshlrev_b32 v16, 16, v188
    v_lshlrev_b32 v17, 16, v228
    v_mul_f32 v16, v16, v17
    v_and_b32 v17, 0xffff0000, v188
    v_and_b32 v21, 0xffff0000, v228
    v_mul_f32 v17, v17, v21
    v_cvt_pk_bf16_f32 v108, v16, v17
    v_lshlrev_b32 v16, 16, v189
    v_lshlrev_b32 v17, 16, v229
    v_mul_f32 v16, v16, v17
    v_and_b32 v17, 0xffff0000, v189
    v_and_b32 v21, 0xffff0000, v229
    v_mul_f32 v17, v17, v21
    v_cvt_pk_bf16_f32 v109, v16, v17
    v_lshlrev_b32 v16, 16, v190
    v_lshlrev_b32 v17, 16, v230
    v_mul_f32 v16, v16, v17
    v_and_b32 v17, 0xffff0000, v190
    v_and_b32 v21, 0xffff0000, v230
    v_mul_f32 v17, v17, v21
    v_cvt_pk_bf16_f32 v110, v16, v17
    v_lshlrev_b32 v16, 16, v191
    v_lshlrev_b32 v17, 16, v231
    v_mul_f32 v16, v16, v17
    v_and_b32 v17, 0xffff0000, v191
    v_and_b32 v21, 0xffff0000, v231
    v_mul_f32 v17, v17, v21
    v_cvt_pk_bf16_f32 v111, v16, v17
    v_smfmac_f32_16x16x64_bf16 v[124:127], v[92:95], v[116:123], v1
    ds_read_b128 v[132:135], v11 offset:2048
    v_lshlrev_b32 v16, 16, v192
    v_lshlrev_b32 v17, 16, v232
    v_mul_f32 v16, v16, v17
    v_and_b32 v17, 0xffff0000, v192
    v_and_b32 v21, 0xffff0000, v232
    v_mul_f32 v17, v17, v21
    v_cvt_pk_bf16_f32 v112, v16, v17
    v_lshlrev_b32 v16, 16, v193
    v_lshlrev_b32 v17, 16, v233
    v_mul_f32 v16, v16, v17
    v_and_b32 v17, 0xffff0000, v193
    v_and_b32 v21, 0xffff0000, v233
    v_mul_f32 v17, v17, v21
    v_cvt_pk_bf16_f32 v113, v16, v17
    v_smfmac_f32_16x16x64_bf16 v[124:127], v[172:175], v[164:171], v1
    ds_read_b128 v[212:215], v5 offset:0
    v_lshlrev_b32 v16, 16, v194
    v_lshlrev_b32 v17, 16, v234
    v_mul_f32 v16, v16, v17
    v_and_b32 v17, 0xffff0000, v194
    v_and_b32 v21, 0xffff0000, v234
    v_mul_f32 v17, v17, v21
    v_cvt_pk_bf16_f32 v114, v16, v17
    v_lshlrev_b32 v16, 16, v195
    v_lshlrev_b32 v17, 16, v235
    v_mul_f32 v16, v16, v17
    v_and_b32 v17, 0xffff0000, v195
    v_and_b32 v21, 0xffff0000, v235
    v_mul_f32 v17, v17, v21
    v_cvt_pk_bf16_f32 v115, v16, v17
    v_mfma_f32_32x32x16_bf16 v[48:63], v[80:83], v[108:111], 0
    v_cvt_pk_bf16_f32 v17, v64, v65
    v_lshlrev_b32 v16, 16, v17
    v_and_b32 v17, 0xffff0000, v17
    v_add_f32 v16, v16, v32
    v_add_f32 v17, v17, v33
    v_cvt_pk_bf16_f32 v164, v16, v17
    v_pk_max_i16 v164, v164, 0
    v_cvt_pk_bf16_f32 v17, v66, v67
    v_lshlrev_b32 v16, 16, v17
    v_and_b32 v17, 0xffff0000, v17
    v_add_f32 v16, v16, v34
    v_add_f32 v17, v17, v35
    v_cvt_pk_bf16_f32 v165, v16, v17
    v_pk_max_i16 v165, v165, 0
    v_cvt_pk_bf16_f32 v17, v68, v69
    v_lshlrev_b32 v16, 16, v17
    v_and_b32 v17, 0xffff0000, v17
    v_add_f32 v16, v16, v36
    v_add_f32 v17, v17, v37
    v_cvt_pk_bf16_f32 v166, v16, v17
    v_pk_max_i16 v166, v166, 0
    v_cvt_pk_bf16_f32 v17, v70, v71
    v_lshlrev_b32 v16, 16, v17
    v_and_b32 v17, 0xffff0000, v17
    v_add_f32 v16, v16, v38
    v_add_f32 v17, v17, v39
    v_cvt_pk_bf16_f32 v167, v16, v17
    v_pk_max_i16 v167, v167, 0
    v_cvt_pk_bf16_f32 v17, v72, v73
    v_lshlrev_b32 v16, 16, v17
    v_and_b32 v17, 0xffff0000, v17
    v_add_f32 v16, v16, v40
    v_add_f32 v17, v17, v41
    v_cvt_pk_bf16_f32 v168, v16, v17
    v_pk_max_i16 v168, v168, 0
    v_cvt_pk_bf16_f32 v17, v74, v75
    v_lshlrev_b32 v16, 16, v17
    v_and_b32 v17, 0xffff0000, v17
    v_add_f32 v16, v16, v42
    v_add_f32 v17, v17, v43
    v_cvt_pk_bf16_f32 v169, v16, v17
    v_pk_max_i16 v169, v169, 0
    v_mfma_f32_32x32x16_bf16 v[48:63], v[84:87], v[112:115], v[48:63]
    s_waitcnt lgkmcnt(4)
    v_cvt_pk_bf16_f32 v17, v76, v77
    v_lshlrev_b32 v16, 16, v17
    v_and_b32 v17, 0xffff0000, v17
    v_add_f32 v16, v16, v44
    v_add_f32 v17, v17, v45
    v_cvt_pk_bf16_f32 v170, v16, v17
    v_pk_max_i16 v170, v170, 0
    v_cvt_pk_bf16_f32 v17, v78, v79
    v_lshlrev_b32 v16, 16, v17
    v_and_b32 v17, 0xffff0000, v17
    v_add_f32 v16, v16, v46
    v_add_f32 v17, v17, v47
    v_cvt_pk_bf16_f32 v171, v16, v17
    v_pk_max_i16 v171, v171, 0
    v_lshlrev_b32 v16, 16, v244
    v_lshlrev_b32 v17, 16, v228
    v_mul_f32 v16, v16, v17
    v_and_b32 v17, 0xffff0000, v244
    v_and_b32 v21, 0xffff0000, v228
    v_mul_f32 v17, v17, v21
    v_cvt_pk_bf16_f32 v116, v16, v17
    v_lshlrev_b32 v16, 16, v245
    v_lshlrev_b32 v17, 16, v229
    v_mul_f32 v16, v16, v17
    v_and_b32 v17, 0xffff0000, v245
    v_and_b32 v21, 0xffff0000, v229
    v_mul_f32 v17, v17, v21
    v_cvt_pk_bf16_f32 v117, v16, v17
    v_lshlrev_b32 v16, 16, v246
    v_lshlrev_b32 v17, 16, v230
    v_mul_f32 v16, v16, v17
    v_and_b32 v17, 0xffff0000, v246
    v_and_b32 v21, 0xffff0000, v230
    v_mul_f32 v17, v17, v21
    v_cvt_pk_bf16_f32 v118, v16, v17
    v_lshlrev_b32 v16, 16, v247
    v_lshlrev_b32 v17, 16, v231
    v_mul_f32 v16, v16, v17
    v_and_b32 v17, 0xffff0000, v247
    v_and_b32 v21, 0xffff0000, v231
    v_mul_f32 v17, v17, v21
    v_cvt_pk_bf16_f32 v119, v16, v17
    v_smfmac_f32_16x16x64_bf16 v[128:131], v[88:91], v[108:115], v1
    ds_read_b128 v[216:219], v5 offset:4160
    v_lshlrev_b32 v16, 16, v248
    v_lshlrev_b32 v17, 16, v232
    v_mul_f32 v16, v16, v17
    v_and_b32 v17, 0xffff0000, v248
    v_and_b32 v21, 0xffff0000, v232
    v_mul_f32 v17, v17, v21
    v_cvt_pk_bf16_f32 v120, v16, v17
    v_lshlrev_b32 v16, 16, v249
    v_lshlrev_b32 v17, 16, v233
    v_mul_f32 v16, v16, v17
    v_and_b32 v17, 0xffff0000, v249
    v_and_b32 v21, 0xffff0000, v233
    v_mul_f32 v17, v17, v21
    v_cvt_pk_bf16_f32 v121, v16, v17
    v_smfmac_f32_16x16x64_bf16 v[124:127], v[176:179], v[164:171], v1
    v_lshlrev_b32 v16, 16, v250
    v_lshlrev_b32 v17, 16, v234
    v_mul_f32 v16, v16, v17
    v_and_b32 v17, 0xffff0000, v250
    v_and_b32 v21, 0xffff0000, v234
    v_mul_f32 v17, v17, v21
    v_cvt_pk_bf16_f32 v122, v16, v17
    v_lshlrev_b32 v16, 16, v251
    v_lshlrev_b32 v17, 16, v235
    v_mul_f32 v16, v16, v17
    v_and_b32 v17, 0xffff0000, v251
    v_and_b32 v21, 0xffff0000, v235
    v_mul_f32 v17, v17, v21
    v_cvt_pk_bf16_f32 v123, v16, v17
    v_mfma_f32_32x32x16_bf16 v[64:79], v[80:83], v[116:119], 0
    v_cvt_pk_bf16_f32 v17, v48, v49
    v_lshlrev_b32 v16, 16, v17
    v_and_b32 v17, 0xffff0000, v17
    v_add_f32 v16, v16, v32
    v_add_f32 v17, v17, v33
    v_cvt_pk_bf16_f32 v164, v16, v17
    v_pk_max_i16 v164, v164, 0
    v_cvt_pk_bf16_f32 v17, v50, v51
    v_lshlrev_b32 v16, 16, v17
    v_and_b32 v17, 0xffff0000, v17
    v_add_f32 v16, v16, v34
    v_add_f32 v17, v17, v35
    v_cvt_pk_bf16_f32 v165, v16, v17
    v_pk_max_i16 v165, v165, 0
    v_cvt_pk_bf16_f32 v17, v52, v53
    v_lshlrev_b32 v16, 16, v17
    v_and_b32 v17, 0xffff0000, v17
    v_add_f32 v16, v16, v36
    v_add_f32 v17, v17, v37
    v_cvt_pk_bf16_f32 v166, v16, v17
    v_pk_max_i16 v166, v166, 0
    v_cvt_pk_bf16_f32 v17, v54, v55
    v_lshlrev_b32 v16, 16, v17
    v_and_b32 v17, 0xffff0000, v17
    v_add_f32 v16, v16, v38
    v_add_f32 v17, v17, v39
    v_cvt_pk_bf16_f32 v167, v16, v17
    v_pk_max_i16 v167, v167, 0
    v_cvt_pk_bf16_f32 v17, v56, v57
    v_lshlrev_b32 v16, 16, v17
    v_and_b32 v17, 0xffff0000, v17
    v_add_f32 v16, v16, v40
    v_add_f32 v17, v17, v41
    v_cvt_pk_bf16_f32 v168, v16, v17
    v_pk_max_i16 v168, v168, 0
    v_cvt_pk_bf16_f32 v17, v58, v59
    v_lshlrev_b32 v16, 16, v17
    v_and_b32 v17, 0xffff0000, v17
    v_add_f32 v16, v16, v42
    v_add_f32 v17, v17, v43
    v_cvt_pk_bf16_f32 v169, v16, v17
    v_pk_max_i16 v169, v169, 0
    v_mfma_f32_32x32x16_bf16 v[64:79], v[84:87], v[120:123], v[64:79]
    v_add_f32 v145, v124, v125
    v_add_f32 v102, v126, v127
    v_cvt_pk_bf16_f32 v145, 0, v145
    v_cvt_pk_bf16_f32 v17, v60, v61
    v_lshlrev_b32 v16, 16, v17
    v_and_b32 v17, 0xffff0000, v17
    v_add_f32 v16, v16, v44
    v_add_f32 v17, v17, v45
    v_cvt_pk_bf16_f32 v170, v16, v17
    v_pk_max_i16 v170, v170, 0
    v_cvt_pk_bf16_f32 v17, v62, v63
    v_lshlrev_b32 v16, 16, v17
    v_and_b32 v17, 0xffff0000, v17
    v_add_f32 v16, v16, v46
    v_add_f32 v17, v17, v47
    v_cvt_pk_bf16_f32 v171, v16, v17
    v_pk_max_i16 v171, v171, 0
    v_lshlrev_b32 v16, 16, v180
    v_lshlrev_b32 v17, 16, v228
    v_mul_f32 v16, v16, v17
    v_and_b32 v17, 0xffff0000, v180
    v_and_b32 v21, 0xffff0000, v228
    v_mul_f32 v17, v17, v21
    v_cvt_pk_bf16_f32 v108, v16, v17
    v_lshlrev_b32 v16, 16, v181
    v_lshlrev_b32 v17, 16, v229
    v_mul_f32 v16, v16, v17
    v_and_b32 v17, 0xffff0000, v181
    v_and_b32 v21, 0xffff0000, v229
    v_mul_f32 v17, v17, v21
    v_cvt_pk_bf16_f32 v109, v16, v17
    v_lshlrev_b32 v16, 16, v182
    v_lshlrev_b32 v17, 16, v230
    v_mul_f32 v16, v16, v17
    v_and_b32 v17, 0xffff0000, v182
    v_and_b32 v21, 0xffff0000, v230
    v_mul_f32 v17, v17, v21
    v_cvt_pk_bf16_f32 v110, v16, v17
    v_lshlrev_b32 v16, 16, v183
    v_lshlrev_b32 v17, 16, v231
    v_mul_f32 v16, v16, v17
    v_and_b32 v17, 0xffff0000, v183
    v_and_b32 v21, 0xffff0000, v231
    v_mul_f32 v17, v17, v21
    v_cvt_pk_bf16_f32 v111, v16, v17
    v_smfmac_f32_16x16x64_bf16 v[128:131], v[92:95], v[116:123], v1
    ds_read_b128 v[124:127], v11 offset:2048
    v_lshlrev_b32 v16, 16, v184
    v_lshlrev_b32 v17, 16, v232
    v_mul_f32 v16, v16, v17
    v_and_b32 v17, 0xffff0000, v184
    v_and_b32 v21, 0xffff0000, v232
    v_mul_f32 v17, v17, v21
    v_cvt_pk_bf16_f32 v112, v16, v17
    v_lshlrev_b32 v16, 16, v185
    v_lshlrev_b32 v17, 16, v233
    v_mul_f32 v16, v16, v17
    v_and_b32 v17, 0xffff0000, v185
    v_and_b32 v21, 0xffff0000, v233
    v_mul_f32 v17, v17, v21
    v_cvt_pk_bf16_f32 v113, v16, v17
    v_smfmac_f32_16x16x64_bf16 v[128:131], v[172:175], v[164:171], v1
    v_lshlrev_b32 v16, 16, v186
    v_lshlrev_b32 v17, 16, v234
    v_mul_f32 v16, v16, v17
    v_and_b32 v17, 0xffff0000, v186
    v_and_b32 v21, 0xffff0000, v234
    v_mul_f32 v17, v17, v21
    v_cvt_pk_bf16_f32 v114, v16, v17
    v_lshlrev_b32 v16, 16, v187
    v_lshlrev_b32 v17, 16, v235
    v_mul_f32 v16, v16, v17
    v_and_b32 v17, 0xffff0000, v187
    v_and_b32 v21, 0xffff0000, v235
    v_mul_f32 v17, v17, v21
    v_cvt_pk_bf16_f32 v115, v16, v17
    v_mfma_f32_32x32x16_bf16 v[48:63], v[80:83], v[108:111], 0
    v_cvt_pk_bf16_f32 v17, v64, v65
    v_lshlrev_b32 v16, 16, v17
    v_and_b32 v17, 0xffff0000, v17
    v_add_f32 v16, v16, v32
    v_add_f32 v17, v17, v33
    v_cvt_pk_bf16_f32 v164, v16, v17
    v_pk_max_i16 v164, v164, 0
    v_cvt_pk_bf16_f32 v17, v66, v67
    v_lshlrev_b32 v16, 16, v17
    v_and_b32 v17, 0xffff0000, v17
    v_add_f32 v16, v16, v34
    v_add_f32 v17, v17, v35
    v_cvt_pk_bf16_f32 v165, v16, v17
    v_pk_max_i16 v165, v165, 0
    v_cvt_pk_bf16_f32 v17, v68, v69
    v_lshlrev_b32 v16, 16, v17
    v_and_b32 v17, 0xffff0000, v17
    v_add_f32 v16, v16, v36
    v_add_f32 v17, v17, v37
    v_cvt_pk_bf16_f32 v166, v16, v17
    v_pk_max_i16 v166, v166, 0
    v_cvt_pk_bf16_f32 v17, v70, v71
    v_lshlrev_b32 v16, 16, v17
    v_and_b32 v17, 0xffff0000, v17
    v_add_f32 v16, v16, v38
    v_add_f32 v17, v17, v39
    v_cvt_pk_bf16_f32 v167, v16, v17
    v_pk_max_i16 v167, v167, 0
    v_cvt_pk_bf16_f32 v17, v72, v73
    v_lshlrev_b32 v16, 16, v17
    v_and_b32 v17, 0xffff0000, v17
    v_add_f32 v16, v16, v40
    v_add_f32 v17, v17, v41
    v_cvt_pk_bf16_f32 v168, v16, v17
    v_pk_max_i16 v168, v168, 0
    v_cvt_pk_bf16_f32 v17, v74, v75
    v_lshlrev_b32 v16, 16, v17
    v_and_b32 v17, 0xffff0000, v17
    v_add_f32 v16, v16, v42
    v_add_f32 v17, v17, v43
    v_cvt_pk_bf16_f32 v169, v16, v17
    v_pk_max_i16 v169, v169, 0
    v_mfma_f32_32x32x16_bf16 v[48:63], v[84:87], v[112:115], v[48:63]
    s_waitcnt lgkmcnt(3)
    v_cvt_pk_bf16_f32 v17, v76, v77
    v_lshlrev_b32 v16, 16, v17
    v_and_b32 v17, 0xffff0000, v17
    v_add_f32 v16, v16, v44
    v_add_f32 v17, v17, v45
    v_cvt_pk_bf16_f32 v170, v16, v17
    v_pk_max_i16 v170, v170, 0
    v_cvt_pk_bf16_f32 v17, v78, v79
    v_lshlrev_b32 v16, 16, v17
    v_and_b32 v17, 0xffff0000, v17
    v_add_f32 v16, v16, v46
    v_add_f32 v17, v17, v47
    v_cvt_pk_bf16_f32 v171, v16, v17
    v_pk_max_i16 v171, v171, 0
    v_lshlrev_b32 v16, 16, v236
    v_lshlrev_b32 v17, 16, v228
    v_mul_f32 v16, v16, v17
    v_and_b32 v17, 0xffff0000, v236
    v_and_b32 v21, 0xffff0000, v228
    v_mul_f32 v17, v17, v21
    v_cvt_pk_bf16_f32 v116, v16, v17
    v_lshlrev_b32 v16, 16, v237
    v_lshlrev_b32 v17, 16, v229
    v_mul_f32 v16, v16, v17
    v_and_b32 v17, 0xffff0000, v237
    v_and_b32 v21, 0xffff0000, v229
    v_mul_f32 v17, v17, v21
    v_cvt_pk_bf16_f32 v117, v16, v17
    v_lshlrev_b32 v16, 16, v238
    v_lshlrev_b32 v17, 16, v230
    v_mul_f32 v16, v16, v17
    v_and_b32 v17, 0xffff0000, v238
    v_and_b32 v21, 0xffff0000, v230
    v_mul_f32 v17, v17, v21
    v_cvt_pk_bf16_f32 v118, v16, v17
    v_lshlrev_b32 v16, 16, v239
    v_lshlrev_b32 v17, 16, v231
    v_mul_f32 v16, v16, v17
    v_and_b32 v17, 0xffff0000, v239
    v_and_b32 v21, 0xffff0000, v231
    v_mul_f32 v17, v17, v21
    v_cvt_pk_bf16_f32 v119, v16, v17
    v_smfmac_f32_16x16x64_bf16 v[132:135], v[88:91], v[108:115], v1
    v_lshlrev_b32 v16, 16, v240
    v_lshlrev_b32 v17, 16, v232
    v_mul_f32 v16, v16, v17
    v_and_b32 v17, 0xffff0000, v240
    v_and_b32 v21, 0xffff0000, v232
    v_mul_f32 v17, v17, v21
    v_cvt_pk_bf16_f32 v120, v16, v17
    v_lshlrev_b32 v16, 16, v241
    v_lshlrev_b32 v17, 16, v233
    v_mul_f32 v16, v16, v17
    v_and_b32 v17, 0xffff0000, v241
    v_and_b32 v21, 0xffff0000, v233
    v_mul_f32 v17, v17, v21
    v_cvt_pk_bf16_f32 v121, v16, v17
    v_smfmac_f32_16x16x64_bf16 v[128:131], v[176:179], v[164:171], v1
    v_lshlrev_b32 v16, 16, v242
    v_lshlrev_b32 v17, 16, v234
    v_mul_f32 v16, v16, v17
    v_and_b32 v17, 0xffff0000, v242
    v_and_b32 v21, 0xffff0000, v234
    v_mul_f32 v17, v17, v21
    v_cvt_pk_bf16_f32 v122, v16, v17
    v_lshlrev_b32 v16, 16, v243
    v_lshlrev_b32 v17, 16, v235
    v_mul_f32 v16, v16, v17
    v_and_b32 v17, 0xffff0000, v243
    v_and_b32 v21, 0xffff0000, v235
    v_mul_f32 v17, v17, v21
    v_cvt_pk_bf16_f32 v123, v16, v17
    v_mfma_f32_32x32x16_bf16 v[64:79], v[80:83], v[116:119], 0
    v_cvt_pk_bf16_f32 v17, v48, v49
    v_lshlrev_b32 v16, 16, v17
    v_and_b32 v17, 0xffff0000, v17
    v_add_f32 v16, v16, v32
    v_add_f32 v17, v17, v33
    v_cvt_pk_bf16_f32 v164, v16, v17
    v_pk_max_i16 v164, v164, 0
    v_cvt_pk_bf16_f32 v17, v50, v51
    v_lshlrev_b32 v16, 16, v17
    v_and_b32 v17, 0xffff0000, v17
    v_add_f32 v16, v16, v34
    v_add_f32 v17, v17, v35
    v_cvt_pk_bf16_f32 v165, v16, v17
    v_pk_max_i16 v165, v165, 0
    v_cvt_pk_bf16_f32 v17, v52, v53
    v_lshlrev_b32 v16, 16, v17
    v_and_b32 v17, 0xffff0000, v17
    v_add_f32 v16, v16, v36
    v_add_f32 v17, v17, v37
    v_cvt_pk_bf16_f32 v166, v16, v17
    v_pk_max_i16 v166, v166, 0
    v_cvt_pk_bf16_f32 v17, v54, v55
    v_lshlrev_b32 v16, 16, v17
    v_and_b32 v17, 0xffff0000, v17
    v_add_f32 v16, v16, v38
    v_add_f32 v17, v17, v39
    v_cvt_pk_bf16_f32 v167, v16, v17
    v_pk_max_i16 v167, v167, 0
    v_cvt_pk_bf16_f32 v17, v56, v57
    v_lshlrev_b32 v16, 16, v17
    v_and_b32 v17, 0xffff0000, v17
    v_add_f32 v16, v16, v40
    v_add_f32 v17, v17, v41
    v_cvt_pk_bf16_f32 v168, v16, v17
    v_pk_max_i16 v168, v168, 0
    v_cvt_pk_bf16_f32 v17, v58, v59
    v_lshlrev_b32 v16, 16, v17
    v_and_b32 v17, 0xffff0000, v17
    v_add_f32 v16, v16, v42
    v_add_f32 v17, v17, v43
    v_cvt_pk_bf16_f32 v169, v16, v17
    v_pk_max_i16 v169, v169, 0
    v_mfma_f32_32x32x16_bf16 v[64:79], v[84:87], v[120:123], v[64:79]
    v_add_f32 v146, v128, v129
    v_add_f32 v103, v130, v131
    v_cvt_pk_bf16_f32 v146, 0, v146
    v_cvt_pk_bf16_f32 v17, v60, v61
    v_lshlrev_b32 v16, 16, v17
    v_and_b32 v17, 0xffff0000, v17
    v_add_f32 v16, v16, v44
    v_add_f32 v17, v17, v45
    v_cvt_pk_bf16_f32 v170, v16, v17
    v_pk_max_i16 v170, v170, 0
    v_cvt_pk_bf16_f32 v17, v62, v63
    v_lshlrev_b32 v16, 16, v17
    v_and_b32 v17, 0xffff0000, v17
    v_add_f32 v16, v16, v46
    v_add_f32 v17, v17, v47
    v_cvt_pk_bf16_f32 v171, v16, v17
    v_pk_max_i16 v171, v171, 0
    v_lshlrev_b32 v16, 16, v196
    v_lshlrev_b32 v17, 16, v228
    v_mul_f32 v16, v16, v17
    v_and_b32 v17, 0xffff0000, v196
    v_and_b32 v21, 0xffff0000, v228
    v_mul_f32 v17, v17, v21
    v_cvt_pk_bf16_f32 v108, v16, v17
    v_lshlrev_b32 v16, 16, v197
    v_lshlrev_b32 v17, 16, v229
    v_mul_f32 v16, v16, v17
    v_and_b32 v17, 0xffff0000, v197
    v_and_b32 v21, 0xffff0000, v229
    v_mul_f32 v17, v17, v21
    v_cvt_pk_bf16_f32 v109, v16, v17
    v_lshlrev_b32 v16, 16, v198
    v_lshlrev_b32 v17, 16, v230
    v_mul_f32 v16, v16, v17
    v_and_b32 v17, 0xffff0000, v198
    v_and_b32 v21, 0xffff0000, v230
    v_mul_f32 v17, v17, v21
    v_cvt_pk_bf16_f32 v110, v16, v17
    v_lshlrev_b32 v16, 16, v199
    v_lshlrev_b32 v17, 16, v231
    v_mul_f32 v16, v16, v17
    v_and_b32 v17, 0xffff0000, v199
    v_and_b32 v21, 0xffff0000, v231
    v_mul_f32 v17, v17, v21
    v_cvt_pk_bf16_f32 v111, v16, v17
    v_smfmac_f32_16x16x64_bf16 v[132:135], v[92:95], v[116:123], v1
    ds_read_b128 v[128:131], v11 offset:2048
    v_lshlrev_b32 v16, 16, v200
    v_lshlrev_b32 v17, 16, v232
    v_mul_f32 v16, v16, v17
    v_and_b32 v17, 0xffff0000, v200
    v_and_b32 v21, 0xffff0000, v232
    v_mul_f32 v17, v17, v21
    v_cvt_pk_bf16_f32 v112, v16, v17
    v_lshlrev_b32 v16, 16, v201
    v_lshlrev_b32 v17, 16, v233
    v_mul_f32 v16, v16, v17
    v_and_b32 v17, 0xffff0000, v201
    v_and_b32 v21, 0xffff0000, v233
    v_mul_f32 v17, v17, v21
    v_cvt_pk_bf16_f32 v113, v16, v17
    v_smfmac_f32_16x16x64_bf16 v[132:135], v[172:175], v[164:171], v1
    v_lshlrev_b32 v16, 16, v202
    v_lshlrev_b32 v17, 16, v234
    v_mul_f32 v16, v16, v17
    v_and_b32 v17, 0xffff0000, v202
    v_and_b32 v21, 0xffff0000, v234
    v_mul_f32 v17, v17, v21
    v_cvt_pk_bf16_f32 v114, v16, v17
    v_lshlrev_b32 v16, 16, v203
    v_lshlrev_b32 v17, 16, v235
    v_mul_f32 v16, v16, v17
    v_and_b32 v17, 0xffff0000, v203
    v_and_b32 v21, 0xffff0000, v235
    v_mul_f32 v17, v17, v21
    v_cvt_pk_bf16_f32 v115, v16, v17
    v_mfma_f32_32x32x16_bf16 v[48:63], v[80:83], v[108:111], 0
    v_cvt_pk_bf16_f32 v17, v64, v65
    v_lshlrev_b32 v16, 16, v17
    v_and_b32 v17, 0xffff0000, v17
    v_add_f32 v16, v16, v32
    v_add_f32 v17, v17, v33
    v_cvt_pk_bf16_f32 v164, v16, v17
    v_pk_max_i16 v164, v164, 0
    v_cvt_pk_bf16_f32 v17, v66, v67
    v_lshlrev_b32 v16, 16, v17
    v_and_b32 v17, 0xffff0000, v17
    v_add_f32 v16, v16, v34
    v_add_f32 v17, v17, v35
    v_cvt_pk_bf16_f32 v165, v16, v17
    v_pk_max_i16 v165, v165, 0
    v_cvt_pk_bf16_f32 v17, v68, v69
    v_lshlrev_b32 v16, 16, v17
    v_and_b32 v17, 0xffff0000, v17
    v_add_f32 v16, v16, v36
    v_add_f32 v17, v17, v37
    v_cvt_pk_bf16_f32 v166, v16, v17
    v_pk_max_i16 v166, v166, 0
    v_cvt_pk_bf16_f32 v17, v70, v71
    v_lshlrev_b32 v16, 16, v17
    v_and_b32 v17, 0xffff0000, v17
    v_add_f32 v16, v16, v38
    v_add_f32 v17, v17, v39
    v_cvt_pk_bf16_f32 v167, v16, v17
    v_pk_max_i16 v167, v167, 0
    v_cvt_pk_bf16_f32 v17, v72, v73
    v_lshlrev_b32 v16, 16, v17
    v_and_b32 v17, 0xffff0000, v17
    v_add_f32 v16, v16, v40
    v_add_f32 v17, v17, v41
    v_cvt_pk_bf16_f32 v168, v16, v17
    v_pk_max_i16 v168, v168, 0
    v_cvt_pk_bf16_f32 v17, v74, v75
    v_lshlrev_b32 v16, 16, v17
    v_and_b32 v17, 0xffff0000, v17
    v_add_f32 v16, v16, v42
    v_add_f32 v17, v17, v43
    v_cvt_pk_bf16_f32 v169, v16, v17
    v_pk_max_i16 v169, v169, 0
    v_mfma_f32_32x32x16_bf16 v[48:63], v[84:87], v[112:115], v[48:63]
    s_waitcnt lgkmcnt(1)
    v_cvt_pk_bf16_f32 v17, v76, v77
    v_lshlrev_b32 v16, 16, v17
    v_and_b32 v17, 0xffff0000, v17
    v_add_f32 v16, v16, v44
    v_add_f32 v17, v17, v45
    v_cvt_pk_bf16_f32 v170, v16, v17
    v_pk_max_i16 v170, v170, 0
    v_cvt_pk_bf16_f32 v17, v78, v79
    v_lshlrev_b32 v16, 16, v17
    v_and_b32 v17, 0xffff0000, v17
    v_add_f32 v16, v16, v46
    v_add_f32 v17, v17, v47
    v_cvt_pk_bf16_f32 v171, v16, v17
    v_pk_max_i16 v171, v171, 0
    v_lshlrev_b32 v16, 16, v220
    v_lshlrev_b32 v17, 16, v228
    v_mul_f32 v16, v16, v17
    v_and_b32 v17, 0xffff0000, v220
    v_and_b32 v21, 0xffff0000, v228
    v_mul_f32 v17, v17, v21
    v_cvt_pk_bf16_f32 v116, v16, v17
    v_lshlrev_b32 v16, 16, v221
    v_lshlrev_b32 v17, 16, v229
    v_mul_f32 v16, v16, v17
    v_and_b32 v17, 0xffff0000, v221
    v_and_b32 v21, 0xffff0000, v229
    v_mul_f32 v17, v17, v21
    v_cvt_pk_bf16_f32 v117, v16, v17
    v_lshlrev_b32 v16, 16, v222
    v_lshlrev_b32 v17, 16, v230
    v_mul_f32 v16, v16, v17
    v_and_b32 v17, 0xffff0000, v222
    v_and_b32 v21, 0xffff0000, v230
    v_mul_f32 v17, v17, v21
    v_cvt_pk_bf16_f32 v118, v16, v17
    v_lshlrev_b32 v16, 16, v223
    v_lshlrev_b32 v17, 16, v231
    v_mul_f32 v16, v16, v17
    v_and_b32 v17, 0xffff0000, v223
    v_and_b32 v21, 0xffff0000, v231
    v_mul_f32 v17, v17, v21
    v_cvt_pk_bf16_f32 v119, v16, v17
    v_smfmac_f32_16x16x64_bf16 v[124:127], v[88:91], v[108:115], v1
    v_lshlrev_b32 v16, 16, v224
    v_lshlrev_b32 v17, 16, v232
    v_mul_f32 v16, v16, v17
    v_and_b32 v17, 0xffff0000, v224
    v_and_b32 v21, 0xffff0000, v232
    v_mul_f32 v17, v17, v21
    v_cvt_pk_bf16_f32 v120, v16, v17
    v_lshlrev_b32 v16, 16, v225
    v_lshlrev_b32 v17, 16, v233
    v_mul_f32 v16, v16, v17
    v_and_b32 v17, 0xffff0000, v225
    v_and_b32 v21, 0xffff0000, v233
    v_mul_f32 v17, v17, v21
    v_cvt_pk_bf16_f32 v121, v16, v17
    v_smfmac_f32_16x16x64_bf16 v[132:135], v[176:179], v[164:171], v1
    v_lshlrev_b32 v16, 16, v226
    v_lshlrev_b32 v17, 16, v234
    v_mul_f32 v16, v16, v17
    v_and_b32 v17, 0xffff0000, v226
    v_and_b32 v21, 0xffff0000, v234
    v_mul_f32 v17, v17, v21
    v_cvt_pk_bf16_f32 v122, v16, v17
    v_lshlrev_b32 v16, 16, v227
    v_lshlrev_b32 v17, 16, v235
    v_mul_f32 v16, v16, v17
    v_and_b32 v17, 0xffff0000, v227
    v_and_b32 v21, 0xffff0000, v235
    v_mul_f32 v17, v17, v21
    v_cvt_pk_bf16_f32 v123, v16, v17
    v_mfma_f32_32x32x16_bf16 v[64:79], v[80:83], v[116:119], 0
    v_cvt_pk_bf16_f32 v17, v48, v49
    v_lshlrev_b32 v16, 16, v17
    v_and_b32 v17, 0xffff0000, v17
    v_add_f32 v16, v16, v32
    v_add_f32 v17, v17, v33
    v_cvt_pk_bf16_f32 v164, v16, v17
    v_pk_max_i16 v164, v164, 0
    v_cvt_pk_bf16_f32 v17, v50, v51
    v_lshlrev_b32 v16, 16, v17
    v_and_b32 v17, 0xffff0000, v17
    v_add_f32 v16, v16, v34
    v_add_f32 v17, v17, v35
    v_cvt_pk_bf16_f32 v165, v16, v17
    v_pk_max_i16 v165, v165, 0
    v_cvt_pk_bf16_f32 v17, v52, v53
    v_lshlrev_b32 v16, 16, v17
    v_and_b32 v17, 0xffff0000, v17
    v_add_f32 v16, v16, v36
    v_add_f32 v17, v17, v37
    v_cvt_pk_bf16_f32 v166, v16, v17
    v_pk_max_i16 v166, v166, 0
    v_cvt_pk_bf16_f32 v17, v54, v55
    v_lshlrev_b32 v16, 16, v17
    v_and_b32 v17, 0xffff0000, v17
    v_add_f32 v16, v16, v38
    v_add_f32 v17, v17, v39
    v_cvt_pk_bf16_f32 v167, v16, v17
    v_pk_max_i16 v167, v167, 0
    v_cvt_pk_bf16_f32 v17, v56, v57
    v_lshlrev_b32 v16, 16, v17
    v_and_b32 v17, 0xffff0000, v17
    v_add_f32 v16, v16, v40
    v_add_f32 v17, v17, v41
    v_cvt_pk_bf16_f32 v168, v16, v17
    v_pk_max_i16 v168, v168, 0
    v_cvt_pk_bf16_f32 v17, v58, v59
    v_lshlrev_b32 v16, 16, v17
    v_and_b32 v17, 0xffff0000, v17
    v_add_f32 v16, v16, v42
    v_add_f32 v17, v17, v43
    v_cvt_pk_bf16_f32 v169, v16, v17
    v_pk_max_i16 v169, v169, 0
    v_mfma_f32_32x32x16_bf16 v[64:79], v[84:87], v[120:123], v[64:79]
    v_add_f32 v147, v132, v133
    v_add_f32 v104, v134, v135
    v_cvt_pk_bf16_f32 v147, 0, v147
    v_cvt_pk_bf16_f32 v17, v60, v61
    v_lshlrev_b32 v16, 16, v17
    v_and_b32 v17, 0xffff0000, v17
    v_add_f32 v16, v16, v44
    v_add_f32 v17, v17, v45
    v_cvt_pk_bf16_f32 v170, v16, v17
    v_pk_max_i16 v170, v170, 0
    v_cvt_pk_bf16_f32 v17, v62, v63
    v_lshlrev_b32 v16, 16, v17
    v_and_b32 v17, 0xffff0000, v17
    v_add_f32 v16, v16, v46
    v_add_f32 v17, v17, v47
    v_cvt_pk_bf16_f32 v171, v16, v17
    v_pk_max_i16 v171, v171, 0
    v_lshlrev_b32 v16, 16, v188
    v_lshlrev_b32 v17, 16, v204
    v_mul_f32 v16, v16, v17
    v_and_b32 v17, 0xffff0000, v188
    v_and_b32 v21, 0xffff0000, v204
    v_mul_f32 v17, v17, v21
    v_cvt_pk_bf16_f32 v108, v16, v17
    v_lshlrev_b32 v16, 16, v189
    v_lshlrev_b32 v17, 16, v205
    v_mul_f32 v16, v16, v17
    v_and_b32 v17, 0xffff0000, v189
    v_and_b32 v21, 0xffff0000, v205
    v_mul_f32 v17, v17, v21
    v_cvt_pk_bf16_f32 v109, v16, v17
    v_lshlrev_b32 v16, 16, v190
    v_lshlrev_b32 v17, 16, v206
    v_mul_f32 v16, v16, v17
    v_and_b32 v17, 0xffff0000, v190
    v_and_b32 v21, 0xffff0000, v206
    v_mul_f32 v17, v17, v21
    v_cvt_pk_bf16_f32 v110, v16, v17
    v_lshlrev_b32 v16, 16, v191
    v_lshlrev_b32 v17, 16, v207
    v_mul_f32 v16, v16, v17
    v_and_b32 v17, 0xffff0000, v191
    v_and_b32 v21, 0xffff0000, v207
    v_mul_f32 v17, v17, v21
    v_cvt_pk_bf16_f32 v111, v16, v17
    v_smfmac_f32_16x16x64_bf16 v[124:127], v[92:95], v[116:123], v1
    ds_read_b128 v[132:135], v11 offset:2048
    v_lshlrev_b32 v16, 16, v192
    v_lshlrev_b32 v17, 16, v208
    v_mul_f32 v16, v16, v17
    v_and_b32 v17, 0xffff0000, v192
    v_and_b32 v21, 0xffff0000, v208
    v_mul_f32 v17, v17, v21
    v_cvt_pk_bf16_f32 v112, v16, v17
    v_lshlrev_b32 v16, 16, v193
    v_lshlrev_b32 v17, 16, v209
    v_mul_f32 v16, v16, v17
    v_and_b32 v17, 0xffff0000, v193
    v_and_b32 v21, 0xffff0000, v209
    v_mul_f32 v17, v17, v21
    v_cvt_pk_bf16_f32 v113, v16, v17
    v_smfmac_f32_16x16x64_bf16 v[124:127], v[172:175], v[164:171], v1
    v_lshlrev_b32 v16, 16, v194
    v_lshlrev_b32 v17, 16, v210
    v_mul_f32 v16, v16, v17
    v_and_b32 v17, 0xffff0000, v194
    v_and_b32 v21, 0xffff0000, v210
    v_mul_f32 v17, v17, v21
    v_cvt_pk_bf16_f32 v114, v16, v17
    v_lshlrev_b32 v16, 16, v195
    v_lshlrev_b32 v17, 16, v211
    v_mul_f32 v16, v16, v17
    v_and_b32 v17, 0xffff0000, v195
    v_and_b32 v21, 0xffff0000, v211
    v_mul_f32 v17, v17, v21
    v_cvt_pk_bf16_f32 v115, v16, v17
    v_mfma_f32_32x32x16_bf16 v[48:63], v[80:83], v[108:111], 0
    v_cvt_pk_bf16_f32 v17, v64, v65
    v_lshlrev_b32 v16, 16, v17
    v_and_b32 v17, 0xffff0000, v17
    v_add_f32 v16, v16, v32
    v_add_f32 v17, v17, v33
    v_cvt_pk_bf16_f32 v164, v16, v17
    v_pk_max_i16 v164, v164, 0
    v_cvt_pk_bf16_f32 v17, v66, v67
    v_lshlrev_b32 v16, 16, v17
    v_and_b32 v17, 0xffff0000, v17
    v_add_f32 v16, v16, v34
    v_add_f32 v17, v17, v35
    v_cvt_pk_bf16_f32 v165, v16, v17
    v_pk_max_i16 v165, v165, 0
    v_cvt_pk_bf16_f32 v17, v68, v69
    v_lshlrev_b32 v16, 16, v17
    v_and_b32 v17, 0xffff0000, v17
    v_add_f32 v16, v16, v36
    v_add_f32 v17, v17, v37
    v_cvt_pk_bf16_f32 v166, v16, v17
    v_pk_max_i16 v166, v166, 0
    v_cvt_pk_bf16_f32 v17, v70, v71
    v_lshlrev_b32 v16, 16, v17
    v_and_b32 v17, 0xffff0000, v17
    v_add_f32 v16, v16, v38
    v_add_f32 v17, v17, v39
    v_cvt_pk_bf16_f32 v167, v16, v17
    v_pk_max_i16 v167, v167, 0
    v_cvt_pk_bf16_f32 v17, v72, v73
    v_lshlrev_b32 v16, 16, v17
    v_and_b32 v17, 0xffff0000, v17
    v_add_f32 v16, v16, v40
    v_add_f32 v17, v17, v41
    v_cvt_pk_bf16_f32 v168, v16, v17
    v_pk_max_i16 v168, v168, 0
    v_cvt_pk_bf16_f32 v17, v74, v75
    v_lshlrev_b32 v16, 16, v17
    v_and_b32 v17, 0xffff0000, v17
    v_add_f32 v16, v16, v42
    v_add_f32 v17, v17, v43
    v_cvt_pk_bf16_f32 v169, v16, v17
    v_pk_max_i16 v169, v169, 0
    v_mfma_f32_32x32x16_bf16 v[48:63], v[84:87], v[112:115], v[48:63]
    s_waitcnt lgkmcnt(1)
    v_cvt_pk_bf16_f32 v17, v76, v77
    v_lshlrev_b32 v16, 16, v17
    v_and_b32 v17, 0xffff0000, v17
    v_add_f32 v16, v16, v44
    v_add_f32 v17, v17, v45
    v_cvt_pk_bf16_f32 v170, v16, v17
    v_pk_max_i16 v170, v170, 0
    v_cvt_pk_bf16_f32 v17, v78, v79
    v_lshlrev_b32 v16, 16, v17
    v_and_b32 v17, 0xffff0000, v17
    v_add_f32 v16, v16, v46
    v_add_f32 v17, v17, v47
    v_cvt_pk_bf16_f32 v171, v16, v17
    v_pk_max_i16 v171, v171, 0
    v_lshlrev_b32 v16, 16, v244
    v_lshlrev_b32 v17, 16, v204
    v_mul_f32 v16, v16, v17
    v_and_b32 v17, 0xffff0000, v244
    v_and_b32 v21, 0xffff0000, v204
    v_mul_f32 v17, v17, v21
    v_cvt_pk_bf16_f32 v116, v16, v17
    v_lshlrev_b32 v16, 16, v245
    v_lshlrev_b32 v17, 16, v205
    v_mul_f32 v16, v16, v17
    v_and_b32 v17, 0xffff0000, v245
    v_and_b32 v21, 0xffff0000, v205
    v_mul_f32 v17, v17, v21
    v_cvt_pk_bf16_f32 v117, v16, v17
    v_lshlrev_b32 v16, 16, v246
    v_lshlrev_b32 v17, 16, v206
    v_mul_f32 v16, v16, v17
    v_and_b32 v17, 0xffff0000, v246
    v_and_b32 v21, 0xffff0000, v206
    v_mul_f32 v17, v17, v21
    v_cvt_pk_bf16_f32 v118, v16, v17
    v_lshlrev_b32 v16, 16, v247
    v_lshlrev_b32 v17, 16, v207
    v_mul_f32 v16, v16, v17
    v_and_b32 v17, 0xffff0000, v247
    v_and_b32 v21, 0xffff0000, v207
    v_mul_f32 v17, v17, v21
    v_cvt_pk_bf16_f32 v119, v16, v17
    v_smfmac_f32_16x16x64_bf16 v[128:131], v[88:91], v[108:115], v1
    ds_read_b128 v[188:191], v3 offset:1024
    v_lshlrev_b32 v16, 16, v248
    v_lshlrev_b32 v17, 16, v208
    v_mul_f32 v16, v16, v17
    v_and_b32 v17, 0xffff0000, v248
    v_and_b32 v21, 0xffff0000, v208
    v_mul_f32 v17, v17, v21
    v_cvt_pk_bf16_f32 v120, v16, v17
    v_lshlrev_b32 v16, 16, v249
    v_lshlrev_b32 v17, 16, v209
    v_mul_f32 v16, v16, v17
    v_and_b32 v17, 0xffff0000, v249
    v_and_b32 v21, 0xffff0000, v209
    v_mul_f32 v17, v17, v21
    v_cvt_pk_bf16_f32 v121, v16, v17
    v_smfmac_f32_16x16x64_bf16 v[124:127], v[176:179], v[164:171], v1
    ds_read_b128 v[192:195], v3 offset:5184
    v_lshlrev_b32 v16, 16, v250
    v_lshlrev_b32 v17, 16, v210
    v_mul_f32 v16, v16, v17
    v_and_b32 v17, 0xffff0000, v250
    v_and_b32 v21, 0xffff0000, v210
    v_mul_f32 v17, v17, v21
    v_cvt_pk_bf16_f32 v122, v16, v17
    v_lshlrev_b32 v16, 16, v251
    v_lshlrev_b32 v17, 16, v211
    v_mul_f32 v16, v16, v17
    v_and_b32 v17, 0xffff0000, v251
    v_and_b32 v21, 0xffff0000, v211
    v_mul_f32 v17, v17, v21
    v_cvt_pk_bf16_f32 v123, v16, v17
    v_mfma_f32_32x32x16_bf16 v[64:79], v[80:83], v[116:119], 0
    v_cvt_pk_bf16_f32 v17, v48, v49
    v_lshlrev_b32 v16, 16, v17
    v_and_b32 v17, 0xffff0000, v17
    v_add_f32 v16, v16, v32
    v_add_f32 v17, v17, v33
    v_cvt_pk_bf16_f32 v164, v16, v17
    v_pk_max_i16 v164, v164, 0
    v_cvt_pk_bf16_f32 v17, v50, v51
    v_lshlrev_b32 v16, 16, v17
    v_and_b32 v17, 0xffff0000, v17
    v_add_f32 v16, v16, v34
    v_add_f32 v17, v17, v35
    v_cvt_pk_bf16_f32 v165, v16, v17
    v_pk_max_i16 v165, v165, 0
    v_cvt_pk_bf16_f32 v17, v52, v53
    v_lshlrev_b32 v16, 16, v17
    v_and_b32 v17, 0xffff0000, v17
    v_add_f32 v16, v16, v36
    v_add_f32 v17, v17, v37
    v_cvt_pk_bf16_f32 v166, v16, v17
    v_pk_max_i16 v166, v166, 0
    v_cvt_pk_bf16_f32 v17, v54, v55
    v_lshlrev_b32 v16, 16, v17
    v_and_b32 v17, 0xffff0000, v17
    v_add_f32 v16, v16, v38
    v_add_f32 v17, v17, v39
    v_cvt_pk_bf16_f32 v167, v16, v17
    v_pk_max_i16 v167, v167, 0
    v_cvt_pk_bf16_f32 v17, v56, v57
    v_lshlrev_b32 v16, 16, v17
    v_and_b32 v17, 0xffff0000, v17
    v_add_f32 v16, v16, v40
    v_add_f32 v17, v17, v41
    v_cvt_pk_bf16_f32 v168, v16, v17
    v_pk_max_i16 v168, v168, 0
    v_cvt_pk_bf16_f32 v17, v58, v59
    v_lshlrev_b32 v16, 16, v17
    v_and_b32 v17, 0xffff0000, v17
    v_add_f32 v16, v16, v42
    v_add_f32 v17, v17, v43
    v_cvt_pk_bf16_f32 v169, v16, v17
    v_pk_max_i16 v169, v169, 0
    v_mfma_f32_32x32x16_bf16 v[64:79], v[84:87], v[120:123], v[64:79]
    v_add_f32 v148, v124, v125
    v_add_f32 v105, v126, v127
    v_cvt_pk_bf16_f32 v148, 0, v148
    v_cvt_pk_bf16_f32 v17, v60, v61
    v_lshlrev_b32 v16, 16, v17
    v_and_b32 v17, 0xffff0000, v17
    v_add_f32 v16, v16, v44
    v_add_f32 v17, v17, v45
    v_cvt_pk_bf16_f32 v170, v16, v17
    v_pk_max_i16 v170, v170, 0
    v_cvt_pk_bf16_f32 v17, v62, v63
    v_lshlrev_b32 v16, 16, v17
    v_and_b32 v17, 0xffff0000, v17
    v_add_f32 v16, v16, v46
    v_add_f32 v17, v17, v47
    v_cvt_pk_bf16_f32 v171, v16, v17
    v_pk_max_i16 v171, v171, 0
    v_lshlrev_b32 v16, 16, v180
    v_lshlrev_b32 v17, 16, v204
    v_mul_f32 v16, v16, v17
    v_and_b32 v17, 0xffff0000, v180
    v_and_b32 v21, 0xffff0000, v204
    v_mul_f32 v17, v17, v21
    v_cvt_pk_bf16_f32 v108, v16, v17
    v_lshlrev_b32 v16, 16, v181
    v_lshlrev_b32 v17, 16, v205
    v_mul_f32 v16, v16, v17
    v_and_b32 v17, 0xffff0000, v181
    v_and_b32 v21, 0xffff0000, v205
    v_mul_f32 v17, v17, v21
    v_cvt_pk_bf16_f32 v109, v16, v17
    v_lshlrev_b32 v16, 16, v182
    v_lshlrev_b32 v17, 16, v206
    v_mul_f32 v16, v16, v17
    v_and_b32 v17, 0xffff0000, v182
    v_and_b32 v21, 0xffff0000, v206
    v_mul_f32 v17, v17, v21
    v_cvt_pk_bf16_f32 v110, v16, v17
    v_lshlrev_b32 v16, 16, v183
    v_lshlrev_b32 v17, 16, v207
    v_mul_f32 v16, v16, v17
    v_and_b32 v17, 0xffff0000, v183
    v_and_b32 v21, 0xffff0000, v207
    v_mul_f32 v17, v17, v21
    v_cvt_pk_bf16_f32 v111, v16, v17
    v_smfmac_f32_16x16x64_bf16 v[128:131], v[92:95], v[116:123], v1
    ds_read_b128 v[124:127], v11 offset:2048
    v_lshlrev_b32 v16, 16, v184
    v_lshlrev_b32 v17, 16, v208
    v_mul_f32 v16, v16, v17
    v_and_b32 v17, 0xffff0000, v184
    v_and_b32 v21, 0xffff0000, v208
    v_mul_f32 v17, v17, v21
    v_cvt_pk_bf16_f32 v112, v16, v17
    v_lshlrev_b32 v16, 16, v185
    v_lshlrev_b32 v17, 16, v209
    v_mul_f32 v16, v16, v17
    v_and_b32 v17, 0xffff0000, v185
    v_and_b32 v21, 0xffff0000, v209
    v_mul_f32 v17, v17, v21
    v_cvt_pk_bf16_f32 v113, v16, v17
    v_smfmac_f32_16x16x64_bf16 v[128:131], v[172:175], v[164:171], v1
    ds_read_b128 v[244:247], v6 offset:512
    v_lshlrev_b32 v16, 16, v186
    v_lshlrev_b32 v17, 16, v210
    v_mul_f32 v16, v16, v17
    v_and_b32 v17, 0xffff0000, v186
    v_and_b32 v21, 0xffff0000, v210
    v_mul_f32 v17, v17, v21
    v_cvt_pk_bf16_f32 v114, v16, v17
    v_lshlrev_b32 v16, 16, v187
    v_lshlrev_b32 v17, 16, v211
    v_mul_f32 v16, v16, v17
    v_and_b32 v17, 0xffff0000, v187
    v_and_b32 v21, 0xffff0000, v211
    v_mul_f32 v17, v17, v21
    v_cvt_pk_bf16_f32 v115, v16, v17
    v_mfma_f32_32x32x16_bf16 v[48:63], v[80:83], v[108:111], 0
    v_cvt_pk_bf16_f32 v17, v64, v65
    v_lshlrev_b32 v16, 16, v17
    v_and_b32 v17, 0xffff0000, v17
    v_add_f32 v16, v16, v32
    v_add_f32 v17, v17, v33
    v_cvt_pk_bf16_f32 v164, v16, v17
    v_pk_max_i16 v164, v164, 0
    v_cvt_pk_bf16_f32 v17, v66, v67
    v_lshlrev_b32 v16, 16, v17
    v_and_b32 v17, 0xffff0000, v17
    v_add_f32 v16, v16, v34
    v_add_f32 v17, v17, v35
    v_cvt_pk_bf16_f32 v165, v16, v17
    v_pk_max_i16 v165, v165, 0
    v_cvt_pk_bf16_f32 v17, v68, v69
    v_lshlrev_b32 v16, 16, v17
    v_and_b32 v17, 0xffff0000, v17
    v_add_f32 v16, v16, v36
    v_add_f32 v17, v17, v37
    v_cvt_pk_bf16_f32 v166, v16, v17
    v_pk_max_i16 v166, v166, 0
    v_cvt_pk_bf16_f32 v17, v70, v71
    v_lshlrev_b32 v16, 16, v17
    v_and_b32 v17, 0xffff0000, v17
    v_add_f32 v16, v16, v38
    v_add_f32 v17, v17, v39
    v_cvt_pk_bf16_f32 v167, v16, v17
    v_pk_max_i16 v167, v167, 0
    v_cvt_pk_bf16_f32 v17, v72, v73
    v_lshlrev_b32 v16, 16, v17
    v_and_b32 v17, 0xffff0000, v17
    v_add_f32 v16, v16, v40
    v_add_f32 v17, v17, v41
    v_cvt_pk_bf16_f32 v168, v16, v17
    v_pk_max_i16 v168, v168, 0
    v_cvt_pk_bf16_f32 v17, v74, v75
    v_lshlrev_b32 v16, 16, v17
    v_and_b32 v17, 0xffff0000, v17
    v_add_f32 v16, v16, v42
    v_add_f32 v17, v17, v43
    v_cvt_pk_bf16_f32 v169, v16, v17
    v_pk_max_i16 v169, v169, 0
    v_mfma_f32_32x32x16_bf16 v[48:63], v[84:87], v[112:115], v[48:63]
    s_waitcnt lgkmcnt(4)
    v_cvt_pk_bf16_f32 v17, v76, v77
    v_lshlrev_b32 v16, 16, v17
    v_and_b32 v17, 0xffff0000, v17
    v_add_f32 v16, v16, v44
    v_add_f32 v17, v17, v45
    v_cvt_pk_bf16_f32 v170, v16, v17
    v_pk_max_i16 v170, v170, 0
    v_cvt_pk_bf16_f32 v17, v78, v79
    v_lshlrev_b32 v16, 16, v17
    v_and_b32 v17, 0xffff0000, v17
    v_add_f32 v16, v16, v46
    v_add_f32 v17, v17, v47
    v_cvt_pk_bf16_f32 v171, v16, v17
    v_pk_max_i16 v171, v171, 0
    v_lshlrev_b32 v16, 16, v236
    v_lshlrev_b32 v17, 16, v204
    v_mul_f32 v16, v16, v17
    v_and_b32 v17, 0xffff0000, v236
    v_and_b32 v21, 0xffff0000, v204
    v_mul_f32 v17, v17, v21
    v_cvt_pk_bf16_f32 v116, v16, v17
    v_lshlrev_b32 v16, 16, v237
    v_lshlrev_b32 v17, 16, v205
    v_mul_f32 v16, v16, v17
    v_and_b32 v17, 0xffff0000, v237
    v_and_b32 v21, 0xffff0000, v205
    v_mul_f32 v17, v17, v21
    v_cvt_pk_bf16_f32 v117, v16, v17
    v_lshlrev_b32 v16, 16, v238
    v_lshlrev_b32 v17, 16, v206
    v_mul_f32 v16, v16, v17
    v_and_b32 v17, 0xffff0000, v238
    v_and_b32 v21, 0xffff0000, v206
    v_mul_f32 v17, v17, v21
    v_cvt_pk_bf16_f32 v118, v16, v17
    v_lshlrev_b32 v16, 16, v239
    v_lshlrev_b32 v17, 16, v207
    v_mul_f32 v16, v16, v17
    v_and_b32 v17, 0xffff0000, v239
    v_and_b32 v21, 0xffff0000, v207
    v_mul_f32 v17, v17, v21
    v_cvt_pk_bf16_f32 v119, v16, v17
    v_smfmac_f32_16x16x64_bf16 v[132:135], v[88:91], v[108:115], v1
    ds_read_b128 v[248:251], v6 offset:4672
    v_lshlrev_b32 v16, 16, v240
    v_lshlrev_b32 v17, 16, v208
    v_mul_f32 v16, v16, v17
    v_and_b32 v17, 0xffff0000, v240
    v_and_b32 v21, 0xffff0000, v208
    v_mul_f32 v17, v17, v21
    v_cvt_pk_bf16_f32 v120, v16, v17
    v_lshlrev_b32 v16, 16, v241
    v_lshlrev_b32 v17, 16, v209
    v_mul_f32 v16, v16, v17
    v_and_b32 v17, 0xffff0000, v241
    v_and_b32 v21, 0xffff0000, v209
    v_mul_f32 v17, v17, v21
    v_cvt_pk_bf16_f32 v121, v16, v17
    v_smfmac_f32_16x16x64_bf16 v[128:131], v[176:179], v[164:171], v1
    v_lshlrev_b32 v16, 16, v242
    v_lshlrev_b32 v17, 16, v210
    v_mul_f32 v16, v16, v17
    v_and_b32 v17, 0xffff0000, v242
    v_and_b32 v21, 0xffff0000, v210
    v_mul_f32 v17, v17, v21
    v_cvt_pk_bf16_f32 v122, v16, v17
    v_lshlrev_b32 v16, 16, v243
    v_lshlrev_b32 v17, 16, v211
    v_mul_f32 v16, v16, v17
    v_and_b32 v17, 0xffff0000, v243
    v_and_b32 v21, 0xffff0000, v211
    v_mul_f32 v17, v17, v21
    v_cvt_pk_bf16_f32 v123, v16, v17
    v_mfma_f32_32x32x16_bf16 v[64:79], v[80:83], v[116:119], 0
    v_cvt_pk_bf16_f32 v17, v48, v49
    v_lshlrev_b32 v16, 16, v17
    v_and_b32 v17, 0xffff0000, v17
    v_add_f32 v16, v16, v32
    v_add_f32 v17, v17, v33
    v_cvt_pk_bf16_f32 v164, v16, v17
    v_pk_max_i16 v164, v164, 0
    v_cvt_pk_bf16_f32 v17, v50, v51
    v_lshlrev_b32 v16, 16, v17
    v_and_b32 v17, 0xffff0000, v17
    v_add_f32 v16, v16, v34
    v_add_f32 v17, v17, v35
    v_cvt_pk_bf16_f32 v165, v16, v17
    v_pk_max_i16 v165, v165, 0
    v_cvt_pk_bf16_f32 v17, v52, v53
    v_lshlrev_b32 v16, 16, v17
    v_and_b32 v17, 0xffff0000, v17
    v_add_f32 v16, v16, v36
    v_add_f32 v17, v17, v37
    v_cvt_pk_bf16_f32 v166, v16, v17
    v_pk_max_i16 v166, v166, 0
    v_cvt_pk_bf16_f32 v17, v54, v55
    v_lshlrev_b32 v16, 16, v17
    v_and_b32 v17, 0xffff0000, v17
    v_add_f32 v16, v16, v38
    v_add_f32 v17, v17, v39
    v_cvt_pk_bf16_f32 v167, v16, v17
    v_pk_max_i16 v167, v167, 0
    v_cvt_pk_bf16_f32 v17, v56, v57
    v_lshlrev_b32 v16, 16, v17
    v_and_b32 v17, 0xffff0000, v17
    v_add_f32 v16, v16, v40
    v_add_f32 v17, v17, v41
    v_cvt_pk_bf16_f32 v168, v16, v17
    v_pk_max_i16 v168, v168, 0
    v_cvt_pk_bf16_f32 v17, v58, v59
    v_lshlrev_b32 v16, 16, v17
    v_and_b32 v17, 0xffff0000, v17
    v_add_f32 v16, v16, v42
    v_add_f32 v17, v17, v43
    v_cvt_pk_bf16_f32 v169, v16, v17
    v_pk_max_i16 v169, v169, 0
    v_mfma_f32_32x32x16_bf16 v[64:79], v[84:87], v[120:123], v[64:79]
    v_add_f32 v149, v128, v129
    v_add_f32 v106, v130, v131
    v_cvt_pk_bf16_f32 v149, 0, v149
    v_cvt_pk_bf16_f32 v17, v60, v61
    v_lshlrev_b32 v16, 16, v17
    v_and_b32 v17, 0xffff0000, v17
    v_add_f32 v16, v16, v44
    v_add_f32 v17, v17, v45
    v_cvt_pk_bf16_f32 v170, v16, v17
    v_pk_max_i16 v170, v170, 0
    v_cvt_pk_bf16_f32 v17, v62, v63
    v_lshlrev_b32 v16, 16, v17
    v_and_b32 v17, 0xffff0000, v17
    v_add_f32 v16, v16, v46
    v_add_f32 v17, v17, v47
    v_cvt_pk_bf16_f32 v171, v16, v17
    v_pk_max_i16 v171, v171, 0
    v_lshlrev_b32 v16, 16, v228
    v_lshlrev_b32 v17, 16, v204
    v_mul_f32 v16, v16, v17
    v_and_b32 v17, 0xffff0000, v228
    v_and_b32 v21, 0xffff0000, v204
    v_mul_f32 v17, v17, v21
    v_cvt_pk_bf16_f32 v108, v16, v17
    v_lshlrev_b32 v16, 16, v229
    v_lshlrev_b32 v17, 16, v205
    v_mul_f32 v16, v16, v17
    v_and_b32 v17, 0xffff0000, v229
    v_and_b32 v21, 0xffff0000, v205
    v_mul_f32 v17, v17, v21
    v_cvt_pk_bf16_f32 v109, v16, v17
    v_lshlrev_b32 v16, 16, v230
    v_lshlrev_b32 v17, 16, v206
    v_mul_f32 v16, v16, v17
    v_and_b32 v17, 0xffff0000, v230
    v_and_b32 v21, 0xffff0000, v206
    v_mul_f32 v17, v17, v21
    v_cvt_pk_bf16_f32 v110, v16, v17
    v_lshlrev_b32 v16, 16, v231
    v_lshlrev_b32 v17, 16, v207
    v_mul_f32 v16, v16, v17
    v_and_b32 v17, 0xffff0000, v231
    v_and_b32 v21, 0xffff0000, v207
    v_mul_f32 v17, v17, v21
    v_cvt_pk_bf16_f32 v111, v16, v17
    v_smfmac_f32_16x16x64_bf16 v[132:135], v[92:95], v[116:123], v1
    ds_read_b128 v[128:131], v11 offset:2048
    v_lshlrev_b32 v16, 16, v232
    v_lshlrev_b32 v17, 16, v208
    v_mul_f32 v16, v16, v17
    v_and_b32 v17, 0xffff0000, v232
    v_and_b32 v21, 0xffff0000, v208
    v_mul_f32 v17, v17, v21
    v_cvt_pk_bf16_f32 v112, v16, v17
    v_lshlrev_b32 v16, 16, v233
    v_lshlrev_b32 v17, 16, v209
    v_mul_f32 v16, v16, v17
    v_and_b32 v17, 0xffff0000, v233
    v_and_b32 v21, 0xffff0000, v209
    v_mul_f32 v17, v17, v21
    v_cvt_pk_bf16_f32 v113, v16, v17
    v_smfmac_f32_16x16x64_bf16 v[132:135], v[172:175], v[164:171], v1
    v_lshlrev_b32 v16, 16, v234
    v_lshlrev_b32 v17, 16, v210
    v_mul_f32 v16, v16, v17
    v_and_b32 v17, 0xffff0000, v234
    v_and_b32 v21, 0xffff0000, v210
    v_mul_f32 v17, v17, v21
    v_cvt_pk_bf16_f32 v114, v16, v17
    v_lshlrev_b32 v16, 16, v235
    v_lshlrev_b32 v17, 16, v211
    v_mul_f32 v16, v16, v17
    v_and_b32 v17, 0xffff0000, v235
    v_and_b32 v21, 0xffff0000, v211
    v_mul_f32 v17, v17, v21
    v_cvt_pk_bf16_f32 v115, v16, v17
    v_mfma_f32_32x32x16_bf16 v[48:63], v[80:83], v[108:111], 0
    v_cvt_pk_bf16_f32 v17, v64, v65
    v_lshlrev_b32 v16, 16, v17
    v_and_b32 v17, 0xffff0000, v17
    v_add_f32 v16, v16, v32
    v_add_f32 v17, v17, v33
    v_cvt_pk_bf16_f32 v164, v16, v17
    v_pk_max_i16 v164, v164, 0
    v_cvt_pk_bf16_f32 v17, v66, v67
    v_lshlrev_b32 v16, 16, v17
    v_and_b32 v17, 0xffff0000, v17
    v_add_f32 v16, v16, v34
    v_add_f32 v17, v17, v35
    v_cvt_pk_bf16_f32 v165, v16, v17
    v_pk_max_i16 v165, v165, 0
    v_cvt_pk_bf16_f32 v17, v68, v69
    v_lshlrev_b32 v16, 16, v17
    v_and_b32 v17, 0xffff0000, v17
    v_add_f32 v16, v16, v36
    v_add_f32 v17, v17, v37
    v_cvt_pk_bf16_f32 v166, v16, v17
    v_pk_max_i16 v166, v166, 0
    v_cvt_pk_bf16_f32 v17, v70, v71
    v_lshlrev_b32 v16, 16, v17
    v_and_b32 v17, 0xffff0000, v17
    v_add_f32 v16, v16, v38
    v_add_f32 v17, v17, v39
    v_cvt_pk_bf16_f32 v167, v16, v17
    v_pk_max_i16 v167, v167, 0
    v_cvt_pk_bf16_f32 v17, v72, v73
    v_lshlrev_b32 v16, 16, v17
    v_and_b32 v17, 0xffff0000, v17
    v_add_f32 v16, v16, v40
    v_add_f32 v17, v17, v41
    v_cvt_pk_bf16_f32 v168, v16, v17
    v_pk_max_i16 v168, v168, 0
    v_cvt_pk_bf16_f32 v17, v74, v75
    v_lshlrev_b32 v16, 16, v17
    v_and_b32 v17, 0xffff0000, v17
    v_add_f32 v16, v16, v42
    v_add_f32 v17, v17, v43
    v_cvt_pk_bf16_f32 v169, v16, v17
    v_pk_max_i16 v169, v169, 0
    v_mfma_f32_32x32x16_bf16 v[48:63], v[84:87], v[112:115], v[48:63]
    s_waitcnt lgkmcnt(3)
    v_cvt_pk_bf16_f32 v17, v76, v77
    v_lshlrev_b32 v16, 16, v17
    v_and_b32 v17, 0xffff0000, v17
    v_add_f32 v16, v16, v44
    v_add_f32 v17, v17, v45
    v_cvt_pk_bf16_f32 v170, v16, v17
    v_pk_max_i16 v170, v170, 0
    v_cvt_pk_bf16_f32 v17, v78, v79
    v_lshlrev_b32 v16, 16, v17
    v_and_b32 v17, 0xffff0000, v17
    v_add_f32 v16, v16, v46
    v_add_f32 v17, v17, v47
    v_cvt_pk_bf16_f32 v171, v16, v17
    v_pk_max_i16 v171, v171, 0
    v_lshlrev_b32 v16, 16, v212
    v_lshlrev_b32 v17, 16, v228
    v_mul_f32 v16, v16, v17
    v_and_b32 v17, 0xffff0000, v212
    v_and_b32 v21, 0xffff0000, v228
    v_mul_f32 v17, v17, v21
    v_cvt_pk_bf16_f32 v116, v16, v17
    v_lshlrev_b32 v16, 16, v213
    v_lshlrev_b32 v17, 16, v229
    v_mul_f32 v16, v16, v17
    v_and_b32 v17, 0xffff0000, v213
    v_and_b32 v21, 0xffff0000, v229
    v_mul_f32 v17, v17, v21
    v_cvt_pk_bf16_f32 v117, v16, v17
    v_lshlrev_b32 v16, 16, v214
    v_lshlrev_b32 v17, 16, v230
    v_mul_f32 v16, v16, v17
    v_and_b32 v17, 0xffff0000, v214
    v_and_b32 v21, 0xffff0000, v230
    v_mul_f32 v17, v17, v21
    v_cvt_pk_bf16_f32 v118, v16, v17
    v_lshlrev_b32 v16, 16, v215
    v_lshlrev_b32 v17, 16, v231
    v_mul_f32 v16, v16, v17
    v_and_b32 v17, 0xffff0000, v215
    v_and_b32 v21, 0xffff0000, v231
    v_mul_f32 v17, v17, v21
    v_cvt_pk_bf16_f32 v119, v16, v17
    v_smfmac_f32_16x16x64_bf16 v[124:127], v[88:91], v[108:115], v1
    v_lshlrev_b32 v16, 16, v216
    v_lshlrev_b32 v17, 16, v232
    v_mul_f32 v16, v16, v17
    v_and_b32 v17, 0xffff0000, v216
    v_and_b32 v21, 0xffff0000, v232
    v_mul_f32 v17, v17, v21
    v_cvt_pk_bf16_f32 v120, v16, v17
    v_lshlrev_b32 v16, 16, v217
    v_lshlrev_b32 v17, 16, v233
    v_mul_f32 v16, v16, v17
    v_and_b32 v17, 0xffff0000, v217
    v_and_b32 v21, 0xffff0000, v233
    v_mul_f32 v17, v17, v21
    v_cvt_pk_bf16_f32 v121, v16, v17
    v_smfmac_f32_16x16x64_bf16 v[132:135], v[176:179], v[164:171], v1
    v_lshlrev_b32 v16, 16, v218
    v_lshlrev_b32 v17, 16, v234
    v_mul_f32 v16, v16, v17
    v_and_b32 v17, 0xffff0000, v218
    v_and_b32 v21, 0xffff0000, v234
    v_mul_f32 v17, v17, v21
    v_cvt_pk_bf16_f32 v122, v16, v17
    v_lshlrev_b32 v16, 16, v219
    v_lshlrev_b32 v17, 16, v235
    v_mul_f32 v16, v16, v17
    v_and_b32 v17, 0xffff0000, v219
    v_and_b32 v21, 0xffff0000, v235
    v_mul_f32 v17, v17, v21
    v_cvt_pk_bf16_f32 v123, v16, v17
    v_mfma_f32_32x32x16_bf16 v[64:79], v[80:83], v[116:119], 0
    v_cvt_pk_bf16_f32 v17, v48, v49
    v_lshlrev_b32 v16, 16, v17
    v_and_b32 v17, 0xffff0000, v17
    v_add_f32 v16, v16, v32
    v_add_f32 v17, v17, v33
    v_cvt_pk_bf16_f32 v164, v16, v17
    v_pk_max_i16 v164, v164, 0
    v_cvt_pk_bf16_f32 v17, v50, v51
    v_lshlrev_b32 v16, 16, v17
    v_and_b32 v17, 0xffff0000, v17
    v_add_f32 v16, v16, v34
    v_add_f32 v17, v17, v35
    v_cvt_pk_bf16_f32 v165, v16, v17
    v_pk_max_i16 v165, v165, 0
    v_cvt_pk_bf16_f32 v17, v52, v53
    v_lshlrev_b32 v16, 16, v17
    v_and_b32 v17, 0xffff0000, v17
    v_add_f32 v16, v16, v36
    v_add_f32 v17, v17, v37
    v_cvt_pk_bf16_f32 v166, v16, v17
    v_pk_max_i16 v166, v166, 0
    v_cvt_pk_bf16_f32 v17, v54, v55
    v_lshlrev_b32 v16, 16, v17
    v_and_b32 v17, 0xffff0000, v17
    v_add_f32 v16, v16, v38
    v_add_f32 v17, v17, v39
    v_cvt_pk_bf16_f32 v167, v16, v17
    v_pk_max_i16 v167, v167, 0
    v_cvt_pk_bf16_f32 v17, v56, v57
    v_lshlrev_b32 v16, 16, v17
    v_and_b32 v17, 0xffff0000, v17
    v_add_f32 v16, v16, v40
    v_add_f32 v17, v17, v41
    v_cvt_pk_bf16_f32 v168, v16, v17
    v_pk_max_i16 v168, v168, 0
    v_cvt_pk_bf16_f32 v17, v58, v59
    v_lshlrev_b32 v16, 16, v17
    v_and_b32 v17, 0xffff0000, v17
    v_add_f32 v16, v16, v42
    v_add_f32 v17, v17, v43
    v_cvt_pk_bf16_f32 v169, v16, v17
    v_pk_max_i16 v169, v169, 0
    v_mfma_f32_32x32x16_bf16 v[64:79], v[84:87], v[120:123], v[64:79]
    v_add_f32 v150, v132, v133
    v_add_f32 v107, v134, v135
    v_cvt_pk_bf16_f32 v150, 0, v150
    v_cvt_pk_bf16_f32 v17, v60, v61
    v_lshlrev_b32 v16, 16, v17
    v_and_b32 v17, 0xffff0000, v17
    v_add_f32 v16, v16, v44
    v_add_f32 v17, v17, v45
    v_cvt_pk_bf16_f32 v170, v16, v17
    v_pk_max_i16 v170, v170, 0
    v_cvt_pk_bf16_f32 v17, v62, v63
    v_lshlrev_b32 v16, 16, v17
    v_and_b32 v17, 0xffff0000, v17
    v_add_f32 v16, v16, v46
    v_add_f32 v17, v17, v47
    v_cvt_pk_bf16_f32 v171, v16, v17
    v_pk_max_i16 v171, v171, 0
    v_lshlrev_b32 v16, 16, v212
    v_lshlrev_b32 v17, 16, v236
    v_mul_f32 v16, v16, v17
    v_and_b32 v17, 0xffff0000, v212
    v_and_b32 v21, 0xffff0000, v236
    v_mul_f32 v17, v17, v21
    v_cvt_pk_bf16_f32 v108, v16, v17
    v_lshlrev_b32 v16, 16, v213
    v_lshlrev_b32 v17, 16, v237
    v_mul_f32 v16, v16, v17
    v_and_b32 v17, 0xffff0000, v213
    v_and_b32 v21, 0xffff0000, v237
    v_mul_f32 v17, v17, v21
    v_cvt_pk_bf16_f32 v109, v16, v17
    v_lshlrev_b32 v16, 16, v214
    v_lshlrev_b32 v17, 16, v238
    v_mul_f32 v16, v16, v17
    v_and_b32 v17, 0xffff0000, v214
    v_and_b32 v21, 0xffff0000, v238
    v_mul_f32 v17, v17, v21
    v_cvt_pk_bf16_f32 v110, v16, v17
    v_lshlrev_b32 v16, 16, v215
    v_lshlrev_b32 v17, 16, v239
    v_mul_f32 v16, v16, v17
    v_and_b32 v17, 0xffff0000, v215
    v_and_b32 v21, 0xffff0000, v239
    v_mul_f32 v17, v17, v21
    v_cvt_pk_bf16_f32 v111, v16, v17
    v_smfmac_f32_16x16x64_bf16 v[124:127], v[92:95], v[116:123], v1
    ds_read_b128 v[132:135], v11 offset:2048
    v_lshlrev_b32 v16, 16, v216
    v_lshlrev_b32 v17, 16, v240
    v_mul_f32 v16, v16, v17
    v_and_b32 v17, 0xffff0000, v216
    v_and_b32 v21, 0xffff0000, v240
    v_mul_f32 v17, v17, v21
    v_cvt_pk_bf16_f32 v112, v16, v17
    v_lshlrev_b32 v16, 16, v217
    v_lshlrev_b32 v17, 16, v241
    v_mul_f32 v16, v16, v17
    v_and_b32 v17, 0xffff0000, v217
    v_and_b32 v21, 0xffff0000, v241
    v_mul_f32 v17, v17, v21
    v_cvt_pk_bf16_f32 v113, v16, v17
    v_smfmac_f32_16x16x64_bf16 v[124:127], v[172:175], v[164:171], v1
    v_lshlrev_b32 v16, 16, v218
    v_lshlrev_b32 v17, 16, v242
    v_mul_f32 v16, v16, v17
    v_and_b32 v17, 0xffff0000, v218
    v_and_b32 v21, 0xffff0000, v242
    v_mul_f32 v17, v17, v21
    v_cvt_pk_bf16_f32 v114, v16, v17
    v_lshlrev_b32 v16, 16, v219
    v_lshlrev_b32 v17, 16, v243
    v_mul_f32 v16, v16, v17
    v_and_b32 v17, 0xffff0000, v219
    v_and_b32 v21, 0xffff0000, v243
    v_mul_f32 v17, v17, v21
    v_cvt_pk_bf16_f32 v115, v16, v17
    v_mfma_f32_32x32x16_bf16 v[48:63], v[80:83], v[108:111], 0
    v_cvt_pk_bf16_f32 v17, v64, v65
    v_lshlrev_b32 v16, 16, v17
    v_and_b32 v17, 0xffff0000, v17
    v_add_f32 v16, v16, v32
    v_add_f32 v17, v17, v33
    v_cvt_pk_bf16_f32 v164, v16, v17
    v_pk_max_i16 v164, v164, 0
    v_cvt_pk_bf16_f32 v17, v66, v67
    v_lshlrev_b32 v16, 16, v17
    v_and_b32 v17, 0xffff0000, v17
    v_add_f32 v16, v16, v34
    v_add_f32 v17, v17, v35
    v_cvt_pk_bf16_f32 v165, v16, v17
    v_pk_max_i16 v165, v165, 0
    v_cvt_pk_bf16_f32 v17, v68, v69
    v_lshlrev_b32 v16, 16, v17
    v_and_b32 v17, 0xffff0000, v17
    v_add_f32 v16, v16, v36
    v_add_f32 v17, v17, v37
    v_cvt_pk_bf16_f32 v166, v16, v17
    v_pk_max_i16 v166, v166, 0
    v_cvt_pk_bf16_f32 v17, v70, v71
    v_lshlrev_b32 v16, 16, v17
    v_and_b32 v17, 0xffff0000, v17
    v_add_f32 v16, v16, v38
    v_add_f32 v17, v17, v39
    v_cvt_pk_bf16_f32 v167, v16, v17
    v_pk_max_i16 v167, v167, 0
    v_cvt_pk_bf16_f32 v17, v72, v73
    v_lshlrev_b32 v16, 16, v17
    v_and_b32 v17, 0xffff0000, v17
    v_add_f32 v16, v16, v40
    v_add_f32 v17, v17, v41
    v_cvt_pk_bf16_f32 v168, v16, v17
    v_pk_max_i16 v168, v168, 0
    v_cvt_pk_bf16_f32 v17, v74, v75
    v_lshlrev_b32 v16, 16, v17
    v_and_b32 v17, 0xffff0000, v17
    v_add_f32 v16, v16, v42
    v_add_f32 v17, v17, v43
    v_cvt_pk_bf16_f32 v169, v16, v17
    v_pk_max_i16 v169, v169, 0
    v_mfma_f32_32x32x16_bf16 v[48:63], v[84:87], v[112:115], v[48:63]
    s_waitcnt lgkmcnt(1)
    v_cvt_pk_bf16_f32 v17, v76, v77
    v_lshlrev_b32 v16, 16, v17
    v_and_b32 v17, 0xffff0000, v17
    v_add_f32 v16, v16, v44
    v_add_f32 v17, v17, v45
    v_cvt_pk_bf16_f32 v170, v16, v17
    v_pk_max_i16 v170, v170, 0
    v_cvt_pk_bf16_f32 v17, v78, v79
    v_lshlrev_b32 v16, 16, v17
    v_and_b32 v17, 0xffff0000, v17
    v_add_f32 v16, v16, v46
    v_add_f32 v17, v17, v47
    v_cvt_pk_bf16_f32 v171, v16, v17
    v_pk_max_i16 v171, v171, 0
    v_lshlrev_b32 v16, 16, v188
    v_lshlrev_b32 v17, 16, v204
    v_mul_f32 v16, v16, v17
    v_and_b32 v17, 0xffff0000, v188
    v_and_b32 v21, 0xffff0000, v204
    v_mul_f32 v17, v17, v21
    v_cvt_pk_bf16_f32 v116, v16, v17
    v_lshlrev_b32 v16, 16, v189
    v_lshlrev_b32 v17, 16, v205
    v_mul_f32 v16, v16, v17
    v_and_b32 v17, 0xffff0000, v189
    v_and_b32 v21, 0xffff0000, v205
    v_mul_f32 v17, v17, v21
    v_cvt_pk_bf16_f32 v117, v16, v17
    v_lshlrev_b32 v16, 16, v190
    v_lshlrev_b32 v17, 16, v206
    v_mul_f32 v16, v16, v17
    v_and_b32 v17, 0xffff0000, v190
    v_and_b32 v21, 0xffff0000, v206
    v_mul_f32 v17, v17, v21
    v_cvt_pk_bf16_f32 v118, v16, v17
    v_lshlrev_b32 v16, 16, v191
    v_lshlrev_b32 v17, 16, v207
    v_mul_f32 v16, v16, v17
    v_and_b32 v17, 0xffff0000, v191
    v_and_b32 v21, 0xffff0000, v207
    v_mul_f32 v17, v17, v21
    v_cvt_pk_bf16_f32 v119, v16, v17
    v_smfmac_f32_16x16x64_bf16 v[128:131], v[88:91], v[108:115], v1
    ds_read_b128 v[212:215], v7 offset:1024
    v_lshlrev_b32 v16, 16, v192
    v_lshlrev_b32 v17, 16, v208
    v_mul_f32 v16, v16, v17
    v_and_b32 v17, 0xffff0000, v192
    v_and_b32 v21, 0xffff0000, v208
    v_mul_f32 v17, v17, v21
    v_cvt_pk_bf16_f32 v120, v16, v17
    v_lshlrev_b32 v16, 16, v193
    v_lshlrev_b32 v17, 16, v209
    v_mul_f32 v16, v16, v17
    v_and_b32 v17, 0xffff0000, v193
    v_and_b32 v21, 0xffff0000, v209
    v_mul_f32 v17, v17, v21
    v_cvt_pk_bf16_f32 v121, v16, v17
    v_smfmac_f32_16x16x64_bf16 v[124:127], v[176:179], v[164:171], v1
    ds_read_b128 v[216:219], v7 offset:5184
    v_lshlrev_b32 v16, 16, v194
    v_lshlrev_b32 v17, 16, v210
    v_mul_f32 v16, v16, v17
    v_and_b32 v17, 0xffff0000, v194
    v_and_b32 v21, 0xffff0000, v210
    v_mul_f32 v17, v17, v21
    v_cvt_pk_bf16_f32 v122, v16, v17
    v_lshlrev_b32 v16, 16, v195
    v_lshlrev_b32 v17, 16, v211
    v_mul_f32 v16, v16, v17
    v_and_b32 v17, 0xffff0000, v195
    v_and_b32 v21, 0xffff0000, v211
    v_mul_f32 v17, v17, v21
    v_cvt_pk_bf16_f32 v123, v16, v17
    v_mfma_f32_32x32x16_bf16 v[64:79], v[80:83], v[116:119], 0
    v_cvt_pk_bf16_f32 v17, v48, v49
    v_lshlrev_b32 v16, 16, v17
    v_and_b32 v17, 0xffff0000, v17
    v_add_f32 v16, v16, v32
    v_add_f32 v17, v17, v33
    v_cvt_pk_bf16_f32 v164, v16, v17
    v_pk_max_i16 v164, v164, 0
    v_cvt_pk_bf16_f32 v17, v50, v51
    v_lshlrev_b32 v16, 16, v17
    v_and_b32 v17, 0xffff0000, v17
    v_add_f32 v16, v16, v34
    v_add_f32 v17, v17, v35
    v_cvt_pk_bf16_f32 v165, v16, v17
    v_pk_max_i16 v165, v165, 0
    v_cvt_pk_bf16_f32 v17, v52, v53
    v_lshlrev_b32 v16, 16, v17
    v_and_b32 v17, 0xffff0000, v17
    v_add_f32 v16, v16, v36
    v_add_f32 v17, v17, v37
    v_cvt_pk_bf16_f32 v166, v16, v17
    v_pk_max_i16 v166, v166, 0
    v_cvt_pk_bf16_f32 v17, v54, v55
    v_lshlrev_b32 v16, 16, v17
    v_and_b32 v17, 0xffff0000, v17
    v_add_f32 v16, v16, v38
    v_add_f32 v17, v17, v39
    v_cvt_pk_bf16_f32 v167, v16, v17
    v_pk_max_i16 v167, v167, 0
    v_cvt_pk_bf16_f32 v17, v56, v57
    v_lshlrev_b32 v16, 16, v17
    v_and_b32 v17, 0xffff0000, v17
    v_add_f32 v16, v16, v40
    v_add_f32 v17, v17, v41
    v_cvt_pk_bf16_f32 v168, v16, v17
    v_pk_max_i16 v168, v168, 0
    v_cvt_pk_bf16_f32 v17, v58, v59
    v_lshlrev_b32 v16, 16, v17
    v_and_b32 v17, 0xffff0000, v17
    v_add_f32 v16, v16, v42
    v_add_f32 v17, v17, v43
    v_cvt_pk_bf16_f32 v169, v16, v17
    v_pk_max_i16 v169, v169, 0
    v_mfma_f32_32x32x16_bf16 v[64:79], v[84:87], v[120:123], v[64:79]
    v_add_f32 v151, v124, v125
    v_add_f32 v96, v126, v127
    v_cvt_pk_bf16_f32 v151, 0, v151
    v_cvt_pk_bf16_f32 v17, v60, v61
    v_lshlrev_b32 v16, 16, v17
    v_and_b32 v17, 0xffff0000, v17
    v_add_f32 v16, v16, v44
    v_add_f32 v17, v17, v45
    v_cvt_pk_bf16_f32 v170, v16, v17
    v_pk_max_i16 v170, v170, 0
    v_cvt_pk_bf16_f32 v17, v62, v63
    v_lshlrev_b32 v16, 16, v17
    v_and_b32 v17, 0xffff0000, v17
    v_add_f32 v16, v16, v46
    v_add_f32 v17, v17, v47
    v_cvt_pk_bf16_f32 v171, v16, v17
    v_pk_max_i16 v171, v171, 0
    v_lshlrev_b32 v16, 16, v196
    v_lshlrev_b32 v17, 16, v188
    v_mul_f32 v16, v16, v17
    v_and_b32 v17, 0xffff0000, v196
    v_and_b32 v21, 0xffff0000, v188
    v_mul_f32 v17, v17, v21
    v_cvt_pk_bf16_f32 v108, v16, v17
    v_lshlrev_b32 v16, 16, v197
    v_lshlrev_b32 v17, 16, v189
    v_mul_f32 v16, v16, v17
    v_and_b32 v17, 0xffff0000, v197
    v_and_b32 v21, 0xffff0000, v189
    v_mul_f32 v17, v17, v21
    v_cvt_pk_bf16_f32 v109, v16, v17
    v_lshlrev_b32 v16, 16, v198
    v_lshlrev_b32 v17, 16, v190
    v_mul_f32 v16, v16, v17
    v_and_b32 v17, 0xffff0000, v198
    v_and_b32 v21, 0xffff0000, v190
    v_mul_f32 v17, v17, v21
    v_cvt_pk_bf16_f32 v110, v16, v17
    v_lshlrev_b32 v16, 16, v199
    v_lshlrev_b32 v17, 16, v191
    v_mul_f32 v16, v16, v17
    v_and_b32 v17, 0xffff0000, v199
    v_and_b32 v21, 0xffff0000, v191
    v_mul_f32 v17, v17, v21
    v_cvt_pk_bf16_f32 v111, v16, v17
    v_smfmac_f32_16x16x64_bf16 v[128:131], v[92:95], v[116:123], v1
    ds_read_b128 v[124:127], v11 offset:2048
    v_lshlrev_b32 v16, 16, v200
    v_lshlrev_b32 v17, 16, v192
    v_mul_f32 v16, v16, v17
    v_and_b32 v17, 0xffff0000, v200
    v_and_b32 v21, 0xffff0000, v192
    v_mul_f32 v17, v17, v21
    v_cvt_pk_bf16_f32 v112, v16, v17
    v_lshlrev_b32 v16, 16, v201
    v_lshlrev_b32 v17, 16, v193
    v_mul_f32 v16, v16, v17
    v_and_b32 v17, 0xffff0000, v201
    v_and_b32 v21, 0xffff0000, v193
    v_mul_f32 v17, v17, v21
    v_cvt_pk_bf16_f32 v113, v16, v17
    v_smfmac_f32_16x16x64_bf16 v[128:131], v[172:175], v[164:171], v1
    v_lshlrev_b32 v16, 16, v202
    v_lshlrev_b32 v17, 16, v194
    v_mul_f32 v16, v16, v17
    v_and_b32 v17, 0xffff0000, v202
    v_and_b32 v21, 0xffff0000, v194
    v_mul_f32 v17, v17, v21
    v_cvt_pk_bf16_f32 v114, v16, v17
    v_lshlrev_b32 v16, 16, v203
    v_lshlrev_b32 v17, 16, v195
    v_mul_f32 v16, v16, v17
    v_and_b32 v17, 0xffff0000, v203
    v_and_b32 v21, 0xffff0000, v195
    v_mul_f32 v17, v17, v21
    v_cvt_pk_bf16_f32 v115, v16, v17
    v_mfma_f32_32x32x16_bf16 v[48:63], v[80:83], v[108:111], 0
    v_cvt_pk_bf16_f32 v17, v64, v65
    v_lshlrev_b32 v16, 16, v17
    v_and_b32 v17, 0xffff0000, v17
    v_add_f32 v16, v16, v32
    v_add_f32 v17, v17, v33
    v_cvt_pk_bf16_f32 v164, v16, v17
    v_pk_max_i16 v164, v164, 0
    v_cvt_pk_bf16_f32 v17, v66, v67
    v_lshlrev_b32 v16, 16, v17
    v_and_b32 v17, 0xffff0000, v17
    v_add_f32 v16, v16, v34
    v_add_f32 v17, v17, v35
    v_cvt_pk_bf16_f32 v165, v16, v17
    v_pk_max_i16 v165, v165, 0
    v_cvt_pk_bf16_f32 v17, v68, v69
    v_lshlrev_b32 v16, 16, v17
    v_and_b32 v17, 0xffff0000, v17
    v_add_f32 v16, v16, v36
    v_add_f32 v17, v17, v37
    v_cvt_pk_bf16_f32 v166, v16, v17
    v_pk_max_i16 v166, v166, 0
    v_cvt_pk_bf16_f32 v17, v70, v71
    v_lshlrev_b32 v16, 16, v17
    v_and_b32 v17, 0xffff0000, v17
    v_add_f32 v16, v16, v38
    v_add_f32 v17, v17, v39
    v_cvt_pk_bf16_f32 v167, v16, v17
    v_pk_max_i16 v167, v167, 0
    v_cvt_pk_bf16_f32 v17, v72, v73
    v_lshlrev_b32 v16, 16, v17
    v_and_b32 v17, 0xffff0000, v17
    v_add_f32 v16, v16, v40
    v_add_f32 v17, v17, v41
    v_cvt_pk_bf16_f32 v168, v16, v17
    v_pk_max_i16 v168, v168, 0
    v_cvt_pk_bf16_f32 v17, v74, v75
    v_lshlrev_b32 v16, 16, v17
    v_and_b32 v17, 0xffff0000, v17
    v_add_f32 v16, v16, v42
    v_add_f32 v17, v17, v43
    v_cvt_pk_bf16_f32 v169, v16, v17
    v_pk_max_i16 v169, v169, 0
    v_mfma_f32_32x32x16_bf16 v[48:63], v[84:87], v[112:115], v[48:63]
    s_waitcnt lgkmcnt(3)
    v_cvt_pk_bf16_f32 v17, v76, v77
    v_lshlrev_b32 v16, 16, v17
    v_and_b32 v17, 0xffff0000, v17
    v_add_f32 v16, v16, v44
    v_add_f32 v17, v17, v45
    v_cvt_pk_bf16_f32 v170, v16, v17
    v_pk_max_i16 v170, v170, 0
    v_cvt_pk_bf16_f32 v17, v78, v79
    v_lshlrev_b32 v16, 16, v17
    v_and_b32 v17, 0xffff0000, v17
    v_add_f32 v16, v16, v46
    v_add_f32 v17, v17, v47
    v_cvt_pk_bf16_f32 v171, v16, v17
    v_pk_max_i16 v171, v171, 0
    v_lshlrev_b32 v16, 16, v220
    v_lshlrev_b32 v17, 16, v188
    v_mul_f32 v16, v16, v17
    v_and_b32 v17, 0xffff0000, v220
    v_and_b32 v21, 0xffff0000, v188
    v_mul_f32 v17, v17, v21
    v_cvt_pk_bf16_f32 v116, v16, v17
    v_lshlrev_b32 v16, 16, v221
    v_lshlrev_b32 v17, 16, v189
    v_mul_f32 v16, v16, v17
    v_and_b32 v17, 0xffff0000, v221
    v_and_b32 v21, 0xffff0000, v189
    v_mul_f32 v17, v17, v21
    v_cvt_pk_bf16_f32 v117, v16, v17
    v_lshlrev_b32 v16, 16, v222
    v_lshlrev_b32 v17, 16, v190
    v_mul_f32 v16, v16, v17
    v_and_b32 v17, 0xffff0000, v222
    v_and_b32 v21, 0xffff0000, v190
    v_mul_f32 v17, v17, v21
    v_cvt_pk_bf16_f32 v118, v16, v17
    v_lshlrev_b32 v16, 16, v223
    v_lshlrev_b32 v17, 16, v191
    v_mul_f32 v16, v16, v17
    v_and_b32 v17, 0xffff0000, v223
    v_and_b32 v21, 0xffff0000, v191
    v_mul_f32 v17, v17, v21
    v_cvt_pk_bf16_f32 v119, v16, v17
    v_smfmac_f32_16x16x64_bf16 v[132:135], v[88:91], v[108:115], v1
    v_lshlrev_b32 v16, 16, v224
    v_lshlrev_b32 v17, 16, v192
    v_mul_f32 v16, v16, v17
    v_and_b32 v17, 0xffff0000, v224
    v_and_b32 v21, 0xffff0000, v192
    v_mul_f32 v17, v17, v21
    v_cvt_pk_bf16_f32 v120, v16, v17
    v_lshlrev_b32 v16, 16, v225
    v_lshlrev_b32 v17, 16, v193
    v_mul_f32 v16, v16, v17
    v_and_b32 v17, 0xffff0000, v225
    v_and_b32 v21, 0xffff0000, v193
    v_mul_f32 v17, v17, v21
    v_cvt_pk_bf16_f32 v121, v16, v17
    v_smfmac_f32_16x16x64_bf16 v[128:131], v[176:179], v[164:171], v1
    v_lshlrev_b32 v16, 16, v226
    v_lshlrev_b32 v17, 16, v194
    v_mul_f32 v16, v16, v17
    v_and_b32 v17, 0xffff0000, v226
    v_and_b32 v21, 0xffff0000, v194
    v_mul_f32 v17, v17, v21
    v_cvt_pk_bf16_f32 v122, v16, v17
    v_lshlrev_b32 v16, 16, v227
    v_lshlrev_b32 v17, 16, v195
    v_mul_f32 v16, v16, v17
    v_and_b32 v17, 0xffff0000, v227
    v_and_b32 v21, 0xffff0000, v195
    v_mul_f32 v17, v17, v21
    v_cvt_pk_bf16_f32 v123, v16, v17
    v_mfma_f32_32x32x16_bf16 v[64:79], v[80:83], v[116:119], 0
    v_cvt_pk_bf16_f32 v17, v48, v49
    v_lshlrev_b32 v16, 16, v17
    v_and_b32 v17, 0xffff0000, v17
    v_add_f32 v16, v16, v32
    v_add_f32 v17, v17, v33
    v_cvt_pk_bf16_f32 v164, v16, v17
    v_pk_max_i16 v164, v164, 0
    v_cvt_pk_bf16_f32 v17, v50, v51
    v_lshlrev_b32 v16, 16, v17
    v_and_b32 v17, 0xffff0000, v17
    v_add_f32 v16, v16, v34
    v_add_f32 v17, v17, v35
    v_cvt_pk_bf16_f32 v165, v16, v17
    v_pk_max_i16 v165, v165, 0
    v_cvt_pk_bf16_f32 v17, v52, v53
    v_lshlrev_b32 v16, 16, v17
    v_and_b32 v17, 0xffff0000, v17
    v_add_f32 v16, v16, v36
    v_add_f32 v17, v17, v37
    v_cvt_pk_bf16_f32 v166, v16, v17
    v_pk_max_i16 v166, v166, 0
    v_cvt_pk_bf16_f32 v17, v54, v55
    v_lshlrev_b32 v16, 16, v17
    v_and_b32 v17, 0xffff0000, v17
    v_add_f32 v16, v16, v38
    v_add_f32 v17, v17, v39
    v_cvt_pk_bf16_f32 v167, v16, v17
    v_pk_max_i16 v167, v167, 0
    v_cvt_pk_bf16_f32 v17, v56, v57
    v_lshlrev_b32 v16, 16, v17
    v_and_b32 v17, 0xffff0000, v17
    v_add_f32 v16, v16, v40
    v_add_f32 v17, v17, v41
    v_cvt_pk_bf16_f32 v168, v16, v17
    v_pk_max_i16 v168, v168, 0
    v_cvt_pk_bf16_f32 v17, v58, v59
    v_lshlrev_b32 v16, 16, v17
    v_and_b32 v17, 0xffff0000, v17
    v_add_f32 v16, v16, v42
    v_add_f32 v17, v17, v43
    v_cvt_pk_bf16_f32 v169, v16, v17
    v_pk_max_i16 v169, v169, 0
    v_mfma_f32_32x32x16_bf16 v[64:79], v[84:87], v[120:123], v[64:79]
    v_add_f32 v152, v128, v129
    v_add_f32 v97, v130, v131
    v_cvt_pk_bf16_f32 v152, 0, v152
    v_cvt_pk_bf16_f32 v17, v60, v61
    v_lshlrev_b32 v16, 16, v17
    v_and_b32 v17, 0xffff0000, v17
    v_add_f32 v16, v16, v44
    v_add_f32 v17, v17, v45
    v_cvt_pk_bf16_f32 v170, v16, v17
    v_pk_max_i16 v170, v170, 0
    v_cvt_pk_bf16_f32 v17, v62, v63
    v_lshlrev_b32 v16, 16, v17
    v_and_b32 v17, 0xffff0000, v17
    v_add_f32 v16, v16, v46
    v_add_f32 v17, v17, v47
    v_cvt_pk_bf16_f32 v171, v16, v17
    v_pk_max_i16 v171, v171, 0
    v_lshlrev_b32 v16, 16, v180
    v_lshlrev_b32 v17, 16, v188
    v_mul_f32 v16, v16, v17
    v_and_b32 v17, 0xffff0000, v180
    v_and_b32 v21, 0xffff0000, v188
    v_mul_f32 v17, v17, v21
    v_cvt_pk_bf16_f32 v108, v16, v17
    v_lshlrev_b32 v16, 16, v181
    v_lshlrev_b32 v17, 16, v189
    v_mul_f32 v16, v16, v17
    v_and_b32 v17, 0xffff0000, v181
    v_and_b32 v21, 0xffff0000, v189
    v_mul_f32 v17, v17, v21
    v_cvt_pk_bf16_f32 v109, v16, v17
    v_lshlrev_b32 v16, 16, v182
    v_lshlrev_b32 v17, 16, v190
    v_mul_f32 v16, v16, v17
    v_and_b32 v17, 0xffff0000, v182
    v_and_b32 v21, 0xffff0000, v190
    v_mul_f32 v17, v17, v21
    v_cvt_pk_bf16_f32 v110, v16, v17
    v_lshlrev_b32 v16, 16, v183
    v_lshlrev_b32 v17, 16, v191
    v_mul_f32 v16, v16, v17
    v_and_b32 v17, 0xffff0000, v183
    v_and_b32 v21, 0xffff0000, v191
    v_mul_f32 v17, v17, v21
    v_cvt_pk_bf16_f32 v111, v16, v17
    v_smfmac_f32_16x16x64_bf16 v[132:135], v[92:95], v[116:123], v1
    ds_read_b128 v[128:131], v11 offset:2048
    v_lshlrev_b32 v16, 16, v184
    v_lshlrev_b32 v17, 16, v192
    v_mul_f32 v16, v16, v17
    v_and_b32 v17, 0xffff0000, v184
    v_and_b32 v21, 0xffff0000, v192
    v_mul_f32 v17, v17, v21
    v_cvt_pk_bf16_f32 v112, v16, v17
    v_lshlrev_b32 v16, 16, v185
    v_lshlrev_b32 v17, 16, v193
    v_mul_f32 v16, v16, v17
    v_and_b32 v17, 0xffff0000, v185
    v_and_b32 v21, 0xffff0000, v193
    v_mul_f32 v17, v17, v21
    v_cvt_pk_bf16_f32 v113, v16, v17
    v_smfmac_f32_16x16x64_bf16 v[132:135], v[172:175], v[164:171], v1
    v_lshlrev_b32 v16, 16, v186
    v_lshlrev_b32 v17, 16, v194
    v_mul_f32 v16, v16, v17
    v_and_b32 v17, 0xffff0000, v186
    v_and_b32 v21, 0xffff0000, v194
    v_mul_f32 v17, v17, v21
    v_cvt_pk_bf16_f32 v114, v16, v17
    v_lshlrev_b32 v16, 16, v187
    v_lshlrev_b32 v17, 16, v195
    v_mul_f32 v16, v16, v17
    v_and_b32 v17, 0xffff0000, v187
    v_and_b32 v21, 0xffff0000, v195
    v_mul_f32 v17, v17, v21
    v_cvt_pk_bf16_f32 v115, v16, v17
    v_mfma_f32_32x32x16_bf16 v[48:63], v[80:83], v[108:111], 0
    v_cvt_pk_bf16_f32 v17, v64, v65
    v_lshlrev_b32 v16, 16, v17
    v_and_b32 v17, 0xffff0000, v17
    v_add_f32 v16, v16, v32
    v_add_f32 v17, v17, v33
    v_cvt_pk_bf16_f32 v164, v16, v17
    v_pk_max_i16 v164, v164, 0
    v_cvt_pk_bf16_f32 v17, v66, v67
    v_lshlrev_b32 v16, 16, v17
    v_and_b32 v17, 0xffff0000, v17
    v_add_f32 v16, v16, v34
    v_add_f32 v17, v17, v35
    v_cvt_pk_bf16_f32 v165, v16, v17
    v_pk_max_i16 v165, v165, 0
    v_cvt_pk_bf16_f32 v17, v68, v69
    v_lshlrev_b32 v16, 16, v17
    v_and_b32 v17, 0xffff0000, v17
    v_add_f32 v16, v16, v36
    v_add_f32 v17, v17, v37
    v_cvt_pk_bf16_f32 v166, v16, v17
    v_pk_max_i16 v166, v166, 0
    v_cvt_pk_bf16_f32 v17, v70, v71
    v_lshlrev_b32 v16, 16, v17
    v_and_b32 v17, 0xffff0000, v17
    v_add_f32 v16, v16, v38
    v_add_f32 v17, v17, v39
    v_cvt_pk_bf16_f32 v167, v16, v17
    v_pk_max_i16 v167, v167, 0
    v_cvt_pk_bf16_f32 v17, v72, v73
    v_lshlrev_b32 v16, 16, v17
    v_and_b32 v17, 0xffff0000, v17
    v_add_f32 v16, v16, v40
    v_add_f32 v17, v17, v41
    v_cvt_pk_bf16_f32 v168, v16, v17
    v_pk_max_i16 v168, v168, 0
    v_cvt_pk_bf16_f32 v17, v74, v75
    v_lshlrev_b32 v16, 16, v17
    v_and_b32 v17, 0xffff0000, v17
    v_add_f32 v16, v16, v42
    v_add_f32 v17, v17, v43
    v_cvt_pk_bf16_f32 v169, v16, v17
    v_pk_max_i16 v169, v169, 0
    v_mfma_f32_32x32x16_bf16 v[48:63], v[84:87], v[112:115], v[48:63]
    s_waitcnt lgkmcnt(1)
    v_cvt_pk_bf16_f32 v17, v76, v77
    v_lshlrev_b32 v16, 16, v17
    v_and_b32 v17, 0xffff0000, v17
    v_add_f32 v16, v16, v44
    v_add_f32 v17, v17, v45
    v_cvt_pk_bf16_f32 v170, v16, v17
    v_pk_max_i16 v170, v170, 0
    v_cvt_pk_bf16_f32 v17, v78, v79
    v_lshlrev_b32 v16, 16, v17
    v_and_b32 v17, 0xffff0000, v17
    v_add_f32 v16, v16, v46
    v_add_f32 v17, v17, v47
    v_cvt_pk_bf16_f32 v171, v16, v17
    v_pk_max_i16 v171, v171, 0
    v_lshlrev_b32 v16, 16, v236
    v_lshlrev_b32 v17, 16, v188
    v_mul_f32 v16, v16, v17
    v_and_b32 v17, 0xffff0000, v236
    v_and_b32 v21, 0xffff0000, v188
    v_mul_f32 v17, v17, v21
    v_cvt_pk_bf16_f32 v116, v16, v17
    v_lshlrev_b32 v16, 16, v237
    v_lshlrev_b32 v17, 16, v189
    v_mul_f32 v16, v16, v17
    v_and_b32 v17, 0xffff0000, v237
    v_and_b32 v21, 0xffff0000, v189
    v_mul_f32 v17, v17, v21
    v_cvt_pk_bf16_f32 v117, v16, v17
    v_lshlrev_b32 v16, 16, v238
    v_lshlrev_b32 v17, 16, v190
    v_mul_f32 v16, v16, v17
    v_and_b32 v17, 0xffff0000, v238
    v_and_b32 v21, 0xffff0000, v190
    v_mul_f32 v17, v17, v21
    v_cvt_pk_bf16_f32 v118, v16, v17
    v_lshlrev_b32 v16, 16, v239
    v_lshlrev_b32 v17, 16, v191
    v_mul_f32 v16, v16, v17
    v_and_b32 v17, 0xffff0000, v239
    v_and_b32 v21, 0xffff0000, v191
    v_mul_f32 v17, v17, v21
    v_cvt_pk_bf16_f32 v119, v16, v17
    v_smfmac_f32_16x16x64_bf16 v[124:127], v[88:91], v[108:115], v1
    v_lshlrev_b32 v16, 16, v240
    v_lshlrev_b32 v17, 16, v192
    v_mul_f32 v16, v16, v17
    v_and_b32 v17, 0xffff0000, v240
    v_and_b32 v21, 0xffff0000, v192
    v_mul_f32 v17, v17, v21
    v_cvt_pk_bf16_f32 v120, v16, v17
    v_lshlrev_b32 v16, 16, v241
    v_lshlrev_b32 v17, 16, v193
    v_mul_f32 v16, v16, v17
    v_and_b32 v17, 0xffff0000, v241
    v_and_b32 v21, 0xffff0000, v193
    v_mul_f32 v17, v17, v21
    v_cvt_pk_bf16_f32 v121, v16, v17
    v_smfmac_f32_16x16x64_bf16 v[132:135], v[176:179], v[164:171], v1
    v_lshlrev_b32 v16, 16, v242
    v_lshlrev_b32 v17, 16, v194
    v_mul_f32 v16, v16, v17
    v_and_b32 v17, 0xffff0000, v242
    v_and_b32 v21, 0xffff0000, v194
    v_mul_f32 v17, v17, v21
    v_cvt_pk_bf16_f32 v122, v16, v17
    v_lshlrev_b32 v16, 16, v243
    v_lshlrev_b32 v17, 16, v195
    v_mul_f32 v16, v16, v17
    v_and_b32 v17, 0xffff0000, v243
    v_and_b32 v21, 0xffff0000, v195
    v_mul_f32 v17, v17, v21
    v_cvt_pk_bf16_f32 v123, v16, v17
    v_mfma_f32_32x32x16_bf16 v[64:79], v[80:83], v[116:119], 0
    v_cvt_pk_bf16_f32 v17, v48, v49
    v_lshlrev_b32 v16, 16, v17
    v_and_b32 v17, 0xffff0000, v17
    v_add_f32 v16, v16, v32
    v_add_f32 v17, v17, v33
    v_cvt_pk_bf16_f32 v164, v16, v17
    v_pk_max_i16 v164, v164, 0
    v_cvt_pk_bf16_f32 v17, v50, v51
    v_lshlrev_b32 v16, 16, v17
    v_and_b32 v17, 0xffff0000, v17
    v_add_f32 v16, v16, v34
    v_add_f32 v17, v17, v35
    v_cvt_pk_bf16_f32 v165, v16, v17
    v_pk_max_i16 v165, v165, 0
    v_cvt_pk_bf16_f32 v17, v52, v53
    v_lshlrev_b32 v16, 16, v17
    v_and_b32 v17, 0xffff0000, v17
    v_add_f32 v16, v16, v36
    v_add_f32 v17, v17, v37
    v_cvt_pk_bf16_f32 v166, v16, v17
    v_pk_max_i16 v166, v166, 0
    v_cvt_pk_bf16_f32 v17, v54, v55
    v_lshlrev_b32 v16, 16, v17
    v_and_b32 v17, 0xffff0000, v17
    v_add_f32 v16, v16, v38
    v_add_f32 v17, v17, v39
    v_cvt_pk_bf16_f32 v167, v16, v17
    v_pk_max_i16 v167, v167, 0
    v_cvt_pk_bf16_f32 v17, v56, v57
    v_lshlrev_b32 v16, 16, v17
    v_and_b32 v17, 0xffff0000, v17
    v_add_f32 v16, v16, v40
    v_add_f32 v17, v17, v41
    v_cvt_pk_bf16_f32 v168, v16, v17
    v_pk_max_i16 v168, v168, 0
    v_cvt_pk_bf16_f32 v17, v58, v59
    v_lshlrev_b32 v16, 16, v17
    v_and_b32 v17, 0xffff0000, v17
    v_add_f32 v16, v16, v42
    v_add_f32 v17, v17, v43
    v_cvt_pk_bf16_f32 v169, v16, v17
    v_pk_max_i16 v169, v169, 0
    v_mfma_f32_32x32x16_bf16 v[64:79], v[84:87], v[120:123], v[64:79]
    v_add_f32 v153, v132, v133
    v_add_f32 v98, v134, v135
    v_cvt_pk_bf16_f32 v153, 0, v153
    v_cvt_pk_bf16_f32 v17, v60, v61
    v_lshlrev_b32 v16, 16, v17
    v_and_b32 v17, 0xffff0000, v17
    v_add_f32 v16, v16, v44
    v_add_f32 v17, v17, v45
    v_cvt_pk_bf16_f32 v170, v16, v17
    v_pk_max_i16 v170, v170, 0
    v_cvt_pk_bf16_f32 v17, v62, v63
    v_lshlrev_b32 v16, 16, v17
    v_and_b32 v17, 0xffff0000, v17
    v_add_f32 v16, v16, v46
    v_add_f32 v17, v17, v47
    v_cvt_pk_bf16_f32 v171, v16, v17
    v_pk_max_i16 v171, v171, 0
    v_lshlrev_b32 v16, 16, v228
    v_lshlrev_b32 v17, 16, v188
    v_mul_f32 v16, v16, v17
    v_and_b32 v17, 0xffff0000, v228
    v_and_b32 v21, 0xffff0000, v188
    v_mul_f32 v17, v17, v21
    v_cvt_pk_bf16_f32 v108, v16, v17
    v_lshlrev_b32 v16, 16, v229
    v_lshlrev_b32 v17, 16, v189
    v_mul_f32 v16, v16, v17
    v_and_b32 v17, 0xffff0000, v229
    v_and_b32 v21, 0xffff0000, v189
    v_mul_f32 v17, v17, v21
    v_cvt_pk_bf16_f32 v109, v16, v17
    v_lshlrev_b32 v16, 16, v230
    v_lshlrev_b32 v17, 16, v190
    v_mul_f32 v16, v16, v17
    v_and_b32 v17, 0xffff0000, v230
    v_and_b32 v21, 0xffff0000, v190
    v_mul_f32 v17, v17, v21
    v_cvt_pk_bf16_f32 v110, v16, v17
    v_lshlrev_b32 v16, 16, v231
    v_lshlrev_b32 v17, 16, v191
    v_mul_f32 v16, v16, v17
    v_and_b32 v17, 0xffff0000, v231
    v_and_b32 v21, 0xffff0000, v191
    v_mul_f32 v17, v17, v21
    v_cvt_pk_bf16_f32 v111, v16, v17
    v_smfmac_f32_16x16x64_bf16 v[124:127], v[92:95], v[116:123], v1
    ds_read_b128 v[132:135], v22 offset:2048
    v_lshlrev_b32 v16, 16, v232
    v_lshlrev_b32 v17, 16, v192
    v_mul_f32 v16, v16, v17
    v_and_b32 v17, 0xffff0000, v232
    v_and_b32 v21, 0xffff0000, v192
    v_mul_f32 v17, v17, v21
    v_cvt_pk_bf16_f32 v112, v16, v17
    v_lshlrev_b32 v16, 16, v233
    v_lshlrev_b32 v17, 16, v193
    v_mul_f32 v16, v16, v17
    v_and_b32 v17, 0xffff0000, v233
    v_and_b32 v21, 0xffff0000, v193
    v_mul_f32 v17, v17, v21
    v_cvt_pk_bf16_f32 v113, v16, v17
    v_smfmac_f32_16x16x64_bf16 v[124:127], v[172:175], v[164:171], v1
    v_lshlrev_b32 v16, 16, v234
    v_lshlrev_b32 v17, 16, v194
    v_mul_f32 v16, v16, v17
    v_and_b32 v17, 0xffff0000, v234
    v_and_b32 v21, 0xffff0000, v194
    v_mul_f32 v17, v17, v21
    v_cvt_pk_bf16_f32 v114, v16, v17
    v_lshlrev_b32 v16, 16, v235
    v_lshlrev_b32 v17, 16, v195
    v_mul_f32 v16, v16, v17
    v_and_b32 v17, 0xffff0000, v235
    v_and_b32 v21, 0xffff0000, v195
    v_mul_f32 v17, v17, v21
    v_cvt_pk_bf16_f32 v115, v16, v17
    v_mfma_f32_32x32x16_bf16 v[48:63], v[80:83], v[108:111], 0
    v_cvt_pk_bf16_f32 v17, v64, v65
    v_lshlrev_b32 v16, 16, v17
    v_and_b32 v17, 0xffff0000, v17
    v_add_f32 v16, v16, v32
    v_add_f32 v17, v17, v33
    v_cvt_pk_bf16_f32 v164, v16, v17
    v_pk_max_i16 v164, v164, 0
    v_cvt_pk_bf16_f32 v17, v66, v67
    v_lshlrev_b32 v16, 16, v17
    v_and_b32 v17, 0xffff0000, v17
    v_add_f32 v16, v16, v34
    v_add_f32 v17, v17, v35
    v_cvt_pk_bf16_f32 v165, v16, v17
    v_pk_max_i16 v165, v165, 0
    v_cvt_pk_bf16_f32 v17, v68, v69
    v_lshlrev_b32 v16, 16, v17
    v_and_b32 v17, 0xffff0000, v17
    v_add_f32 v16, v16, v36
    v_add_f32 v17, v17, v37
    v_cvt_pk_bf16_f32 v166, v16, v17
    v_pk_max_i16 v166, v166, 0
    v_cvt_pk_bf16_f32 v17, v70, v71
    v_lshlrev_b32 v16, 16, v17
    v_and_b32 v17, 0xffff0000, v17
    v_add_f32 v16, v16, v38
    v_add_f32 v17, v17, v39
    v_cvt_pk_bf16_f32 v167, v16, v17
    v_pk_max_i16 v167, v167, 0
    v_cvt_pk_bf16_f32 v17, v72, v73
    v_lshlrev_b32 v16, 16, v17
    v_and_b32 v17, 0xffff0000, v17
    v_add_f32 v16, v16, v40
    v_add_f32 v17, v17, v41
    v_cvt_pk_bf16_f32 v168, v16, v17
    v_pk_max_i16 v168, v168, 0
    v_cvt_pk_bf16_f32 v17, v74, v75
    v_lshlrev_b32 v16, 16, v17
    v_and_b32 v17, 0xffff0000, v17
    v_add_f32 v16, v16, v42
    v_add_f32 v17, v17, v43
    v_cvt_pk_bf16_f32 v169, v16, v17
    v_pk_max_i16 v169, v169, 0
    v_mfma_f32_32x32x16_bf16 v[48:63], v[84:87], v[112:115], v[48:63]
    s_waitcnt lgkmcnt(1)
    v_cvt_pk_bf16_f32 v17, v76, v77
    v_lshlrev_b32 v16, 16, v17
    v_and_b32 v17, 0xffff0000, v17
    v_add_f32 v16, v16, v44
    v_add_f32 v17, v17, v45
    v_cvt_pk_bf16_f32 v170, v16, v17
    v_pk_max_i16 v170, v170, 0
    v_cvt_pk_bf16_f32 v17, v78, v79
    v_lshlrev_b32 v16, 16, v17
    v_and_b32 v17, 0xffff0000, v17
    v_add_f32 v16, v16, v46
    v_add_f32 v17, v17, v47
    v_cvt_pk_bf16_f32 v171, v16, v17
    v_pk_max_i16 v171, v171, 0
    v_lshlrev_b32 v16, 16, v244
    v_lshlrev_b32 v17, 16, v236
    v_mul_f32 v16, v16, v17
    v_and_b32 v17, 0xffff0000, v244
    v_and_b32 v21, 0xffff0000, v236
    v_mul_f32 v17, v17, v21
    v_cvt_pk_bf16_f32 v116, v16, v17
    v_lshlrev_b32 v16, 16, v245
    v_lshlrev_b32 v17, 16, v237
    v_mul_f32 v16, v16, v17
    v_and_b32 v17, 0xffff0000, v245
    v_and_b32 v21, 0xffff0000, v237
    v_mul_f32 v17, v17, v21
    v_cvt_pk_bf16_f32 v117, v16, v17
    v_lshlrev_b32 v16, 16, v246
    v_lshlrev_b32 v17, 16, v238
    v_mul_f32 v16, v16, v17
    v_and_b32 v17, 0xffff0000, v246
    v_and_b32 v21, 0xffff0000, v238
    v_mul_f32 v17, v17, v21
    v_cvt_pk_bf16_f32 v118, v16, v17
    v_lshlrev_b32 v16, 16, v247
    v_lshlrev_b32 v17, 16, v239
    v_mul_f32 v16, v16, v17
    v_and_b32 v17, 0xffff0000, v247
    v_and_b32 v21, 0xffff0000, v239
    v_mul_f32 v17, v17, v21
    v_cvt_pk_bf16_f32 v119, v16, v17
    v_smfmac_f32_16x16x64_bf16 v[128:131], v[88:91], v[108:115], v1
    v_lshlrev_b32 v16, 16, v248
    v_lshlrev_b32 v17, 16, v240
    v_mul_f32 v16, v16, v17
    v_and_b32 v17, 0xffff0000, v248
    v_and_b32 v21, 0xffff0000, v240
    v_mul_f32 v17, v17, v21
    v_cvt_pk_bf16_f32 v120, v16, v17
    v_lshlrev_b32 v16, 16, v249
    v_lshlrev_b32 v17, 16, v241
    v_mul_f32 v16, v16, v17
    v_and_b32 v17, 0xffff0000, v249
    v_and_b32 v21, 0xffff0000, v241
    v_mul_f32 v17, v17, v21
    v_cvt_pk_bf16_f32 v121, v16, v17
    v_smfmac_f32_16x16x64_bf16 v[124:127], v[176:179], v[164:171], v1
    v_lshlrev_b32 v16, 16, v250
    v_lshlrev_b32 v17, 16, v242
    v_mul_f32 v16, v16, v17
    v_and_b32 v17, 0xffff0000, v250
    v_and_b32 v21, 0xffff0000, v242
    v_mul_f32 v17, v17, v21
    v_cvt_pk_bf16_f32 v122, v16, v17
    v_lshlrev_b32 v16, 16, v251
    v_lshlrev_b32 v17, 16, v243
    v_mul_f32 v16, v16, v17
    v_and_b32 v17, 0xffff0000, v251
    v_and_b32 v21, 0xffff0000, v243
    v_mul_f32 v17, v17, v21
    v_cvt_pk_bf16_f32 v123, v16, v17
    v_mfma_f32_32x32x16_bf16 v[64:79], v[80:83], v[116:119], 0
    v_cvt_pk_bf16_f32 v17, v48, v49
    v_lshlrev_b32 v16, 16, v17
    v_and_b32 v17, 0xffff0000, v17
    v_add_f32 v16, v16, v32
    v_add_f32 v17, v17, v33
    v_cvt_pk_bf16_f32 v164, v16, v17
    v_pk_max_i16 v164, v164, 0
    v_cvt_pk_bf16_f32 v17, v50, v51
    v_lshlrev_b32 v16, 16, v17
    v_and_b32 v17, 0xffff0000, v17
    v_add_f32 v16, v16, v34
    v_add_f32 v17, v17, v35
    v_cvt_pk_bf16_f32 v165, v16, v17
    v_pk_max_i16 v165, v165, 0
    v_cvt_pk_bf16_f32 v17, v52, v53
    v_lshlrev_b32 v16, 16, v17
    v_and_b32 v17, 0xffff0000, v17
    v_add_f32 v16, v16, v36
    v_add_f32 v17, v17, v37
    v_cvt_pk_bf16_f32 v166, v16, v17
    v_pk_max_i16 v166, v166, 0
    v_cvt_pk_bf16_f32 v17, v54, v55
    v_lshlrev_b32 v16, 16, v17
    v_and_b32 v17, 0xffff0000, v17
    v_add_f32 v16, v16, v38
    v_add_f32 v17, v17, v39
    v_cvt_pk_bf16_f32 v167, v16, v17
    v_pk_max_i16 v167, v167, 0
    v_cvt_pk_bf16_f32 v17, v56, v57
    v_lshlrev_b32 v16, 16, v17
    v_and_b32 v17, 0xffff0000, v17
    v_add_f32 v16, v16, v40
    v_add_f32 v17, v17, v41
    v_cvt_pk_bf16_f32 v168, v16, v17
    v_pk_max_i16 v168, v168, 0
    v_cvt_pk_bf16_f32 v17, v58, v59
    v_lshlrev_b32 v16, 16, v17
    v_and_b32 v17, 0xffff0000, v17
    v_add_f32 v16, v16, v42
    v_add_f32 v17, v17, v43
    v_cvt_pk_bf16_f32 v169, v16, v17
    v_pk_max_i16 v169, v169, 0
    v_mfma_f32_32x32x16_bf16 v[64:79], v[84:87], v[120:123], v[64:79]
    v_add_f32 v154, v124, v125
    v_add_f32 v99, v126, v127
    v_cvt_pk_bf16_f32 v154, 0, v154
    v_cvt_pk_bf16_f32 v17, v60, v61
    v_lshlrev_b32 v16, 16, v17
    v_and_b32 v17, 0xffff0000, v17
    v_add_f32 v16, v16, v44
    v_add_f32 v17, v17, v45
    v_cvt_pk_bf16_f32 v170, v16, v17
    v_pk_max_i16 v170, v170, 0
    v_cvt_pk_bf16_f32 v17, v62, v63
    v_lshlrev_b32 v16, 16, v17
    v_and_b32 v17, 0xffff0000, v17
    v_add_f32 v16, v16, v46
    v_add_f32 v17, v17, v47
    v_cvt_pk_bf16_f32 v171, v16, v17
    v_pk_max_i16 v171, v171, 0
    v_lshlrev_b32 v16, 16, v212
    v_lshlrev_b32 v17, 16, v228
    v_mul_f32 v16, v16, v17
    v_and_b32 v17, 0xffff0000, v212
    v_and_b32 v21, 0xffff0000, v228
    v_mul_f32 v17, v17, v21
    v_cvt_pk_bf16_f32 v108, v16, v17
    v_lshlrev_b32 v16, 16, v213
    v_lshlrev_b32 v17, 16, v229
    v_mul_f32 v16, v16, v17
    v_and_b32 v17, 0xffff0000, v213
    v_and_b32 v21, 0xffff0000, v229
    v_mul_f32 v17, v17, v21
    v_cvt_pk_bf16_f32 v109, v16, v17
    v_lshlrev_b32 v16, 16, v214
    v_lshlrev_b32 v17, 16, v230
    v_mul_f32 v16, v16, v17
    v_and_b32 v17, 0xffff0000, v214
    v_and_b32 v21, 0xffff0000, v230
    v_mul_f32 v17, v17, v21
    v_cvt_pk_bf16_f32 v110, v16, v17
    v_lshlrev_b32 v16, 16, v215
    v_lshlrev_b32 v17, 16, v231
    v_mul_f32 v16, v16, v17
    v_and_b32 v17, 0xffff0000, v215
    v_and_b32 v21, 0xffff0000, v231
    v_mul_f32 v17, v17, v21
    v_cvt_pk_bf16_f32 v111, v16, v17
    v_smfmac_f32_16x16x64_bf16 v[128:131], v[92:95], v[116:123], v1
    v_lshlrev_b32 v16, 16, v216
    v_lshlrev_b32 v17, 16, v232
    v_mul_f32 v16, v16, v17
    v_and_b32 v17, 0xffff0000, v216
    v_and_b32 v21, 0xffff0000, v232
    v_mul_f32 v17, v17, v21
    v_cvt_pk_bf16_f32 v112, v16, v17
    v_lshlrev_b32 v16, 16, v217
    v_lshlrev_b32 v17, 16, v233
    v_mul_f32 v16, v16, v17
    v_and_b32 v17, 0xffff0000, v217
    v_and_b32 v21, 0xffff0000, v233
    v_mul_f32 v17, v17, v21
    v_cvt_pk_bf16_f32 v113, v16, v17
    v_smfmac_f32_16x16x64_bf16 v[128:131], v[172:175], v[164:171], v1
    v_lshlrev_b32 v16, 16, v218
    v_lshlrev_b32 v17, 16, v234
    v_mul_f32 v16, v16, v17
    v_and_b32 v17, 0xffff0000, v218
    v_and_b32 v21, 0xffff0000, v234
    v_mul_f32 v17, v17, v21
    v_cvt_pk_bf16_f32 v114, v16, v17
    v_lshlrev_b32 v16, 16, v219
    v_lshlrev_b32 v17, 16, v235
    v_mul_f32 v16, v16, v17
    v_and_b32 v17, 0xffff0000, v219
    v_and_b32 v21, 0xffff0000, v235
    v_mul_f32 v17, v17, v21
    v_cvt_pk_bf16_f32 v115, v16, v17
    v_mfma_f32_32x32x16_bf16 v[48:63], v[80:83], v[108:111], 0
    v_cvt_pk_bf16_f32 v17, v64, v65
    v_lshlrev_b32 v16, 16, v17
    v_and_b32 v17, 0xffff0000, v17
    v_add_f32 v16, v16, v32
    v_add_f32 v17, v17, v33
    v_cvt_pk_bf16_f32 v164, v16, v17
    v_pk_max_i16 v164, v164, 0
    v_cvt_pk_bf16_f32 v17, v66, v67
    v_lshlrev_b32 v16, 16, v17
    v_and_b32 v17, 0xffff0000, v17
    v_add_f32 v16, v16, v34
    v_add_f32 v17, v17, v35
    v_cvt_pk_bf16_f32 v165, v16, v17
    v_pk_max_i16 v165, v165, 0
    v_cvt_pk_bf16_f32 v17, v68, v69
    v_lshlrev_b32 v16, 16, v17
    v_and_b32 v17, 0xffff0000, v17
    v_add_f32 v16, v16, v36
    v_add_f32 v17, v17, v37
    v_cvt_pk_bf16_f32 v166, v16, v17
    v_pk_max_i16 v166, v166, 0
    v_cvt_pk_bf16_f32 v17, v70, v71
    v_lshlrev_b32 v16, 16, v17
    v_and_b32 v17, 0xffff0000, v17
    v_add_f32 v16, v16, v38
    v_add_f32 v17, v17, v39
    v_cvt_pk_bf16_f32 v167, v16, v17
    v_pk_max_i16 v167, v167, 0
    v_cvt_pk_bf16_f32 v17, v72, v73
    v_lshlrev_b32 v16, 16, v17
    v_and_b32 v17, 0xffff0000, v17
    v_add_f32 v16, v16, v40
    v_add_f32 v17, v17, v41
    v_cvt_pk_bf16_f32 v168, v16, v17
    v_pk_max_i16 v168, v168, 0
    v_cvt_pk_bf16_f32 v17, v74, v75
    v_lshlrev_b32 v16, 16, v17
    v_and_b32 v17, 0xffff0000, v17
    v_add_f32 v16, v16, v42
    v_add_f32 v17, v17, v43
    v_cvt_pk_bf16_f32 v169, v16, v17
    v_pk_max_i16 v169, v169, 0
    v_mfma_f32_32x32x16_bf16 v[48:63], v[84:87], v[112:115], v[48:63]
    s_waitcnt lgkmcnt(0)
    v_cvt_pk_bf16_f32 v17, v76, v77
    v_lshlrev_b32 v16, 16, v17
    v_and_b32 v17, 0xffff0000, v17
    v_add_f32 v16, v16, v44
    v_add_f32 v17, v17, v45
    v_cvt_pk_bf16_f32 v170, v16, v17
    v_pk_max_i16 v170, v170, 0
    v_cvt_pk_bf16_f32 v17, v78, v79
    v_lshlrev_b32 v16, 16, v17
    v_and_b32 v17, 0xffff0000, v17
    v_add_f32 v16, v16, v46
    v_add_f32 v17, v17, v47
    v_cvt_pk_bf16_f32 v171, v16, v17
    v_pk_max_i16 v171, v171, 0
    v_smfmac_f32_16x16x64_bf16 v[132:135], v[88:91], v[108:115], v1
    s_nop 0
    v_smfmac_f32_16x16x64_bf16 v[128:131], v[176:179], v[164:171], v1
    v_cvt_pk_bf16_f32 v17, v48, v49
    v_lshlrev_b32 v16, 16, v17
    v_and_b32 v17, 0xffff0000, v17
    v_add_f32 v16, v16, v32
    v_add_f32 v17, v17, v33
    v_cvt_pk_bf16_f32 v164, v16, v17
    v_pk_max_i16 v164, v164, 0
    v_cvt_pk_bf16_f32 v17, v50, v51
    v_lshlrev_b32 v16, 16, v17
    v_and_b32 v17, 0xffff0000, v17
    v_add_f32 v16, v16, v34
    v_add_f32 v17, v17, v35
    v_cvt_pk_bf16_f32 v165, v16, v17
    v_pk_max_i16 v165, v165, 0
    v_cvt_pk_bf16_f32 v17, v52, v53
    v_lshlrev_b32 v16, 16, v17
    v_and_b32 v17, 0xffff0000, v17
    v_add_f32 v16, v16, v36
    v_add_f32 v17, v17, v37
    v_cvt_pk_bf16_f32 v166, v16, v17
    v_pk_max_i16 v166, v166, 0
    v_cvt_pk_bf16_f32 v17, v54, v55
    v_lshlrev_b32 v16, 16, v17
    v_and_b32 v17, 0xffff0000, v17
    v_add_f32 v16, v16, v38
    v_add_f32 v17, v17, v39
    v_cvt_pk_bf16_f32 v167, v16, v17
    v_pk_max_i16 v167, v167, 0
    v_cvt_pk_bf16_f32 v17, v56, v57
    v_lshlrev_b32 v16, 16, v17
    v_and_b32 v17, 0xffff0000, v17
    v_add_f32 v16, v16, v40
    v_add_f32 v17, v17, v41
    v_cvt_pk_bf16_f32 v168, v16, v17
    v_pk_max_i16 v168, v168, 0
    v_cvt_pk_bf16_f32 v17, v58, v59
    v_lshlrev_b32 v16, 16, v17
    v_and_b32 v17, 0xffff0000, v17
    v_add_f32 v16, v16, v42
    v_add_f32 v17, v17, v43
    v_cvt_pk_bf16_f32 v169, v16, v17
    v_pk_max_i16 v169, v169, 0
    v_add_f32 v155, v128, v129
    v_add_f32 v252, v130, v131
    v_cvt_pk_bf16_f32 v155, 0, v155
    v_cvt_pk_bf16_f32 v17, v60, v61
    v_lshlrev_b32 v16, 16, v17
    v_and_b32 v17, 0xffff0000, v17
    v_add_f32 v16, v16, v44
    v_add_f32 v17, v17, v45
    v_cvt_pk_bf16_f32 v170, v16, v17
    v_pk_max_i16 v170, v170, 0
    v_cvt_pk_bf16_f32 v17, v62, v63
    v_lshlrev_b32 v16, 16, v17
    v_and_b32 v17, 0xffff0000, v17
    v_add_f32 v16, v16, v46
    v_add_f32 v17, v17, v47
    v_cvt_pk_bf16_f32 v171, v16, v17
    v_pk_max_i16 v171, v171, 0
    s_nop 1
    v_smfmac_f32_16x16x64_bf16 v[132:135], v[172:175], v[164:171], v1
    s_nop 7
    v_add_f32 v156, v132, v133
    v_add_f32 v253, v134, v135
    v_cvt_pk_bf16_f32 v156, 0, v156
    v_max3_f32 v16, v136, v137, v138
    v_max3_f32 v16, v16, v139, v140
    v_max3_f32 v16, v16, v141, v142
    v_max3_f32 v16, v16, v143, v144
    v_max3_f32 v16, v16, v145, v146
    v_max3_f32 v16, v16, v147, v148
    v_max3_f32 v16, v16, v149, v150
    v_max3_f32 v16, v16, v151, v152
    v_max3_f32 v16, v16, v153, v154
    v_max3_f32 v16, v16, v155, v156
    s_nop 1
    v_max_f32_dpp v16, v16, v16 quad_perm:[1,0,3,2] row_mask:0xf bank_mask:0xf
    s_nop 1
    v_max_f32_dpp v16, v16, v16 quad_perm:[2,3,0,1] row_mask:0xf bank_mask:0xf
    s_nop 1
    v_max_f32_dpp v16, v16, v16 row_half_mirror row_mask:0xf bank_mask:0xf
    v_mov_b32 v17, v16
    s_nop 1
    v_permlane32_swap_b32 v16, v17
    v_max_f32 v16, v16, v17
    v_mov_b32 v15, 0
    v_mov_b32 v14, 0
    v_sub_f32 v17, v136, v16
    v_mul_f32 v17, 0x3fb8aa3b, v17
    v_exp_f32 v17, v17
    s_nop 0
    v_add_f32 v15, v15, v17
    v_fmac_f32 v14, v17, v157
    v_sub_f32 v17, v137, v16
    v_mul_f32 v17, 0x3fb8aa3b, v17
    v_exp_f32 v17, v17
    s_nop 0
    v_add_f32 v15, v15, v17
    v_fmac_f32 v14, v17, v158
    v_sub_f32 v17, v138, v16
    v_mul_f32 v17, 0x3fb8aa3b, v17
    v_exp_f32 v17, v17
    s_nop 0
    v_add_f32 v15, v15, v17
    v_fmac_f32 v14, v17, v159
    v_sub_f32 v17, v139, v16
    v_mul_f32 v17, 0x3fb8aa3b, v17
    v_exp_f32 v17, v17
    s_nop 0
    v_add_f32 v15, v15, v17
    v_fmac_f32 v14, v17, v160
    v_sub_f32 v17, v140, v16
    v_mul_f32 v17, 0x3fb8aa3b, v17
    v_exp_f32 v17, v17
    s_nop 0
    v_add_f32 v15, v15, v17
    v_fmac_f32 v14, v17, v161
    v_sub_f32 v17, v141, v16
    v_mul_f32 v17, 0x3fb8aa3b, v17
    v_exp_f32 v17, v17
    s_nop 0
    v_add_f32 v15, v15, v17
    v_fmac_f32 v14, v17, v162
    v_sub_f32 v17, v142, v16
    v_mul_f32 v17, 0x3fb8aa3b, v17
    v_exp_f32 v17, v17
    s_nop 0
    v_add_f32 v15, v15, v17
    v_fmac_f32 v14, v17, v163
    v_sub_f32 v17, v143, v16
    v_mul_f32 v17, 0x3fb8aa3b, v17
    v_exp_f32 v17, v17
    s_nop 0
    v_add_f32 v15, v15, v17
    v_fmac_f32 v14, v17, v100
    v_sub_f32 v17, v144, v16
    v_mul_f32 v17, 0x3fb8aa3b, v17
    v_exp_f32 v17, v17
    s_nop 0
    v_add_f32 v15, v15, v17
    v_fmac_f32 v14, v17, v101
    v_sub_f32 v17, v145, v16
    v_mul_f32 v17, 0x3fb8aa3b, v17
    v_exp_f32 v17, v17
    s_nop 0
    v_add_f32 v15, v15, v17
    v_fmac_f32 v14, v17, v102
    v_sub_f32 v17, v146, v16
    v_mul_f32 v17, 0x3fb8aa3b, v17
    v_exp_f32 v17, v17
    s_nop 0
    v_add_f32 v15, v15, v17
    v_fmac_f32 v14, v17, v103
    v_sub_f32 v17, v147, v16
    v_mul_f32 v17, 0x3fb8aa3b, v17
    v_exp_f32 v17, v17
    s_nop 0
    v_add_f32 v15, v15, v17
    v_fmac_f32 v14, v17, v104
    v_sub_f32 v17, v148, v16
    v_mul_f32 v17, 0x3fb8aa3b, v17
    v_exp_f32 v17, v17
    s_nop 0
    v_add_f32 v15, v15, v17
    v_fmac_f32 v14, v17, v105
    v_sub_f32 v17, v149, v16
    v_mul_f32 v17, 0x3fb8aa3b, v17
    v_exp_f32 v17, v17
    s_nop 0
    v_add_f32 v15, v15, v17
    v_fmac_f32 v14, v17, v106
    v_sub_f32 v17, v150, v16
    v_mul_f32 v17, 0x3fb8aa3b, v17
    v_exp_f32 v17, v17
    s_nop 0
    v_add_f32 v15, v15, v17
    v_fmac_f32 v14, v17, v107
    v_sub_f32 v17, v151, v16
    v_mul_f32 v17, 0x3fb8aa3b, v17
    v_exp_f32 v17, v17
    s_nop 0
    v_add_f32 v15, v15, v17
    v_fmac_f32 v14, v17, v96
    v_sub_f32 v17, v152, v16
    v_mul_f32 v17, 0x3fb8aa3b, v17
    v_exp_f32 v17, v17
    s_nop 0
    v_add_f32 v15, v15, v17
    v_fmac_f32 v14, v17, v97
    v_sub_f32 v17, v153, v16
    v_mul_f32 v17, 0x3fb8aa3b, v17
    v_exp_f32 v17, v17
    s_nop 0
    v_add_f32 v15, v15, v17
    v_fmac_f32 v14, v17, v98
    v_sub_f32 v17, v154, v16
    v_mul_f32 v17, 0x3fb8aa3b, v17
    v_exp_f32 v17, v17
    s_nop 0
    v_add_f32 v15, v15, v17
    v_fmac_f32 v14, v17, v99
    v_sub_f32 v17, v155, v16
    v_mul_f32 v17, 0x3fb8aa3b, v17
    v_exp_f32 v17, v17
    s_nop 0
    v_add_f32 v15, v15, v17
    v_fmac_f32 v14, v17, v252
    v_sub_f32 v17, v156, v16
    v_mul_f32 v17, 0x3fb8aa3b, v17
    v_exp_f32 v17, v17
    s_nop 0
    v_add_f32 v15, v15, v17
    v_fmac_f32 v14, v17, v253
    s_cbranch_scc0 L_mid_x
    v_permlane32_swap_b32 v19, v15
    v_permlane32_swap_b32 v18, v14
    v_add_f32 v15, v19, v15
    v_add_f32 v14, v18, v14
    s_nop 0
    v_add_f32_dpp v15, v15, v15 quad_perm:[1,0,3,2] row_mask:0xf bank_mask:0xf
    v_add_f32_dpp v14, v14, v14 quad_perm:[1,0,3,2] row_mask:0xf bank_mask:0xf
    s_nop 0
    v_add_f32_dpp v15, v15, v15 quad_perm:[2,3,0,1] row_mask:0xf bank_mask:0xf
    v_add_f32_dpp v14, v14, v14 quad_perm:[2,3,0,1] row_mask:0xf bank_mask:0xf
    s_nop 0
    v_add_f32_dpp v15, v15, v15 row_half_mirror row_mask:0xf bank_mask:0xf
    v_add_f32_dpp v14, v14, v14 row_half_mirror row_mask:0xf bank_mask:0xf
    v_rcp_f32 v19, v15
    s_mov_b64 exec, s[30:31]
    v_mul_f32 v14, v14, v19
    v_cvt_pk_bf16_f32 v16, v14, v14
    global_store_short v23, v16, s[16:17]
    s_endpgm
L_mid_x:
    s_mov_b32 s35, 1
    v_mov_b32 v19, v15
    v_mov_b32 v18, v14
    global_load_dwordx4 v[24:27], v23, s[4:5] offset:3328
    global_load_dword v30, v31, s[4:5] offset:3424
    global_load_dwordx2 v[28:29], v23, s[4:5] offset:3344
    s_waitcnt vmcnt(2)
    v_lshl_add_u32 v24, v24, 6, v20
    buffer_load_dwordx4 v[136:139], v24, s[20:23], 0 offen
    v_lshl_add_u32 v25, v25, 6, v20
    buffer_load_dwordx4 v[140:143], v25, s[20:23], 0 offen
    s_waitcnt vmcnt(3)
    v_lshl_add_u32 v30, v30, 6, v20
    buffer_load_dwordx4 v[144:147], v30, s[20:23], 0 offen
    v_lshl_add_u32 v26, v26, 6, v20
    buffer_load_dwordx4 v[148:151], v26, s[20:23], 0 offen
    v_lshl_add_u32 v27, v27, 6, v20
    buffer_load_dwordx4 v[152:155], v27, s[20:23], 0 offen
    s_waitcnt vmcnt(5)
    v_lshl_add_u32 v28, v28, 6, v20
    buffer_load_dwordx4 v[156:159], v28, s[20:23], 0 offen
    v_lshl_add_u32 v29, v29, 6, v20
    buffer_load_dwordx4 v[160:163], v29, s[20:23], 0 offen
    s_lshl_b32 s39, s2, 6
    s_mov_b32 s30, 0x01010101
    s_mov_b32 s31, s30
    v_bfe_u32 v23, v0, 6, 3
    v_bfe_u32 v31, v0, 3, 2
    v_lshl_add_u32 v23, v23, 2, v31
    v_and_or_b32 v31, v0, 32, s39
    v_add_lshl_u32 v23, v23, v31, 1
    s_branch L_job_x
.section .rodata,"a"
.p2align 6
.amdhsa_kernel standalone__factorization_afm__recsys_kernel
  .amdhsa_next_free_vgpr 256
  .amdhsa_next_free_sgpr 96
  .amdhsa_accum_offset 256
  .amdhsa_group_segment_fixed_size 0
  .amdhsa_kernarg_size 88
  .amdhsa_user_sgpr_count 2
  .amdhsa_user_sgpr_kernarg_segment_ptr 1
  .amdhsa_system_sgpr_workgroup_id_x 1
  .amdhsa_float_denorm_mode_32 3
.end_amdhsa_kernel
```
